```python
import torch

def _softmax(x, axis=-1):
    return torch.softmax(x, dim=axis)

def _gelu(x):
    return torch.nn.functional.gelu(x, approximate='tanh')

def _silu(x):
    return torch.nn.functional.silu(x)

def _sigmoid(x):
    return torch.sigmoid(x)

def _layernorm(x, axis=-1, eps=1e-05):
    m = x.mean(dim=axis, keepdim=True)
    v = x.var(dim=axis, keepdim=True, unbiased=False)
    return (x - m) / torch.sqrt(v + eps)

def _scatter_add(tgt, idx, src, axis=0):
    return tgt.clone().index_add_(axis, idx, src)

def _segment_sum(src, seg, n):
    out = torch.zeros((n,) + src.shape[1:], dtype=src.dtype)
    return out.index_add_(0, seg, src)

def _pad(x, pw):
    flat = tuple((v for pair in reversed(pw) for v in pair))
    return torch.nn.functional.pad(x, flat)
kernel_name = 'concat_heads__memory_aug_recurrent_mem_tr__ssm_conv_s5__prompt'

def setup_inputs():

    _w = lambda a: (lambda t: t.to(torch.bfloat16) if t.is_floating_point() else t)(torch.as_tensor(a))

    def _A_setup():
        B, S, Dm = (1, 2048, 512)
        H, Dh = (32, 128)
        M, seg = (8, 32)
        seg = min(seg, S)
        S = S // seg * seg
        return {'x': _w((lambda *s: torch.randn(*s, dtype=torch.bfloat16) * 0.05)(B, S, Dm)), 'mem0': _w((lambda *s: torch.randn(*s, dtype=torch.bfloat16) * 0.8)(B, M, Dm)), 'Wq': _w((lambda *s: torch.randn(*s, dtype=torch.bfloat16) * 1.6)(Dm, H, Dh) * Dm ** (-0.5)), 'Wk': _w((lambda *s: torch.randn(*s, dtype=torch.bfloat16) * 1.6)(Dm, H, Dh) * Dm ** (-0.5)), 'Wv': _w((lambda *s: torch.randn(*s, dtype=torch.bfloat16) * 0.8)(Dm, H, Dh) * Dm ** (-0.5)), 'Wo': _w((lambda *s: torch.randn(*s, dtype=torch.bfloat16) * 0.8)(H, Dh, Dm) * (H * Dh) ** (-0.5)), 'seg_len': seg}
    _A_in = _A_setup()

    def _B_setup():
        B, S, D = (1, 2048, 512)
        P = D
        Lambda_re = -0.5 * (lambda _x: torch.exp(torch.as_tensor(_x)))((lambda *s: torch.randn(*s, dtype=torch.bfloat16) * 0.8)(P))
        Lambda_im = (lambda *s: torch.randn(*s, dtype=torch.bfloat16) * 0.8)(P) * 1.0
        B_re = (lambda *s: torch.randn(*s, dtype=torch.bfloat16) * 0.8)(P, D) * D ** (-0.5)
        B_im = (lambda *s: torch.randn(*s, dtype=torch.bfloat16) * 0.8)(P, D) * D ** (-0.5)
        C_re = (lambda *s: torch.randn(*s, dtype=torch.bfloat16) * 0.8)(D, P) * P ** (-0.5)
        C_im = (lambda *s: torch.randn(*s, dtype=torch.bfloat16) * 0.8)(D, P) * P ** (-0.5)
        log_dt = (lambda *s: torch.randn(*s, dtype=torch.bfloat16) * 0.8)(P) * 0.3 - 2.0
        Dskip = (lambda *s: torch.randn(*s, dtype=torch.bfloat16) * 0.8)(D)
        return {'x': _w((lambda *s: torch.randn(*s, dtype=torch.bfloat16) * 0.05)(B, S, D)), 'Lambda_re': _w(Lambda_re), 'Lambda_im': _w(Lambda_im), 'B_re': _w(B_re), 'B_im': _w(B_im), 'C_re': _w(C_re), 'C_im': _w(C_im), 'log_dt': _w(log_dt), 'Dskip': _w(Dskip)}
    _B_in = _B_setup()
    return {'A_x': _A_in['x'], 'A_mem0': _A_in['mem0'], 'A_Wq': _A_in['Wq'], 'A_Wk': _A_in['Wk'], 'A_Wv': _A_in['Wv'], 'A_Wo': _A_in['Wo'], 'A_seg_len': _A_in['seg_len'], 'B_x': _B_in['x'], 'B_Lambda_re': _B_in['Lambda_re'], 'B_Lambda_im': _B_in['Lambda_im'], 'B_B_re': _B_in['B_re'], 'B_B_im': _B_in['B_im'], 'B_C_re': _B_in['C_re'], 'B_C_im': _B_in['C_im'], 'B_log_dt': _B_in['log_dt'], 'B_Dskip': _B_in['Dskip']}

def reference(A_x, A_mem0, A_Wq, A_Wk, A_Wv, A_Wo, A_seg_len, B_x, B_Lambda_re, B_Lambda_im, B_B_re, B_B_im, B_C_re, B_C_im, B_log_dt, B_Dskip):

    def _A_ref(x, mem0, Wq, Wk, Wv, Wo, seg_len):
        B, S, Dm = x.shape
        H, Dh = (Wq.shape[1], Wq.shape[2])
        M = mem0.shape[1]
        scale = Dh ** (-0.5)
        n_seg = S // seg_len
        L = M + seg_len
        idx = torch.arange(L)
        mask = (idx[:, None] < M) | (idx[:, None] >= idx[None, :])
        mem = mem0
        outs = []
        for s in range(n_seg):
            xs = x[:, s * seg_len:(s + 1) * seg_len, :].clone()
            h = torch.concatenate([mem, xs], axis=1)
            q = torch.einsum('btd,dhe->bhte', h, Wq)
            k = torch.einsum('btd,dhe->bhte', h, Wk)
            v = torch.einsum('btd,dhe->bhte', h, Wv)
            scores = torch.einsum('bhqe,bhke->bhqk', q, k) * scale
            scores = torch.where(mask[None, None], scores, -1000000000.0)
            p = _softmax(scores, axis=-1)
            o = torch.einsum('bhqk,bhke->bhqe', p, v)
            o = torch.einsum('bhte,hed->btd', o, Wo)
            mem = o[:, :M, :].clone()
            outs.append(o[:, M:, :])
        return torch.concatenate(outs, axis=1)

    def _B_ref(x, Lambda_re, Lambda_im, B_re, B_im, C_re, C_im, log_dt, Dskip):
        Bsz, L, H = x.shape
        Lam = Lambda_re + 1j * Lambda_im
        Bmat = B_re + 1j * B_im
        Cmat = C_re + 1j * C_im
        dt = torch.exp(log_dt)
        Lam_bar = torch.exp(dt * Lam)
        B_bar = ((Lam_bar - 1.0) / Lam)[:, None] * Bmat
        Bu = torch.einsum('bld,pd->blp', x + 0j, B_bar)
        h = torch.zeros_like(Bu[:, 0, :])
        hs = []
        for t in range(L):
            h = Lam_bar[None, :] * h + Bu[:, t, :]
            hs.append(h)
        hseq = torch.stack(hs, 1)
        y = 2.0 * torch.einsum('blp,dp->bld', hseq, Cmat).real + x * Dskip[None, None, :]
        return y
    a = _A_ref(A_x, A_mem0, A_Wq, A_Wk, A_Wv, A_Wo, A_seg_len)
    b = _B_ref(B_x, B_Lambda_re, B_Lambda_im, B_B_re, B_B_im, B_C_re, B_C_im, B_log_dt, B_Dskip)
    return torch.concatenate([a, b], axis=-1)
```

```asm
; @launch grid=(256,1,1) block=(256,1,1) lds=163840
.amdgcn_target "amdgcn-amd-amdhsa--gfx950"
.text
.globl concat_heads__memory_aug_recurrent_mem_tr__ssm_conv_s5__prompt_kernel
.p2align 8
.type concat_heads__memory_aug_recurrent_mem_tr__ssm_conv_s5__prompt_kernel,@function
concat_heads__memory_aug_recurrent_mem_tr__ssm_conv_s5__prompt_kernel:
    s_cmp_ge_u32 s2, 256
    s_cbranch_scc1 L_exit
    s_load_dwordx2 s[4:5], s[0:1], 136
    s_load_dwordx2 s[8:9], s[0:1], 144
    s_getreg_b32 s3, hwreg(HW_REG_XCC_ID, 0, 4)
    s_mov_b32 s10, 268435456
    s_mov_b32 s11, 0x20000
    s_waitcnt lgkmcnt(0)
    s_and_b32 s6, s3, 1
    s_lshl_b32 s6, s6, 6
    s_lshl_b32 s7, s3, 2
    s_add_u32 s6, s6, s7
    s_cmp_eq_u32 s3, 0
    s_cselect_b32 s6, 128, s6
    v_mov_b32 v1, s6
    v_mov_b32 v2, 1
    v_cmp_eq_u32 vcc, 0, v0
    s_and_saveexec_b64 s[6:7], vcc
    global_atomic_add v3, v1, v2, s[4:5] sc0
    s_waitcnt vmcnt(0)
    v_mov_b32 v4, 25984
    ds_write_b32 v4, v3
    s_waitcnt lgkmcnt(0)
    s_mov_b64 exec, s[6:7]
    s_cmp_lg_u32 s2, 0
    s_cbranch_scc1 L_noz
    v_mov_b32 v8, 0
    v_mov_b32 v9, 0
    v_mov_b32 v10, 0
    v_mov_b32 v11, 0
    v_lshlrev_b32 v5, 4, v0
    s_mov_b32 s6, 589824
    buffer_store_dwordx4 v[8:11], v5, s[8:11], s6 offen sc1
    s_add_u32 s6, s6, 4096
    buffer_store_dwordx4 v[8:11], v5, s[8:11], s6 offen sc1
    s_add_u32 s6, s6, 4096
    buffer_store_dwordx4 v[8:11], v5, s[8:11], s6 offen sc1
    s_add_u32 s6, s6, 4096
    buffer_store_dwordx4 v[8:11], v5, s[8:11], s6 offen sc1
    s_waitcnt vmcnt(0)
    s_barrier
    v_mov_b32 v5, 196
    v_mov_b32 v6, 1
    v_cmp_eq_u32 vcc, 0, v0
    s_and_saveexec_b64 s[12:13], vcc
    global_atomic_add v5, v6, s[4:5]
    s_mov_b64 exec, s[12:13]
L_noz:
    s_barrier
    v_mov_b32 v4, 25984
    ds_read_b32 v3, v4
    s_waitcnt lgkmcnt(0)
    v_readfirstlane_b32 s17, v3
    v_readfirstlane_b32 s18, v0
    s_lshr_b32 s18, s18, 6
    s_cmp_ge_u32 s17, 32
    s_cbranch_scc1 L_exit

    s_cmp_lg_u32 s3, 0
    s_cbranch_scc1 L_bulk

    v_and_b32 v32, 63, v0
    v_and_b32 v33, 15, v32
    v_lshrrev_b32 v40, 4, v32
    v_lshlrev_b32 v2, 4, v32
    v_and_b32 v41, 1, v32
    v_mul_u32_u24 v41, 0xAAAA, v41
    v_add_u32 v1, 0x4444, v41
    v_mul_u32_u24 v41, 544, v40
    v_lshlrev_b32 v42, 2, v33
    s_lshl_b32 s28, s18, 6
    v_add3_u32 v3, v41, v42, s28
    v_lshrrev_b32 v41, 1, v33
    v_mul_u32_u24 v43, 272, v41
    v_lshlrev_b32 v42, 4, v40
    v_add_u32 v4, v43, v42
    v_lshlrev_b32 v43, 6, v41
    v_lshrrev_b32 v44, 1, v40
    v_lshlrev_b32 v44, 9, v44
    v_add_u32 v43, v43, v44
    v_and_b32 v44, 1, v40
    v_lshlrev_b32 v44, 5, v44
    v_add_u32 v43, v43, v44
    v_and_b32 v44, 1, v33
    v_lshlrev_b32 v44, 4, v44
    v_add_u32 v6, v43, v44
    v_and_b32 v41, 7, v33
    v_mul_u32_u24 v41, 272, v41
    v_add_u32 v5, v41, v42
    s_lshl_b32 s28, s18, 12
    s_add_u32 s28, s28, 32768
    v_add_u32 v7, s28, v2
    v_add_u32 v8, 0x10000, v7
    v_mul_u32_u24 v41, 16640, v40
    v_lshlrev_b32 v42, 2, v33
    s_mul_i32 s28, s18, 66560
    s_lshl_b32 s29, s17, 6
    s_add_u32 s28, s28, s29
    v_add3_u32 v9, v41, v42, s28
    s_mul_i32 s28, s17, 8320
    s_lshl_b32 s29, s18, 11
    s_add_u32 s28, s28, s29
    v_add_u32 v10, s28, v2
    s_lshr_b32 s28, s17, 3
    s_lshl_b32 s28, s28, 2
    s_add_u32 s28, s28, s18
    s_lshl_b32 s28, s28, 9
    s_and_b32 s29, s17, 7
    s_lshl_b32 s29, s29, 6
    s_add_u32 s28, s28, s29
    v_and_b32 v41, 3, v32
    v_lshlrev_b32 v41, 4, v41
    v_lshlrev_b32 v43, 2, v40
    v_add3_u32 v11, v41, v43, s28
    v_lshrrev_b32 v41, 5, v32
    v_lshlrev_b32 v41, 11, v41
    v_and_b32 v42, 31, v32
    v_lshlrev_b32 v42, 4, v42
    s_lshl_b32 s28, s18, 9
    v_add3_u32 v12, v41, v42, s28
    v_lshrrev_b32 v41, 1, v40
    v_lshlrev_b32 v41, 8, v41
    v_lshlrev_b32 v42, 4, v33
    v_and_b32 v43, 1, v40
    v_lshlrev_b32 v43, 3, v43
    v_add3_u32 v13, v41, v42, v43
    v_lshlrev_b32 v41, 7, v40
    v_lshlrev_b32 v42, 2, v33
    v_add_u32 v14, v41, v42
    v_mov_b32 v15, -1
    v_lshrrev_b32 v43, 2, v33
    v_and_b32 v42, 3, v33
    v_mov_b32 v44, 0x3f80
    v_mov_b32 v45, 0x3f800000
    v_cmp_eq_u32 vcc, 1, v42
    s_nop 1
    v_cndmask_b32 v44, v44, v45, vcc
    v_cmp_gt_u32 vcc, 2, v42
    s_nop 1
    v_cndmask_b32 v44, 0, v44, vcc

    v_cmp_eq_u32 vcc, 0, v43
    s_nop 1
    v_cndmask_b32 v48, 0, v44, vcc
    v_cmp_eq_u32 vcc, 1, v43
    s_nop 1
    v_cndmask_b32 v49, 0, v44, vcc
    v_cmp_eq_u32 vcc, 2, v43
    s_nop 1
    v_cndmask_b32 v50, 0, v44, vcc
    v_cmp_eq_u32 vcc, 3, v43
    s_nop 1
    v_cndmask_b32 v51, 0, v44, vcc
    ds_write_b128 v2, v[48:51] offset:23936
    v_mov_b32 v52, 0x3f803f80
    v_mov_b32 v54, 0x3f803f80
    v_mov_b32 v41, 0x3f003f00
    v_cmp_gt_u32 vcc, 2, v40
    s_nop 1
    v_cndmask_b32 v53, 0, v41, vcc
    v_cndmask_b32 v55, 0, v41, vcc
    ds_write_b128 v2, v[52:55] offset:24960

    v_mov_b32 v16, 0
    v_mov_b32 v17, 0
    v_mov_b32 v18, 0
    v_mov_b32 v19, 0
    v_mov_b32 v20, 0
    v_mov_b32 v21, 0
    v_mov_b32 v22, 0
    v_mov_b32 v23, 0
    v_mov_b32 v24, 0
    v_mov_b32 v25, 0
    v_mov_b32 v26, 0
    v_mov_b32 v27, 0
    v_mov_b32 v28, 0
    v_mov_b32 v29, 0
    v_mov_b32 v30, 0
    v_mov_b32 v31, 0
    ds_write_b128 v2, v[16:19] offset:22912
    s_mov_b32 s30, 0xaaaaaaaa
    s_mov_b32 s31, 0xaaaaaaaa
    s_mov_b32 s32, 0x000f000f
    s_mov_b32 s33, 0x000f000f
    s_mov_b32 s36, 0x3e0293ee
    s_mov_b32 s37, 0
    s_lshl_b32 s28, s18, 11
    s_add_u32 s45, s28, 8192
    s_and_b32 s28, s18, 1
    s_lshl_b32 s28, s28, 12
    s_lshr_b32 s29, s18, 1
    s_mul_i32 s29, s29, 16777216
    s_add_u32 s35, s28, s29
    s_add_u32 s35, s35, 16777216

    v_and_b32 v32, 63, v0
    v_and_b32 v33, 15, v32
    v_lshrrev_b32 v40, 4, v32
    v_lshrrev_b32 v41, 1, v40
    v_lshlrev_b32 v41, 3, v41
    v_and_b32 v42, 1, v40
    v_lshlrev_b32 v42, 1, v42
    v_add_u32 v41, v41, v42
    v_lshrrev_b32 v42, 2, v33
    v_and_b32 v43, 1, v42
    v_lshlrev_b32 v43, 4, v43
    v_lshrrev_b32 v44, 1, v42
    v_lshlrev_b32 v44, 2, v44
    v_add3_u32 v41, v41, v43, v44
    v_lshlrev_b32 v41, 8, v41
    v_and_b32 v43, 3, v33
    v_lshlrev_b32 v43, 3, v43
    s_lshl_b32 s28, s18, 6
    s_add_u32 s28, s28, 32768
    v_add3_u32 v47, v41, v43, s28
    v_add_u32 v48, 0x10000, v47
    v_lshrrev_b32 v41, 1, v40
    v_lshlrev_b32 v41, 2, v41
    v_and_b32 v44, 1, v40
    v_lshlrev_b32 v44, 1, v44
    v_add_u32 v41, v41, v44
    v_and_b32 v44, 1, v42
    v_lshlrev_b32 v44, 4, v44
    v_add_u32 v41, v41, v44
    v_lshlrev_b32 v41, 10, v41
    v_lshrrev_b32 v44, 1, v42
    v_lshlrev_b32 v44, 5, v44
    v_add3_u32 v41, v41, v44, v43
    s_lshl_b32 s28, s18, 8
    s_add_u32 s28, s28, 32768
    v_add_u32 v49, s28, v41
    v_add_u32 v50, 0x10000, v49
    s_lshl_b32 s44, s17, 17
    s_lshl_b32 s29, s18, 12
    s_add_u32 s44, s44, s29
    s_load_dwordx2 s[12:13], s[0:1], 40
    s_mov_b32 s14, 0x400000
    s_mov_b32 s15, 0x20000
    s_waitcnt lgkmcnt(0)

    s_lshl_b32 s28, s18, 12
    s_add_u32 m0, s28, 32768
    s_add_u32 s29, s44, 0
    buffer_load_dwordx4 v2, s[12:15], s29 offen  lds
    s_lshl_b32 s28, s18, 12
    s_add_u32 m0, s28, 33792
    s_add_u32 s29, s44, 1024
    buffer_load_dwordx4 v2, s[12:15], s29 offen  lds
    s_lshl_b32 s28, s18, 12
    s_add_u32 m0, s28, 34816
    s_add_u32 s29, s44, 2048
    buffer_load_dwordx4 v2, s[12:15], s29 offen  lds
    s_lshl_b32 s28, s18, 12
    s_add_u32 m0, s28, 35840
    s_add_u32 s29, s44, 3072
    buffer_load_dwordx4 v2, s[12:15], s29 offen  lds
    s_lshl_b32 s28, s18, 12
    s_add_u32 m0, s28, 49152
    s_add_u32 s29, s44, 16384
    buffer_load_dwordx4 v2, s[12:15], s29 offen  lds
    s_lshl_b32 s28, s18, 12
    s_add_u32 m0, s28, 50176
    s_add_u32 s29, s44, 17408
    buffer_load_dwordx4 v2, s[12:15], s29 offen  lds
    s_lshl_b32 s28, s18, 12
    s_add_u32 m0, s28, 51200
    s_add_u32 s29, s44, 18432
    buffer_load_dwordx4 v2, s[12:15], s29 offen  lds
    s_lshl_b32 s28, s18, 12
    s_add_u32 m0, s28, 52224
    s_add_u32 s29, s44, 19456
    buffer_load_dwordx4 v2, s[12:15], s29 offen  lds
    s_lshl_b32 s28, s18, 12
    s_add_u32 m0, s28, 65536
    s_add_u32 s29, s44, 32768
    buffer_load_dwordx4 v2, s[12:15], s29 offen  lds
    s_lshl_b32 s28, s18, 12
    s_add_u32 m0, s28, 66560
    s_add_u32 s29, s44, 33792
    buffer_load_dwordx4 v2, s[12:15], s29 offen  lds
    s_lshl_b32 s28, s18, 12
    s_add_u32 m0, s28, 67584
    s_add_u32 s29, s44, 34816
    buffer_load_dwordx4 v2, s[12:15], s29 offen  lds
    s_lshl_b32 s28, s18, 12
    s_add_u32 m0, s28, 68608
    s_add_u32 s29, s44, 35840
    buffer_load_dwordx4 v2, s[12:15], s29 offen  lds
    s_lshl_b32 s28, s18, 12
    s_add_u32 m0, s28, 81920
    s_add_u32 s29, s44, 49152
    buffer_load_dwordx4 v2, s[12:15], s29 offen  lds
    s_lshl_b32 s28, s18, 12
    s_add_u32 m0, s28, 82944
    s_add_u32 s29, s44, 50176
    buffer_load_dwordx4 v2, s[12:15], s29 offen  lds
    s_lshl_b32 s28, s18, 12
    s_add_u32 m0, s28, 83968
    s_add_u32 s29, s44, 51200
    buffer_load_dwordx4 v2, s[12:15], s29 offen  lds
    s_lshl_b32 s28, s18, 12
    s_add_u32 m0, s28, 84992
    s_add_u32 s29, s44, 52224
    buffer_load_dwordx4 v2, s[12:15], s29 offen  lds
    s_lshl_b32 s28, s18, 12
    s_add_u32 m0, s28, 98304
    s_add_u32 s29, s44, 65536
    buffer_load_dwordx4 v2, s[12:15], s29 offen  lds
    s_lshl_b32 s28, s18, 12
    s_add_u32 m0, s28, 99328
    s_add_u32 s29, s44, 66560
    buffer_load_dwordx4 v2, s[12:15], s29 offen  lds
    s_lshl_b32 s28, s18, 12
    s_add_u32 m0, s28, 100352
    s_add_u32 s29, s44, 67584
    buffer_load_dwordx4 v2, s[12:15], s29 offen  lds
    s_lshl_b32 s28, s18, 12
    s_add_u32 m0, s28, 101376
    s_add_u32 s29, s44, 68608
    buffer_load_dwordx4 v2, s[12:15], s29 offen  lds
    s_lshl_b32 s28, s18, 12
    s_add_u32 m0, s28, 114688
    s_add_u32 s29, s44, 81920
    buffer_load_dwordx4 v2, s[12:15], s29 offen  lds
    s_lshl_b32 s28, s18, 12
    s_add_u32 m0, s28, 115712
    s_add_u32 s29, s44, 82944
    buffer_load_dwordx4 v2, s[12:15], s29 offen  lds
    s_lshl_b32 s28, s18, 12
    s_add_u32 m0, s28, 116736
    s_add_u32 s29, s44, 83968
    buffer_load_dwordx4 v2, s[12:15], s29 offen  lds
    s_lshl_b32 s28, s18, 12
    s_add_u32 m0, s28, 117760
    s_add_u32 s29, s44, 84992
    buffer_load_dwordx4 v2, s[12:15], s29 offen  lds
    s_lshl_b32 s28, s18, 12
    s_add_u32 m0, s28, 131072
    s_add_u32 s29, s44, 98304
    buffer_load_dwordx4 v2, s[12:15], s29 offen  lds
    s_lshl_b32 s28, s18, 12
    s_add_u32 m0, s28, 132096
    s_add_u32 s29, s44, 99328
    buffer_load_dwordx4 v2, s[12:15], s29 offen  lds
    s_lshl_b32 s28, s18, 12
    s_add_u32 m0, s28, 133120
    s_add_u32 s29, s44, 100352
    buffer_load_dwordx4 v2, s[12:15], s29 offen  lds
    s_lshl_b32 s28, s18, 12
    s_add_u32 m0, s28, 134144
    s_add_u32 s29, s44, 101376
    buffer_load_dwordx4 v2, s[12:15], s29 offen  lds
    s_lshl_b32 s28, s18, 12
    s_add_u32 m0, s28, 147456
    s_add_u32 s29, s44, 114688
    buffer_load_dwordx4 v2, s[12:15], s29 offen  lds
    s_lshl_b32 s28, s18, 12
    s_add_u32 m0, s28, 148480
    s_add_u32 s29, s44, 115712
    buffer_load_dwordx4 v2, s[12:15], s29 offen  lds
    s_lshl_b32 s28, s18, 12
    s_add_u32 m0, s28, 149504
    s_add_u32 s29, s44, 116736
    buffer_load_dwordx4 v2, s[12:15], s29 offen  lds
    s_lshl_b32 s28, s18, 12
    s_add_u32 m0, s28, 150528
    s_add_u32 s29, s44, 117760
    buffer_load_dwordx4 v2, s[12:15], s29 offen  lds
    v_mov_b32 v40, -1
    v_mov_b32 v41, -1
    v_mov_b32 v42, -1
    v_mov_b32 v43, -1
    s_mov_b32 s28, 1048576
    s_mov_b32 s29, 1318912
    buffer_store_dwordx4 v[40:43], v10, s[8:11], s28 offen
    buffer_store_dwordx4 v[40:43], v10, s[8:11], s28 offen offset:1024
    buffer_store_dwordx4 v[40:43], v10, s[8:11], s29 offen
    buffer_store_dwordx4 v[40:43], v10, s[8:11], s29 offen offset:1024
    s_mov_b64 exec, s[32:33]

    s_mov_b32 s28, 524288
    buffer_store_dword v40, v11, s[8:11], s28 offen
    s_mov_b32 s28, 532480
    buffer_store_dword v40, v11, s[8:11], s28 offen
    s_mov_b32 s28, 540672
    buffer_store_dword v40, v11, s[8:11], s28 offen
    s_mov_b32 s28, 548864
    buffer_store_dword v40, v11, s[8:11], s28 offen
    s_mov_b64 exec, -1
    s_load_dwordx2 s[48:49], s[0:1], 8
    s_mov_b32 s50, 8192
    s_mov_b32 s51, 0x20000
    v_lshrrev_b32 v72, 7, v0
    v_lshlrev_b32 v72, 6, v72
    v_bfe_u32 v73, v0, 4, 3
    v_lshlrev_b32 v73, 10, v73
    v_and_b32 v74, 15, v0
    v_lshlrev_b32 v74, 1, v74
    v_add3_u32 v72, v72, v73, v74
    s_waitcnt lgkmcnt(0)

    buffer_load_ushort v56, v72, s[48:51], 0 offen offset:0
    buffer_load_ushort v57, v72, s[48:51], 0 offen offset:32
    buffer_load_ushort v58, v72, s[48:51], 0 offen offset:128
    buffer_load_ushort v59, v72, s[48:51], 0 offen offset:160
    buffer_load_ushort v60, v72, s[48:51], 0 offen offset:256
    buffer_load_ushort v61, v72, s[48:51], 0 offen offset:288
    buffer_load_ushort v62, v72, s[48:51], 0 offen offset:384
    buffer_load_ushort v63, v72, s[48:51], 0 offen offset:416
    buffer_load_ushort v64, v72, s[48:51], 0 offen offset:512
    buffer_load_ushort v65, v72, s[48:51], 0 offen offset:544
    buffer_load_ushort v66, v72, s[48:51], 0 offen offset:640
    buffer_load_ushort v67, v72, s[48:51], 0 offen offset:672
    buffer_load_ushort v68, v72, s[48:51], 0 offen offset:768
    buffer_load_ushort v69, v72, s[48:51], 0 offen offset:800
    buffer_load_ushort v70, v72, s[48:51], 0 offen offset:896
    buffer_load_ushort v71, v72, s[48:51], 0 offen offset:928
    s_waitcnt vmcnt(48)
    s_barrier
    ds_read_b64_tr_b16 v[128:129], v49 offset:0
    ds_read_b64_tr_b16 v[130:131], v49 offset:1024
    ds_read_b64_tr_b16 v[132:133], v49 offset:8192
    ds_read_b64_tr_b16 v[134:135], v49 offset:9216
    ds_read_b64_tr_b16 v[160:161], v49 offset:64
    ds_read_b64_tr_b16 v[162:163], v49 offset:1088
    ds_read_b64_tr_b16 v[164:165], v49 offset:8256
    ds_read_b64_tr_b16 v[166:167], v49 offset:9280
    ds_read_b64_tr_b16 v[192:193], v49 offset:128
    ds_read_b64_tr_b16 v[194:195], v49 offset:1152
    ds_read_b64_tr_b16 v[196:197], v49 offset:8320
    ds_read_b64_tr_b16 v[198:199], v49 offset:9344
    ds_read_b64_tr_b16 v[224:225], v49 offset:192
    ds_read_b64_tr_b16 v[226:227], v49 offset:1216
    ds_read_b64_tr_b16 v[228:229], v49 offset:8384
    ds_read_b64_tr_b16 v[230:231], v49 offset:9408
    s_waitcnt lgkmcnt(0)
    s_waitcnt vmcnt(40)
    s_barrier
    ds_read_b64_tr_b16 v[136:137], v49 offset:32768
    ds_read_b64_tr_b16 v[138:139], v49 offset:33792
    ds_read_b64_tr_b16 v[140:141], v49 offset:40960
    ds_read_b64_tr_b16 v[142:143], v49 offset:41984
    ds_read_b64_tr_b16 v[168:169], v49 offset:32832
    ds_read_b64_tr_b16 v[170:171], v49 offset:33856
    ds_read_b64_tr_b16 v[172:173], v49 offset:41024
    ds_read_b64_tr_b16 v[174:175], v49 offset:42048
    ds_read_b64_tr_b16 v[200:201], v49 offset:32896
    ds_read_b64_tr_b16 v[202:203], v49 offset:33920
    ds_read_b64_tr_b16 v[204:205], v49 offset:41088
    ds_read_b64_tr_b16 v[206:207], v49 offset:42112
    ds_read_b64_tr_b16 v[232:233], v49 offset:32960
    ds_read_b64_tr_b16 v[234:235], v49 offset:33984
    ds_read_b64_tr_b16 v[236:237], v49 offset:41152
    ds_read_b64_tr_b16 v[238:239], v49 offset:42176
    s_waitcnt lgkmcnt(0)
    s_waitcnt vmcnt(32)
    s_barrier
    ds_read_b64_tr_b16 v[144:145], v50 offset:0
    ds_read_b64_tr_b16 v[146:147], v50 offset:1024
    ds_read_b64_tr_b16 v[148:149], v50 offset:8192
    ds_read_b64_tr_b16 v[150:151], v50 offset:9216
    ds_read_b64_tr_b16 v[176:177], v50 offset:64
    ds_read_b64_tr_b16 v[178:179], v50 offset:1088
    ds_read_b64_tr_b16 v[180:181], v50 offset:8256
    ds_read_b64_tr_b16 v[182:183], v50 offset:9280
    ds_read_b64_tr_b16 v[208:209], v50 offset:128
    ds_read_b64_tr_b16 v[210:211], v50 offset:1152
    ds_read_b64_tr_b16 v[212:213], v50 offset:8320
    ds_read_b64_tr_b16 v[214:215], v50 offset:9344
    ds_read_b64_tr_b16 v[240:241], v50 offset:192
    ds_read_b64_tr_b16 v[242:243], v50 offset:1216
    ds_read_b64_tr_b16 v[244:245], v50 offset:8384
    ds_read_b64_tr_b16 v[246:247], v50 offset:9408
    s_waitcnt lgkmcnt(0)
    s_waitcnt vmcnt(24)
    s_barrier
    ds_read_b64_tr_b16 v[152:153], v50 offset:32768
    ds_read_b64_tr_b16 v[154:155], v50 offset:33792
    ds_read_b64_tr_b16 v[156:157], v50 offset:40960
    ds_read_b64_tr_b16 v[158:159], v50 offset:41984
    ds_read_b64_tr_b16 v[184:185], v50 offset:32832
    ds_read_b64_tr_b16 v[186:187], v50 offset:33856
    ds_read_b64_tr_b16 v[188:189], v50 offset:41024
    ds_read_b64_tr_b16 v[190:191], v50 offset:42048
    ds_read_b64_tr_b16 v[216:217], v50 offset:32896
    ds_read_b64_tr_b16 v[218:219], v50 offset:33920
    ds_read_b64_tr_b16 v[220:221], v50 offset:41088
    ds_read_b64_tr_b16 v[222:223], v50 offset:42112
    ds_read_b64_tr_b16 v[248:249], v50 offset:32960
    ds_read_b64_tr_b16 v[250:251], v50 offset:33984
    ds_read_b64_tr_b16 v[252:253], v50 offset:41152
    ds_read_b64_tr_b16 v[254:255], v50 offset:42176
    s_waitcnt lgkmcnt(0)
    s_waitcnt vmcnt(0)
    s_barrier
    v_lshlrev_b32 v73, 2, v0
    v_lshl_or_b32 v56, v57, 16, v56
    ds_write_b32 v73, v56 offset:0
    v_lshl_or_b32 v58, v59, 16, v58
    ds_write_b32 v73, v58 offset:1024
    v_lshl_or_b32 v60, v61, 16, v60
    ds_write_b32 v73, v60 offset:2048
    v_lshl_or_b32 v62, v63, 16, v62
    ds_write_b32 v73, v62 offset:3072
    v_lshl_or_b32 v64, v65, 16, v64
    ds_write_b32 v73, v64 offset:4096
    v_lshl_or_b32 v66, v67, 16, v66
    ds_write_b32 v73, v66 offset:5120
    v_lshl_or_b32 v68, v69, 16, v68
    ds_write_b32 v73, v68 offset:6144
    v_lshl_or_b32 v70, v71, 16, v70
    ds_write_b32 v73, v70 offset:7168
    s_waitcnt lgkmcnt(0)
    v_mov_b32 v40, 192
    v_mov_b32 v41, 1
    v_cmp_eq_u32 vcc, 0, v0
    s_and_saveexec_b64 s[6:7], vcc
    global_atomic_add v40, v41, s[4:5]
    s_mov_b64 exec, s[6:7]
    v_mov_b32 v52, 196
L_fzw:
    global_load_dword v53, v52, s[4:5] sc1
    s_waitcnt vmcnt(0)
    v_readfirstlane_b32 s28, v53
    s_cmp_ge_u32 s28, 1
    s_cbranch_scc1 L_fzd
    s_add_u32 s37, s37, 1
    s_cmp_lt_u32 s37, 1000000
    s_cbranch_scc1 L_fzw
    s_endpgm
L_fzd:
    v_and_b32 v40, 7, v32
    v_lshlrev_b32 v40, 7, v40
    v_min_u32 v40, 768, v40
    s_mov_b32 s29, 602112
L_wtw_m:
    buffer_load_dword v41, v40, s[8:11], s29 offen sc1
    s_waitcnt vmcnt(0)
    v_cmp_gt_u32 vcc, 32, v41
    s_cbranch_vccz L_wtd_m
    s_add_u32 s37, s37, 1
    s_cmp_lt_u32 s37, 1000000
    s_cbranch_scc1 L_wtw_m
    s_endpgm
L_wtd_m:
    s_lshl_b32 s28, s18, 12
    s_add_u32 m0, s28, 32768
    s_add_u32 s29, s44, 117440512
    buffer_load_dwordx4 v2, s[8:11], s29 offen sc1 lds
    s_lshl_b32 s28, s18, 12
    s_add_u32 m0, s28, 33792
    s_add_u32 s29, s44, 117441536
    buffer_load_dwordx4 v2, s[8:11], s29 offen sc1 lds
    s_lshl_b32 s28, s18, 12
    s_add_u32 m0, s28, 34816
    s_add_u32 s29, s44, 117442560
    buffer_load_dwordx4 v2, s[8:11], s29 offen sc1 lds
    s_lshl_b32 s28, s18, 12
    s_add_u32 m0, s28, 35840
    s_add_u32 s29, s44, 117443584
    buffer_load_dwordx4 v2, s[8:11], s29 offen sc1 lds
    s_lshl_b32 s28, s18, 12
    s_add_u32 m0, s28, 49152
    s_add_u32 s29, s44, 117456896
    buffer_load_dwordx4 v2, s[8:11], s29 offen sc1 lds
    s_lshl_b32 s28, s18, 12
    s_add_u32 m0, s28, 50176
    s_add_u32 s29, s44, 117457920
    buffer_load_dwordx4 v2, s[8:11], s29 offen sc1 lds
    s_lshl_b32 s28, s18, 12
    s_add_u32 m0, s28, 51200
    s_add_u32 s29, s44, 117458944
    buffer_load_dwordx4 v2, s[8:11], s29 offen sc1 lds
    s_lshl_b32 s28, s18, 12
    s_add_u32 m0, s28, 52224
    s_add_u32 s29, s44, 117459968
    buffer_load_dwordx4 v2, s[8:11], s29 offen sc1 lds
    s_lshl_b32 s28, s18, 12
    s_add_u32 m0, s28, 65536
    s_add_u32 s29, s44, 117473280
    buffer_load_dwordx4 v2, s[8:11], s29 offen sc1 lds
    s_lshl_b32 s28, s18, 12
    s_add_u32 m0, s28, 66560
    s_add_u32 s29, s44, 117474304
    buffer_load_dwordx4 v2, s[8:11], s29 offen sc1 lds
    s_lshl_b32 s28, s18, 12
    s_add_u32 m0, s28, 67584
    s_add_u32 s29, s44, 117475328
    buffer_load_dwordx4 v2, s[8:11], s29 offen sc1 lds
    s_lshl_b32 s28, s18, 12
    s_add_u32 m0, s28, 68608
    s_add_u32 s29, s44, 117476352
    buffer_load_dwordx4 v2, s[8:11], s29 offen sc1 lds
    s_lshl_b32 s28, s18, 12
    s_add_u32 m0, s28, 81920
    s_add_u32 s29, s44, 117489664
    buffer_load_dwordx4 v2, s[8:11], s29 offen sc1 lds
    s_lshl_b32 s28, s18, 12
    s_add_u32 m0, s28, 82944
    s_add_u32 s29, s44, 117490688
    buffer_load_dwordx4 v2, s[8:11], s29 offen sc1 lds
    s_lshl_b32 s28, s18, 12
    s_add_u32 m0, s28, 83968
    s_add_u32 s29, s44, 117491712
    buffer_load_dwordx4 v2, s[8:11], s29 offen sc1 lds
    s_lshl_b32 s28, s18, 12
    s_add_u32 m0, s28, 84992
    s_add_u32 s29, s44, 117492736
    buffer_load_dwordx4 v2, s[8:11], s29 offen sc1 lds
    s_lshl_b32 s28, s18, 12
    s_add_u32 m0, s28, 98304
    s_add_u32 s29, s44, 117506048
    buffer_load_dwordx4 v2, s[8:11], s29 offen sc1 lds
    s_lshl_b32 s28, s18, 12
    s_add_u32 m0, s28, 99328
    s_add_u32 s29, s44, 117507072
    buffer_load_dwordx4 v2, s[8:11], s29 offen sc1 lds
    s_lshl_b32 s28, s18, 12
    s_add_u32 m0, s28, 100352
    s_add_u32 s29, s44, 117508096
    buffer_load_dwordx4 v2, s[8:11], s29 offen sc1 lds
    s_lshl_b32 s28, s18, 12
    s_add_u32 m0, s28, 101376
    s_add_u32 s29, s44, 117509120
    buffer_load_dwordx4 v2, s[8:11], s29 offen sc1 lds
    s_lshl_b32 s28, s18, 12
    s_add_u32 m0, s28, 114688
    s_add_u32 s29, s44, 117522432
    buffer_load_dwordx4 v2, s[8:11], s29 offen sc1 lds
    s_lshl_b32 s28, s18, 12
    s_add_u32 m0, s28, 115712
    s_add_u32 s29, s44, 117523456
    buffer_load_dwordx4 v2, s[8:11], s29 offen sc1 lds
    s_lshl_b32 s28, s18, 12
    s_add_u32 m0, s28, 116736
    s_add_u32 s29, s44, 117524480
    buffer_load_dwordx4 v2, s[8:11], s29 offen sc1 lds
    s_lshl_b32 s28, s18, 12
    s_add_u32 m0, s28, 117760
    s_add_u32 s29, s44, 117525504
    buffer_load_dwordx4 v2, s[8:11], s29 offen sc1 lds
    s_lshl_b32 s28, s18, 12
    s_add_u32 m0, s28, 131072
    s_add_u32 s29, s44, 117538816
    buffer_load_dwordx4 v2, s[8:11], s29 offen sc1 lds
    s_lshl_b32 s28, s18, 12
    s_add_u32 m0, s28, 132096
    s_add_u32 s29, s44, 117539840
    buffer_load_dwordx4 v2, s[8:11], s29 offen sc1 lds
    s_lshl_b32 s28, s18, 12
    s_add_u32 m0, s28, 133120
    s_add_u32 s29, s44, 117540864
    buffer_load_dwordx4 v2, s[8:11], s29 offen sc1 lds
    s_lshl_b32 s28, s18, 12
    s_add_u32 m0, s28, 134144
    s_add_u32 s29, s44, 117541888
    buffer_load_dwordx4 v2, s[8:11], s29 offen sc1 lds
    s_lshl_b32 s28, s18, 12
    s_add_u32 m0, s28, 147456
    s_add_u32 s29, s44, 117555200
    buffer_load_dwordx4 v2, s[8:11], s29 offen sc1 lds
    s_lshl_b32 s28, s18, 12
    s_add_u32 m0, s28, 148480
    s_add_u32 s29, s44, 117556224
    buffer_load_dwordx4 v2, s[8:11], s29 offen sc1 lds
    s_lshl_b32 s28, s18, 12
    s_add_u32 m0, s28, 149504
    s_add_u32 s29, s44, 117557248
    buffer_load_dwordx4 v2, s[8:11], s29 offen sc1 lds
    s_lshl_b32 s28, s18, 12
    s_add_u32 m0, s28, 150528
    s_add_u32 s29, s44, 117558272
    buffer_load_dwordx4 v2, s[8:11], s29 offen sc1 lds
    s_waitcnt vmcnt(28)
    s_barrier
    ds_read_b64_tr_b16 a[0:1], v47 offset:0
    ds_read_b64_tr_b16 a[2:3], v47 offset:256
    ds_read_b64_tr_b16 a[4:5], v47 offset:8192
    ds_read_b64_tr_b16 a[6:7], v47 offset:8448
    ds_read_b64_tr_b16 a[64:65], v47 offset:32
    ds_read_b64_tr_b16 a[66:67], v47 offset:288
    ds_read_b64_tr_b16 a[68:69], v47 offset:8224
    ds_read_b64_tr_b16 a[70:71], v47 offset:8480
    s_waitcnt lgkmcnt(0)
    s_waitcnt vmcnt(24)
    s_barrier
    s_lshl_b32 s28, s18, 12
    s_add_u32 m0, s28, 32768
    s_add_u32 s29, s44, 121634816
    buffer_load_dwordx4 v2, s[8:11], s29 offen sc1 lds
    s_lshl_b32 s28, s18, 12
    s_add_u32 m0, s28, 33792
    s_add_u32 s29, s44, 121635840
    buffer_load_dwordx4 v2, s[8:11], s29 offen sc1 lds
    s_lshl_b32 s28, s18, 12
    s_add_u32 m0, s28, 34816
    s_add_u32 s29, s44, 121636864
    buffer_load_dwordx4 v2, s[8:11], s29 offen sc1 lds
    s_lshl_b32 s28, s18, 12
    s_add_u32 m0, s28, 35840
    s_add_u32 s29, s44, 121637888
    buffer_load_dwordx4 v2, s[8:11], s29 offen sc1 lds
    ds_read_b64_tr_b16 a[8:9], v47 offset:16384
    ds_read_b64_tr_b16 a[10:11], v47 offset:16640
    ds_read_b64_tr_b16 a[12:13], v47 offset:24576
    ds_read_b64_tr_b16 a[14:15], v47 offset:24832
    ds_read_b64_tr_b16 a[72:73], v47 offset:16416
    ds_read_b64_tr_b16 a[74:75], v47 offset:16672
    ds_read_b64_tr_b16 a[76:77], v47 offset:24608
    ds_read_b64_tr_b16 a[78:79], v47 offset:24864
    s_waitcnt lgkmcnt(0)
    s_waitcnt vmcnt(24)
    s_barrier
    s_lshl_b32 s28, s18, 12
    s_add_u32 m0, s28, 49152
    s_add_u32 s29, s44, 121651200
    buffer_load_dwordx4 v2, s[8:11], s29 offen sc1 lds
    s_lshl_b32 s28, s18, 12
    s_add_u32 m0, s28, 50176
    s_add_u32 s29, s44, 121652224
    buffer_load_dwordx4 v2, s[8:11], s29 offen sc1 lds
    s_lshl_b32 s28, s18, 12
    s_add_u32 m0, s28, 51200
    s_add_u32 s29, s44, 121653248
    buffer_load_dwordx4 v2, s[8:11], s29 offen sc1 lds
    s_lshl_b32 s28, s18, 12
    s_add_u32 m0, s28, 52224
    s_add_u32 s29, s44, 121654272
    buffer_load_dwordx4 v2, s[8:11], s29 offen sc1 lds
    ds_read_b64_tr_b16 a[16:17], v47 offset:32768
    ds_read_b64_tr_b16 a[18:19], v47 offset:33024
    ds_read_b64_tr_b16 a[20:21], v47 offset:40960
    ds_read_b64_tr_b16 a[22:23], v47 offset:41216
    ds_read_b64_tr_b16 a[80:81], v47 offset:32800
    ds_read_b64_tr_b16 a[82:83], v47 offset:33056
    ds_read_b64_tr_b16 a[84:85], v47 offset:40992
    ds_read_b64_tr_b16 a[86:87], v47 offset:41248
    s_waitcnt lgkmcnt(0)
    s_waitcnt vmcnt(24)
    s_barrier
    s_lshl_b32 s28, s18, 12
    s_add_u32 m0, s28, 65536
    s_add_u32 s29, s44, 121667584
    buffer_load_dwordx4 v2, s[8:11], s29 offen sc1 lds
    s_lshl_b32 s28, s18, 12
    s_add_u32 m0, s28, 66560
    s_add_u32 s29, s44, 121668608
    buffer_load_dwordx4 v2, s[8:11], s29 offen sc1 lds
    s_lshl_b32 s28, s18, 12
    s_add_u32 m0, s28, 67584
    s_add_u32 s29, s44, 121669632
    buffer_load_dwordx4 v2, s[8:11], s29 offen sc1 lds
    s_lshl_b32 s28, s18, 12
    s_add_u32 m0, s28, 68608
    s_add_u32 s29, s44, 121670656
    buffer_load_dwordx4 v2, s[8:11], s29 offen sc1 lds
    ds_read_b64_tr_b16 a[24:25], v47 offset:49152
    ds_read_b64_tr_b16 a[26:27], v47 offset:49408
    ds_read_b64_tr_b16 a[28:29], v47 offset:57344
    ds_read_b64_tr_b16 a[30:31], v47 offset:57600
    ds_read_b64_tr_b16 a[88:89], v47 offset:49184
    ds_read_b64_tr_b16 a[90:91], v47 offset:49440
    ds_read_b64_tr_b16 a[92:93], v47 offset:57376
    ds_read_b64_tr_b16 a[94:95], v47 offset:57632
    s_waitcnt lgkmcnt(0)
    s_waitcnt vmcnt(24)
    s_barrier
    s_lshl_b32 s28, s18, 12
    s_add_u32 m0, s28, 81920
    s_add_u32 s29, s44, 121683968
    buffer_load_dwordx4 v2, s[8:11], s29 offen sc1 lds
    s_lshl_b32 s28, s18, 12
    s_add_u32 m0, s28, 82944
    s_add_u32 s29, s44, 121684992
    buffer_load_dwordx4 v2, s[8:11], s29 offen sc1 lds
    s_lshl_b32 s28, s18, 12
    s_add_u32 m0, s28, 83968
    s_add_u32 s29, s44, 121686016
    buffer_load_dwordx4 v2, s[8:11], s29 offen sc1 lds
    s_lshl_b32 s28, s18, 12
    s_add_u32 m0, s28, 84992
    s_add_u32 s29, s44, 121687040
    buffer_load_dwordx4 v2, s[8:11], s29 offen sc1 lds
    ds_read_b64_tr_b16 a[32:33], v48 offset:0
    ds_read_b64_tr_b16 a[34:35], v48 offset:256
    ds_read_b64_tr_b16 a[36:37], v48 offset:8192
    ds_read_b64_tr_b16 a[38:39], v48 offset:8448
    ds_read_b64_tr_b16 a[96:97], v48 offset:32
    ds_read_b64_tr_b16 a[98:99], v48 offset:288
    ds_read_b64_tr_b16 a[100:101], v48 offset:8224
    ds_read_b64_tr_b16 a[102:103], v48 offset:8480
    s_waitcnt lgkmcnt(0)
    s_waitcnt vmcnt(24)
    s_barrier
    s_lshl_b32 s28, s18, 12
    s_add_u32 m0, s28, 98304
    s_add_u32 s29, s44, 121700352
    buffer_load_dwordx4 v2, s[8:11], s29 offen sc1 lds
    s_lshl_b32 s28, s18, 12
    s_add_u32 m0, s28, 99328
    s_add_u32 s29, s44, 121701376
    buffer_load_dwordx4 v2, s[8:11], s29 offen sc1 lds
    s_lshl_b32 s28, s18, 12
    s_add_u32 m0, s28, 100352
    s_add_u32 s29, s44, 121702400
    buffer_load_dwordx4 v2, s[8:11], s29 offen sc1 lds
    s_lshl_b32 s28, s18, 12
    s_add_u32 m0, s28, 101376
    s_add_u32 s29, s44, 121703424
    buffer_load_dwordx4 v2, s[8:11], s29 offen sc1 lds
    ds_read_b64_tr_b16 a[40:41], v48 offset:16384
    ds_read_b64_tr_b16 a[42:43], v48 offset:16640
    ds_read_b64_tr_b16 a[44:45], v48 offset:24576
    ds_read_b64_tr_b16 a[46:47], v48 offset:24832
    ds_read_b64_tr_b16 a[104:105], v48 offset:16416
    ds_read_b64_tr_b16 a[106:107], v48 offset:16672
    ds_read_b64_tr_b16 a[108:109], v48 offset:24608
    ds_read_b64_tr_b16 a[110:111], v48 offset:24864
    s_waitcnt lgkmcnt(0)
    s_waitcnt vmcnt(24)
    s_barrier
    s_lshl_b32 s28, s18, 12
    s_add_u32 m0, s28, 114688
    s_add_u32 s29, s44, 121716736
    buffer_load_dwordx4 v2, s[8:11], s29 offen sc1 lds
    s_lshl_b32 s28, s18, 12
    s_add_u32 m0, s28, 115712
    s_add_u32 s29, s44, 121717760
    buffer_load_dwordx4 v2, s[8:11], s29 offen sc1 lds
    s_lshl_b32 s28, s18, 12
    s_add_u32 m0, s28, 116736
    s_add_u32 s29, s44, 121718784
    buffer_load_dwordx4 v2, s[8:11], s29 offen sc1 lds
    s_lshl_b32 s28, s18, 12
    s_add_u32 m0, s28, 117760
    s_add_u32 s29, s44, 121719808
    buffer_load_dwordx4 v2, s[8:11], s29 offen sc1 lds
    ds_read_b64_tr_b16 a[48:49], v48 offset:32768
    ds_read_b64_tr_b16 a[50:51], v48 offset:33024
    ds_read_b64_tr_b16 a[52:53], v48 offset:40960
    ds_read_b64_tr_b16 a[54:55], v48 offset:41216
    ds_read_b64_tr_b16 a[112:113], v48 offset:32800
    ds_read_b64_tr_b16 a[114:115], v48 offset:33056
    ds_read_b64_tr_b16 a[116:117], v48 offset:40992
    ds_read_b64_tr_b16 a[118:119], v48 offset:41248
    s_waitcnt lgkmcnt(0)
    s_waitcnt vmcnt(24)
    s_barrier
    s_lshl_b32 s28, s18, 12
    s_add_u32 m0, s28, 131072
    s_add_u32 s29, s44, 121733120
    buffer_load_dwordx4 v2, s[8:11], s29 offen sc1 lds
    s_lshl_b32 s28, s18, 12
    s_add_u32 m0, s28, 132096
    s_add_u32 s29, s44, 121734144
    buffer_load_dwordx4 v2, s[8:11], s29 offen sc1 lds
    s_lshl_b32 s28, s18, 12
    s_add_u32 m0, s28, 133120
    s_add_u32 s29, s44, 121735168
    buffer_load_dwordx4 v2, s[8:11], s29 offen sc1 lds
    s_lshl_b32 s28, s18, 12
    s_add_u32 m0, s28, 134144
    s_add_u32 s29, s44, 121736192
    buffer_load_dwordx4 v2, s[8:11], s29 offen sc1 lds
    ds_read_b64_tr_b16 a[56:57], v48 offset:49152
    ds_read_b64_tr_b16 a[58:59], v48 offset:49408
    ds_read_b64_tr_b16 a[60:61], v48 offset:57344
    ds_read_b64_tr_b16 a[62:63], v48 offset:57600
    ds_read_b64_tr_b16 a[120:121], v48 offset:49184
    ds_read_b64_tr_b16 a[122:123], v48 offset:49440
    ds_read_b64_tr_b16 a[124:125], v48 offset:57376
    ds_read_b64_tr_b16 a[126:127], v48 offset:57632
    s_waitcnt lgkmcnt(0)
    s_waitcnt vmcnt(24)
    s_barrier
    s_lshl_b32 s28, s18, 12
    s_add_u32 m0, s28, 147456
    s_add_u32 s29, s44, 121749504
    buffer_load_dwordx4 v2, s[8:11], s29 offen sc1 lds
    s_lshl_b32 s28, s18, 12
    s_add_u32 m0, s28, 148480
    s_add_u32 s29, s44, 121750528
    buffer_load_dwordx4 v2, s[8:11], s29 offen sc1 lds
    s_lshl_b32 s28, s18, 12
    s_add_u32 m0, s28, 149504
    s_add_u32 s29, s44, 121751552
    buffer_load_dwordx4 v2, s[8:11], s29 offen sc1 lds
    s_lshl_b32 s28, s18, 12
    s_add_u32 m0, s28, 150528
    s_add_u32 s29, s44, 121752576
    buffer_load_dwordx4 v2, s[8:11], s29 offen sc1 lds
    ds_read_b64_tr_b16 a[128:129], v47 offset:0
    ds_read_b64_tr_b16 a[130:131], v47 offset:256
    ds_read_b64_tr_b16 a[132:133], v47 offset:8192
    ds_read_b64_tr_b16 a[134:135], v47 offset:8448
    ds_read_b64_tr_b16 a[192:193], v47 offset:32
    ds_read_b64_tr_b16 a[194:195], v47 offset:288
    ds_read_b64_tr_b16 a[196:197], v47 offset:8224
    ds_read_b64_tr_b16 a[198:199], v47 offset:8480
    s_waitcnt lgkmcnt(0)
    s_waitcnt vmcnt(24)
    s_barrier
    s_lshl_b32 s28, s18, 12
    s_add_u32 m0, s28, 32768
    s_add_u32 s29, s44, 125829120
    buffer_load_dwordx4 v2, s[8:11], s29 offen sc1 lds
    s_lshl_b32 s28, s18, 12
    s_add_u32 m0, s28, 33792
    s_add_u32 s29, s44, 125830144
    buffer_load_dwordx4 v2, s[8:11], s29 offen sc1 lds
    s_lshl_b32 s28, s18, 12
    s_add_u32 m0, s28, 34816
    s_add_u32 s29, s44, 125831168
    buffer_load_dwordx4 v2, s[8:11], s29 offen sc1 lds
    s_lshl_b32 s28, s18, 12
    s_add_u32 m0, s28, 35840
    s_add_u32 s29, s44, 125832192
    buffer_load_dwordx4 v2, s[8:11], s29 offen sc1 lds
    ds_read_b64_tr_b16 a[136:137], v47 offset:16384
    ds_read_b64_tr_b16 a[138:139], v47 offset:16640
    ds_read_b64_tr_b16 a[140:141], v47 offset:24576
    ds_read_b64_tr_b16 a[142:143], v47 offset:24832
    ds_read_b64_tr_b16 a[200:201], v47 offset:16416
    ds_read_b64_tr_b16 a[202:203], v47 offset:16672
    ds_read_b64_tr_b16 a[204:205], v47 offset:24608
    ds_read_b64_tr_b16 a[206:207], v47 offset:24864
    s_waitcnt lgkmcnt(0)
    s_waitcnt vmcnt(24)
    s_barrier
    s_lshl_b32 s28, s18, 12
    s_add_u32 m0, s28, 49152
    s_add_u32 s29, s44, 125845504
    buffer_load_dwordx4 v2, s[8:11], s29 offen sc1 lds
    s_lshl_b32 s28, s18, 12
    s_add_u32 m0, s28, 50176
    s_add_u32 s29, s44, 125846528
    buffer_load_dwordx4 v2, s[8:11], s29 offen sc1 lds
    s_lshl_b32 s28, s18, 12
    s_add_u32 m0, s28, 51200
    s_add_u32 s29, s44, 125847552
    buffer_load_dwordx4 v2, s[8:11], s29 offen sc1 lds
    s_lshl_b32 s28, s18, 12
    s_add_u32 m0, s28, 52224
    s_add_u32 s29, s44, 125848576
    buffer_load_dwordx4 v2, s[8:11], s29 offen sc1 lds
    ds_read_b64_tr_b16 a[144:145], v47 offset:32768
    ds_read_b64_tr_b16 a[146:147], v47 offset:33024
    ds_read_b64_tr_b16 a[148:149], v47 offset:40960
    ds_read_b64_tr_b16 a[150:151], v47 offset:41216
    ds_read_b64_tr_b16 a[208:209], v47 offset:32800
    ds_read_b64_tr_b16 a[210:211], v47 offset:33056
    ds_read_b64_tr_b16 a[212:213], v47 offset:40992
    ds_read_b64_tr_b16 a[214:215], v47 offset:41248
    s_waitcnt lgkmcnt(0)
    s_waitcnt vmcnt(24)
    s_barrier
    s_lshl_b32 s28, s18, 12
    s_add_u32 m0, s28, 65536
    s_add_u32 s29, s44, 125861888
    buffer_load_dwordx4 v2, s[8:11], s29 offen sc1 lds
    s_lshl_b32 s28, s18, 12
    s_add_u32 m0, s28, 66560
    s_add_u32 s29, s44, 125862912
    buffer_load_dwordx4 v2, s[8:11], s29 offen sc1 lds
    s_lshl_b32 s28, s18, 12
    s_add_u32 m0, s28, 67584
    s_add_u32 s29, s44, 125863936
    buffer_load_dwordx4 v2, s[8:11], s29 offen sc1 lds
    s_lshl_b32 s28, s18, 12
    s_add_u32 m0, s28, 68608
    s_add_u32 s29, s44, 125864960
    buffer_load_dwordx4 v2, s[8:11], s29 offen sc1 lds
    ds_read_b64_tr_b16 a[152:153], v47 offset:49152
    ds_read_b64_tr_b16 a[154:155], v47 offset:49408
    ds_read_b64_tr_b16 a[156:157], v47 offset:57344
    ds_read_b64_tr_b16 a[158:159], v47 offset:57600
    ds_read_b64_tr_b16 a[216:217], v47 offset:49184
    ds_read_b64_tr_b16 a[218:219], v47 offset:49440
    ds_read_b64_tr_b16 a[220:221], v47 offset:57376
    ds_read_b64_tr_b16 a[222:223], v47 offset:57632
    s_waitcnt lgkmcnt(0)
    s_waitcnt vmcnt(24)
    s_barrier
    s_lshl_b32 s28, s18, 12
    s_add_u32 m0, s28, 81920
    s_add_u32 s29, s44, 125878272
    buffer_load_dwordx4 v2, s[8:11], s29 offen sc1 lds
    s_lshl_b32 s28, s18, 12
    s_add_u32 m0, s28, 82944
    s_add_u32 s29, s44, 125879296
    buffer_load_dwordx4 v2, s[8:11], s29 offen sc1 lds
    s_lshl_b32 s28, s18, 12
    s_add_u32 m0, s28, 83968
    s_add_u32 s29, s44, 125880320
    buffer_load_dwordx4 v2, s[8:11], s29 offen sc1 lds
    s_lshl_b32 s28, s18, 12
    s_add_u32 m0, s28, 84992
    s_add_u32 s29, s44, 125881344
    buffer_load_dwordx4 v2, s[8:11], s29 offen sc1 lds
    ds_read_b64_tr_b16 a[160:161], v48 offset:0
    ds_read_b64_tr_b16 a[162:163], v48 offset:256
    ds_read_b64_tr_b16 a[164:165], v48 offset:8192
    ds_read_b64_tr_b16 a[166:167], v48 offset:8448
    ds_read_b64_tr_b16 a[224:225], v48 offset:32
    ds_read_b64_tr_b16 a[226:227], v48 offset:288
    ds_read_b64_tr_b16 a[228:229], v48 offset:8224
    ds_read_b64_tr_b16 a[230:231], v48 offset:8480
    s_waitcnt lgkmcnt(0)
    s_waitcnt vmcnt(24)
    s_barrier
    s_lshl_b32 s28, s18, 12
    s_add_u32 m0, s28, 98304
    s_add_u32 s29, s44, 125894656
    buffer_load_dwordx4 v2, s[8:11], s29 offen sc1 lds
    s_lshl_b32 s28, s18, 12
    s_add_u32 m0, s28, 99328
    s_add_u32 s29, s44, 125895680
    buffer_load_dwordx4 v2, s[8:11], s29 offen sc1 lds
    s_lshl_b32 s28, s18, 12
    s_add_u32 m0, s28, 100352
    s_add_u32 s29, s44, 125896704
    buffer_load_dwordx4 v2, s[8:11], s29 offen sc1 lds
    s_lshl_b32 s28, s18, 12
    s_add_u32 m0, s28, 101376
    s_add_u32 s29, s44, 125897728
    buffer_load_dwordx4 v2, s[8:11], s29 offen sc1 lds
    ds_read_b64_tr_b16 a[168:169], v48 offset:16384
    ds_read_b64_tr_b16 a[170:171], v48 offset:16640
    ds_read_b64_tr_b16 a[172:173], v48 offset:24576
    ds_read_b64_tr_b16 a[174:175], v48 offset:24832
    ds_read_b64_tr_b16 a[232:233], v48 offset:16416
    ds_read_b64_tr_b16 a[234:235], v48 offset:16672
    ds_read_b64_tr_b16 a[236:237], v48 offset:24608
    ds_read_b64_tr_b16 a[238:239], v48 offset:24864
    s_waitcnt lgkmcnt(0)
    s_waitcnt vmcnt(24)
    s_barrier
    s_lshl_b32 s28, s18, 12
    s_add_u32 m0, s28, 114688
    s_add_u32 s29, s44, 125911040
    buffer_load_dwordx4 v2, s[8:11], s29 offen sc1 lds
    s_lshl_b32 s28, s18, 12
    s_add_u32 m0, s28, 115712
    s_add_u32 s29, s44, 125912064
    buffer_load_dwordx4 v2, s[8:11], s29 offen sc1 lds
    s_lshl_b32 s28, s18, 12
    s_add_u32 m0, s28, 116736
    s_add_u32 s29, s44, 125913088
    buffer_load_dwordx4 v2, s[8:11], s29 offen sc1 lds
    s_lshl_b32 s28, s18, 12
    s_add_u32 m0, s28, 117760
    s_add_u32 s29, s44, 125914112
    buffer_load_dwordx4 v2, s[8:11], s29 offen sc1 lds
    ds_read_b64_tr_b16 a[176:177], v48 offset:32768
    ds_read_b64_tr_b16 a[178:179], v48 offset:33024
    ds_read_b64_tr_b16 a[180:181], v48 offset:40960
    ds_read_b64_tr_b16 a[182:183], v48 offset:41216
    ds_read_b64_tr_b16 a[240:241], v48 offset:32800
    ds_read_b64_tr_b16 a[242:243], v48 offset:33056
    ds_read_b64_tr_b16 a[244:245], v48 offset:40992
    ds_read_b64_tr_b16 a[246:247], v48 offset:41248
    s_waitcnt lgkmcnt(0)
    s_waitcnt vmcnt(24)
    s_barrier
    s_lshl_b32 s28, s18, 12
    s_add_u32 m0, s28, 131072
    s_add_u32 s29, s44, 125927424
    buffer_load_dwordx4 v2, s[8:11], s29 offen sc1 lds
    s_lshl_b32 s28, s18, 12
    s_add_u32 m0, s28, 132096
    s_add_u32 s29, s44, 125928448
    buffer_load_dwordx4 v2, s[8:11], s29 offen sc1 lds
    s_lshl_b32 s28, s18, 12
    s_add_u32 m0, s28, 133120
    s_add_u32 s29, s44, 125929472
    buffer_load_dwordx4 v2, s[8:11], s29 offen sc1 lds
    s_lshl_b32 s28, s18, 12
    s_add_u32 m0, s28, 134144
    s_add_u32 s29, s44, 125930496
    buffer_load_dwordx4 v2, s[8:11], s29 offen sc1 lds
    ds_read_b64_tr_b16 a[184:185], v48 offset:49152
    ds_read_b64_tr_b16 a[186:187], v48 offset:49408
    ds_read_b64_tr_b16 a[188:189], v48 offset:57344
    ds_read_b64_tr_b16 a[190:191], v48 offset:57600
    ds_read_b64_tr_b16 a[248:249], v48 offset:49184
    ds_read_b64_tr_b16 a[250:251], v48 offset:49440
    ds_read_b64_tr_b16 a[252:253], v48 offset:57376
    ds_read_b64_tr_b16 a[254:255], v48 offset:57632
    s_waitcnt lgkmcnt(0)
    s_waitcnt vmcnt(24)
    s_barrier
    s_lshl_b32 s28, s18, 12
    s_add_u32 m0, s28, 147456
    s_add_u32 s29, s44, 125943808
    buffer_load_dwordx4 v2, s[8:11], s29 offen sc1 lds
    s_lshl_b32 s28, s18, 12
    s_add_u32 m0, s28, 148480
    s_add_u32 s29, s44, 125944832
    buffer_load_dwordx4 v2, s[8:11], s29 offen sc1 lds
    s_lshl_b32 s28, s18, 12
    s_add_u32 m0, s28, 149504
    s_add_u32 s29, s44, 125945856
    buffer_load_dwordx4 v2, s[8:11], s29 offen sc1 lds
    s_lshl_b32 s28, s18, 12
    s_add_u32 m0, s28, 150528
    s_add_u32 s29, s44, 125946880
    buffer_load_dwordx4 v2, s[8:11], s29 offen sc1 lds
    ds_read_b64_tr_b16 v[56:57], v47 offset:0
    ds_read_b64_tr_b16 v[58:59], v47 offset:256
    ds_read_b64_tr_b16 v[60:61], v47 offset:8192
    ds_read_b64_tr_b16 v[62:63], v47 offset:8448
    ds_read_b64_tr_b16 v[64:65], v47 offset:32
    ds_read_b64_tr_b16 v[66:67], v47 offset:288
    ds_read_b64_tr_b16 v[68:69], v47 offset:8224
    ds_read_b64_tr_b16 v[70:71], v47 offset:8480
    s_waitcnt lgkmcnt(0)
    s_waitcnt vmcnt(24)
    s_barrier
    ds_read_b64_tr_b16 v[72:73], v47 offset:16384
    ds_read_b64_tr_b16 v[74:75], v47 offset:16640
    ds_read_b64_tr_b16 v[76:77], v47 offset:24576
    ds_read_b64_tr_b16 v[78:79], v47 offset:24832
    ds_read_b64_tr_b16 v[80:81], v47 offset:16416
    ds_read_b64_tr_b16 v[82:83], v47 offset:16672
    ds_read_b64_tr_b16 v[84:85], v47 offset:24608
    ds_read_b64_tr_b16 v[86:87], v47 offset:24864
    ds_write_b128 v7, v[56:59] offset:0
    ds_write_b128 v7, v[60:63] offset:1024
    ds_write_b128 v7, v[64:67] offset:2048
    ds_write_b128 v7, v[68:71] offset:3072
    s_waitcnt lgkmcnt(0)
    s_waitcnt vmcnt(20)
    s_barrier
    ds_read_b64_tr_b16 v[56:57], v47 offset:32768
    ds_read_b64_tr_b16 v[58:59], v47 offset:33024
    ds_read_b64_tr_b16 v[60:61], v47 offset:40960
    ds_read_b64_tr_b16 v[62:63], v47 offset:41216
    ds_read_b64_tr_b16 v[64:65], v47 offset:32800
    ds_read_b64_tr_b16 v[66:67], v47 offset:33056
    ds_read_b64_tr_b16 v[68:69], v47 offset:40992
    ds_read_b64_tr_b16 v[70:71], v47 offset:41248
    ds_write_b128 v7, v[72:75] offset:16384
    ds_write_b128 v7, v[76:79] offset:17408
    ds_write_b128 v7, v[80:83] offset:18432
    ds_write_b128 v7, v[84:87] offset:19456
    s_waitcnt lgkmcnt(0)
    s_waitcnt vmcnt(16)
    s_barrier
    v_mov_b32 v40, 192
    global_load_dwordx2 v[42:43], v40, s[4:5] sc1
    s_lshl_b32 s40, s17, 2
    s_add_u32 s29, s40, 589824
    buffer_load_dword v44, off, s[8:11], s29 sc1
    s_add_u32 s29, s40, 589952
    buffer_load_dword v45, off, s[8:11], s29 sc1
    s_add_u32 s40, s40, 590080
    buffer_load_dword v51, off, s[8:11], s40 sc1
    s_mov_b32 s41, 1
    ds_read_b64_tr_b16 v[72:73], v47 offset:49152
    ds_read_b64_tr_b16 v[74:75], v47 offset:49408
    ds_read_b64_tr_b16 v[76:77], v47 offset:57344
    ds_read_b64_tr_b16 v[78:79], v47 offset:57600
    ds_read_b64_tr_b16 v[80:81], v47 offset:49184
    ds_read_b64_tr_b16 v[82:83], v47 offset:49440
    ds_read_b64_tr_b16 v[84:85], v47 offset:57376
    ds_read_b64_tr_b16 v[86:87], v47 offset:57632
    ds_write_b128 v7, v[56:59] offset:32768
    ds_write_b128 v7, v[60:63] offset:33792
    ds_write_b128 v7, v[64:67] offset:34816
    ds_write_b128 v7, v[68:71] offset:35840
    s_waitcnt lgkmcnt(0)
    s_waitcnt vmcnt(12)
    s_barrier
    ds_read_b64_tr_b16 v[56:57], v48 offset:0
    ds_read_b64_tr_b16 v[58:59], v48 offset:256
    ds_read_b64_tr_b16 v[60:61], v48 offset:8192
    ds_read_b64_tr_b16 v[62:63], v48 offset:8448
    ds_read_b64_tr_b16 v[64:65], v48 offset:32
    ds_read_b64_tr_b16 v[66:67], v48 offset:288
    ds_read_b64_tr_b16 v[68:69], v48 offset:8224
    ds_read_b64_tr_b16 v[70:71], v48 offset:8480
    ds_write_b128 v7, v[72:75] offset:49152
    ds_write_b128 v7, v[76:79] offset:50176
    ds_write_b128 v7, v[80:83] offset:51200
    ds_write_b128 v7, v[84:87] offset:52224
    s_waitcnt lgkmcnt(0)
    s_waitcnt vmcnt(8)
    s_barrier
    ds_read_b64_tr_b16 v[72:73], v48 offset:16384
    ds_read_b64_tr_b16 v[74:75], v48 offset:16640
    ds_read_b64_tr_b16 v[76:77], v48 offset:24576
    ds_read_b64_tr_b16 v[78:79], v48 offset:24832
    ds_read_b64_tr_b16 v[80:81], v48 offset:16416
    ds_read_b64_tr_b16 v[82:83], v48 offset:16672
    ds_read_b64_tr_b16 v[84:85], v48 offset:24608
    ds_read_b64_tr_b16 v[86:87], v48 offset:24864
    ds_write_b128 v8, v[56:59] offset:0
    ds_write_b128 v8, v[60:63] offset:1024
    ds_write_b128 v8, v[64:67] offset:2048
    ds_write_b128 v8, v[68:71] offset:3072
    s_waitcnt lgkmcnt(0)
    s_waitcnt vmcnt(4)
    s_barrier
    ds_read_b64_tr_b16 v[56:57], v48 offset:32768
    ds_read_b64_tr_b16 v[58:59], v48 offset:33024
    ds_read_b64_tr_b16 v[60:61], v48 offset:40960
    ds_read_b64_tr_b16 v[62:63], v48 offset:41216
    ds_read_b64_tr_b16 v[64:65], v48 offset:32800
    ds_read_b64_tr_b16 v[66:67], v48 offset:33056
    ds_read_b64_tr_b16 v[68:69], v48 offset:40992
    ds_read_b64_tr_b16 v[70:71], v48 offset:41248
    ds_write_b128 v8, v[72:75] offset:16384
    ds_write_b128 v8, v[76:79] offset:17408
    ds_write_b128 v8, v[80:83] offset:18432
    ds_write_b128 v8, v[84:87] offset:19456
    s_waitcnt lgkmcnt(0)
    s_waitcnt vmcnt(0)
    s_barrier
    ds_read_b64_tr_b16 v[72:73], v48 offset:49152
    ds_read_b64_tr_b16 v[74:75], v48 offset:49408
    ds_read_b64_tr_b16 v[76:77], v48 offset:57344
    ds_read_b64_tr_b16 v[78:79], v48 offset:57600
    ds_read_b64_tr_b16 v[80:81], v48 offset:49184
    ds_read_b64_tr_b16 v[82:83], v48 offset:49440
    ds_read_b64_tr_b16 v[84:85], v48 offset:57376
    ds_read_b64_tr_b16 v[86:87], v48 offset:57632
    ds_write_b128 v8, v[56:59] offset:32768
    ds_write_b128 v8, v[60:63] offset:33792
    ds_write_b128 v8, v[64:67] offset:34816
    ds_write_b128 v8, v[68:71] offset:35840
    s_waitcnt lgkmcnt(0)
    s_barrier
    ds_write_b128 v8, v[72:75] offset:49152
    ds_write_b128 v8, v[76:79] offset:50176
    ds_write_b128 v8, v[80:83] offset:51200
    ds_write_b128 v8, v[84:87] offset:52224
    s_waitcnt lgkmcnt(0)
    s_barrier
    v_mov_b32 v40, 200
    v_mov_b32 v41, 1
    v_cmp_eq_u32 vcc, 0, v0
    s_and_saveexec_b64 s[6:7], vcc
    global_atomic_add v40, v41, s[4:5]
    s_mov_b64 exec, s[6:7]
    v_readfirstlane_b32 s28, v42
    v_readfirstlane_b32 s29, v43
    v_readfirstlane_b32 s44, v44
    s_cmp_ge_u32 s28, 32
    s_cselect_b32 s28, s41, 0
    s_min_u32 s28, s28, s44
    v_readfirstlane_b32 s44, v45
    s_min_u32 s28, s28, s44
    v_mov_b32 v0, v51
    s_mov_b32 s41, 1
    s_cmp_ge_u32 s28, 1
    s_cbranch_scc1 L_fast0
    v_mov_b32 v40, 192
L_initw:
    global_load_dwordx2 v[42:43], v40, s[4:5] sc1
    s_waitcnt vmcnt(0)
    v_readfirstlane_b32 s28, v42
    v_readfirstlane_b32 s29, v43
    s_cmp_ge_u32 s28, 32
    s_cselect_b32 s28, 1, 0
    s_and_b32 s28, s28, s29
    s_cmp_lg_u32 s28, 0
    s_cbranch_scc1 L_initd
    s_add_u32 s37, s37, 1
    s_cmp_lt_u32 s37, 1000000
    s_cbranch_scc1 L_initw
    s_endpgm
L_initd:

    s_lshl_b32 s29, s17, 2
    s_add_u32 s29, s29, 589824
L_kv0_0:
    buffer_load_dword v42, off, s[8:11], s29 sc1
    s_waitcnt vmcnt(0)
    v_readfirstlane_b32 s28, v42
    s_cmp_ge_u32 s28, 1
    s_cbranch_scc1 L_kv0d_0
    s_sleep 2
    s_add_u32 s37, s37, 1
    s_cmp_lt_u32 s37, 1000000
    s_cbranch_scc1 L_kv0_0
    s_endpgm
L_kv0d_0:
    s_lshl_b32 s29, s17, 2
    s_add_u32 s29, s29, 589952
L_kv0_1:
    buffer_load_dword v42, off, s[8:11], s29 sc1
    s_waitcnt vmcnt(0)
    v_readfirstlane_b32 s28, v42
    s_cmp_ge_u32 s28, 1
    s_cbranch_scc1 L_kv0d_1
    s_sleep 2
    s_add_u32 s37, s37, 1
    s_cmp_lt_u32 s37, 1000000
    s_cbranch_scc1 L_kv0_1
    s_endpgm
L_kv0d_1:
    buffer_load_dword v0, off, s[8:11], s40 sc1
L_fast0:
    s_lshl_b32 s29, s17, 13
    s_lshl_b32 s28, s18, 11
    s_add_u32 s29, s29, s28
    s_add_u32 s29, s29, 16777216
    s_mov_b32 m0, s45
    s_nop 0
    buffer_load_dwordx4 v2, s[8:11], s29 offen sc1 lds
    buffer_load_dwordx4 v2, s[8:11], s29 offen offset:1024 sc1 lds
    s_waitcnt vmcnt(0)

    s_mov_b32 s16, 0
    s_mov_b32 s20, 1048576
    s_mov_b32 s21, 1052672
    s_mov_b32 s42, 1056896
    s_mov_b32 s43, 1060992
    s_mov_b32 s22, 1318912
    s_mov_b32 s23, 532480
    s_mov_b32 s24, 536576
    s_mov_b32 s25, 548864
    s_lshl_b32 s29, s17, 11
    s_lshl_b32 s44, s18, 9
    s_add_u32 s29, s29, s44
    s_add_u32 s38, s29, 83886080
    s_add_u32 s39, s29, 88080384
    s_add_u32 s28, s17, 32
    s_lshl_b32 s28, s28, 13
    s_lshl_b32 s44, s18, 11
    s_add_u32 s28, s28, s44
    s_add_u32 s26, s28, 16777216
    s_add_u32 s27, s28, 33554432
    s_add_u32 s28, s17, 64
    s_lshl_b32 s28, s28, 13
    s_add_u32 s34, s28, s35
    s_lshl_b32 s28, s17, 7
    s_add_u32 s7, s28, 593920
    s_cmp_ge_u32 s18, 2
    s_cselect_b64 s[46:47], -1, 0
    s_mov_b32 s19, s23
    s_cmp_eq_u32 s18, 0
    s_cselect_b32 s70, 1, 0
    s_mov_b32 s71, 0
    s_sub_u32 s27, s27, 262144
    s_lshl_b32 s73, s17, 2
    s_add_u32 s73, s73, 590208
    s_mov_b32 s72, 1
    s_mov_b32 s74, 0
    s_mov_b32 s12, 0x11111111
    s_mov_b32 s13, 0x11111111
    v_mov_b64 v[64:65], 0
    v_mov_b64 v[66:67], 0
    v_mov_b64 v[68:69], 0
    v_mov_b64 v[70:71], 0
    v_mov_b64 v[72:73], 0
    v_mov_b64 v[74:75], 0
    v_mov_b64 v[76:77], 0
    v_mov_b64 v[78:79], 0
    v_mov_b64 v[80:81], 0
    v_mov_b64 v[82:83], 0
    v_mov_b64 v[84:85], 0
    v_mov_b64 v[86:87], 0
    ds_read_b128 v[88:91], v7 offset:0
    ds_read_b128 v[92:95], v7 offset:1024
    ds_read_b128 v[96:99], v7 offset:2048
    ds_read_b128 v[100:103], v7 offset:3072
    ds_read_b128 v[104:107], v7 offset:16384
    ds_read_b128 v[108:111], v7 offset:17408
    ds_read_b128 v[112:115], v7 offset:18432
    ds_read_b128 v[116:119], v7 offset:19456
    ds_read_b128 v[120:123], v7 offset:32768
    ds_read_b128 v[124:127], v7 offset:33792
    ds_read_b128 v[48:51], v12 offset:0
    ds_read_b128 v[52:55], v12 offset:4096
L_step_m:
    s_waitcnt lgkmcnt(0)
    s_barrier
    ds_read_b128 v[32:35], v6 offset:0
    ds_read_b128 v[36:39], v6 offset:1024
    ds_read_b128 v[40:43], v6 offset:2048
    ds_read_b128 v[44:47], v6 offset:3072
    ds_read_b32 v60, v3 offset:18560
    ds_read_b32 v61, v3 offset:18832
    s_mov_b32 s23, s19
    s_add_u32 s24, s19, 4096
    v_readfirstlane_b32 s28, v0
    s_cmp_lt_u32 s28, s41
    s_cbranch_scc1 L_kvw_m
L_kvok_m:
    s_mov_b32 s40, s73
    s_mov_b32 s41, s72
    s_waitcnt lgkmcnt(5)
    v_smfmac_f32_16x16x64_bf16 v[64:67], v[32:35], v[88:95], v1
    ds_read_b128 v[88:91], v7 offset:34816
    v_smfmac_f32_16x16x64_bf16 v[68:71], v[32:35], v[96:103], v1
    ds_read_b128 v[92:95], v7 offset:35840
    v_smfmac_f32_16x16x64_bf16 v[72:75], v[32:35], a[0:7], v1
    ds_read_b128 v[96:99], v7 offset:49152
    s_waitcnt vmcnt(0)
    buffer_load_dwordx2 v[16:17], v13, s[8:11], s27 offen offset:0 sc1
    v_smfmac_f32_16x16x64_bf16 v[76:79], v[32:35], a[64:71], v1
    ds_read_b128 v[100:103], v7 offset:50176
    s_waitcnt lgkmcnt(8)
    v_smfmac_f32_16x16x64_bf16 v[64:67], v[36:39], v[104:111], v1
    ds_read_b128 v[104:107], v7 offset:51200
    ds_read_b128 v[48:51], v6 offset:4096
    v_smfmac_f32_16x16x64_bf16 v[68:71], v[36:39], v[112:119], v1
    ds_read_b128 v[108:111], v7 offset:52224
    ds_read_b128 v[52:55], v6 offset:5120
    v_smfmac_f32_16x16x64_bf16 v[72:75], v[36:39], a[8:15], v1
    ds_read_b128 v[112:115], v8 offset:0
    buffer_load_dwordx2 v[20:21], v13, s[8:11], s27 offen offset:512 sc1
    v_smfmac_f32_16x16x64_bf16 v[76:79], v[36:39], a[72:79], v1
    ds_read_b128 v[116:119], v8 offset:1024
    s_waitcnt lgkmcnt(8)
    v_smfmac_f32_16x16x64_bf16 v[64:67], v[40:43], v[120:127], v1
    ds_read_b128 v[120:123], v8 offset:2048
    v_smfmac_f32_16x16x64_bf16 v[68:71], v[40:43], v[88:95], v1
    ds_read_b128 v[124:127], v8 offset:3072
    v_smfmac_f32_16x16x64_bf16 v[72:75], v[40:43], a[16:23], v1
    ds_read_b128 v[88:91], v8 offset:16384
    ds_read_b128 v[56:59], v6 offset:6144
    buffer_load_dwordx2 v[24:25], v13, s[8:11], s27 offen offset:1024 sc1
    v_smfmac_f32_16x16x64_bf16 v[76:79], v[40:43], a[80:87], v1
    ds_read_b128 v[92:95], v8 offset:17408
    s_waitcnt lgkmcnt(8)
    v_smfmac_f32_16x16x64_bf16 v[64:67], v[44:47], v[96:103], v1
    ds_read_b128 v[96:99], v8 offset:18432
    v_smfmac_f32_16x16x64_bf16 v[68:71], v[44:47], v[104:111], v1
    ds_read_b128 v[100:103], v8 offset:19456
    v_smfmac_f32_16x16x64_bf16 v[72:75], v[44:47], a[24:31], v1
    ds_read_b128 v[104:107], v8 offset:32768
    buffer_load_dwordx2 v[28:29], v13, s[8:11], s27 offen offset:1536 sc1
    v_smfmac_f32_16x16x64_bf16 v[76:79], v[44:47], a[88:95], v1
    ds_read_b128 v[108:111], v8 offset:33792
    s_waitcnt lgkmcnt(7)
    v_smfmac_f32_16x16x64_bf16 v[64:67], v[48:51], v[112:119], v1
    ds_read_b128 v[112:115], v8 offset:34816
    v_smfmac_f32_16x16x64_bf16 v[68:71], v[48:51], v[120:127], v1
    ds_read_b128 v[116:119], v8 offset:35840
    v_lshrrev_b32 v0, 2, v2
    buffer_store_dword v18, v0, s[8:11], s39 offen sc1
    v_smfmac_f32_16x16x64_bf16 v[72:75], v[48:51], a[32:39], v1
    ds_read_b128 v[120:123], v8 offset:49152
    buffer_store_dword v26, v0, s[8:11], s39 offen offset:256 sc1
    v_smfmac_f32_16x16x64_bf16 v[76:79], v[48:51], a[96:103], v1
    ds_read_b128 v[124:127], v8 offset:50176
    s_waitcnt lgkmcnt(6)
    v_smfmac_f32_16x16x64_bf16 v[64:67], v[52:55], v[88:95], v1
    ds_read_b128 v[88:91], v8 offset:51200
    buffer_store_dword v60, v14, s[8:11], s38 offen sc1
    v_smfmac_f32_16x16x64_bf16 v[68:71], v[52:55], v[96:103], v1
    ds_read_b128 v[92:95], v8 offset:52224
    buffer_store_dword v61, v14, s[8:11], s38 offen offset:64 sc1
    ds_read_b128 v[60:63], v6 offset:7168
    v_smfmac_f32_16x16x64_bf16 v[72:75], v[52:55], a[40:47], v1
    ds_read_b128 v[96:99], v2 offset:8192
    v_mov_b32 v0, s74
    s_mov_b64 exec, s[70:71]
    buffer_store_dword v0, off, s[8:11], s7 sc1
    s_mov_b64 exec, -1
    v_smfmac_f32_16x16x64_bf16 v[76:79], v[52:55], a[104:111], v1
    ds_read_b128 v[100:103], v2 offset:9216
    v_lshlrev_b32 v0, 2, v2
    buffer_load_dword v0, v0, s[8:11], s34 offen
    s_waitcnt lgkmcnt(7)
    v_smfmac_f32_16x16x64_bf16 v[64:67], v[56:59], v[104:111], v1
    ds_read_b128 v[104:107], v2 offset:10240
    v_smfmac_f32_16x16x64_bf16 v[68:71], v[56:59], v[112:119], v1
    ds_read_b128 v[108:111], v2 offset:11264
    v_smfmac_f32_16x16x64_bf16 v[72:75], v[56:59], a[48:55], v1
    ds_read_b128 v[112:115], v2 offset:12288
    buffer_load_dword v0, off, s[8:11], s40 sc1
    v_smfmac_f32_16x16x64_bf16 v[76:79], v[56:59], a[112:119], v1
    ds_read_b128 v[116:119], v2 offset:13312
    s_waitcnt lgkmcnt(6)
    v_smfmac_f32_16x16x64_bf16 v[64:67], v[60:63], v[120:127], v1
    ds_read_b128 v[120:123], v2 offset:14336
    v_smfmac_f32_16x16x64_bf16 v[68:71], v[60:63], v[88:95], v1
    ds_read_b128 v[124:127], v2 offset:15360
    v_smfmac_f32_16x16x64_bf16 v[72:75], v[60:63], a[56:63], v1
    v_smfmac_f32_16x16x64_bf16 v[76:79], v[60:63], a[120:127], v1
    v_smfmac_f32_16x16x64_bf16 v[80:83], v[32:35], a[128:135], v1
    v_smfmac_f32_16x16x64_bf16 v[84:87], v[32:35], a[192:199], v1
    v_add_f32 v64, v64, v65
    v_add_f32 v66, v66, v67
    v_add_f32 v68, v68, v69
    v_add_f32 v70, v70, v71
    v_cvt_pk_bf16_f32 v64, v64, v68
    v_cvt_pk_bf16_f32 v66, v66, v70
    v_add_f32 v72, v72, v73
    ds_write_b32 v3, v64 offset:16384
    v_add_f32 v74, v74, v75
    ds_write_b32 v3, v66 offset:16656
    v_add_f32 v76, v76, v77
    v_add_f32 v78, v78, v79
    v_cvt_pk_bf16_f32 v72, v72, v76
    v_cvt_pk_bf16_f32 v74, v74, v78
    ds_write_b32 v3, v72 offset:18560
    ds_write_b32 v3, v74 offset:18832
    v_smfmac_f32_16x16x64_bf16 v[80:83], v[36:39], a[136:143], v1
    v_mad_u32_u24 v65, v2, 3, v10
    s_mov_b32 exec_hi, 0
    buffer_store_dword v15, v65, s[8:11], s22 offen
    s_mov_b32 exec_hi, -1
    v_smfmac_f32_16x16x64_bf16 v[84:87], v[36:39], a[200:207], v1
    v_smfmac_f32_16x16x64_bf16 v[80:83], v[40:43], a[144:151], v1
    s_mov_b64 exec, s[32:33]
    buffer_store_dword v15, v11, s[8:11], s25 offen
    s_mov_b64 exec, -1
    s_waitcnt lgkmcnt(0)
    s_barrier
    ds_read_b128 v[64:67], v4 offset:16384
    v_smfmac_f32_16x16x64_bf16 v[84:87], v[40:43], a[208:215], v1
    ds_read_b128 v[68:71], v4 offset:16448
    v_smfmac_f32_16x16x64_bf16 v[80:83], v[44:47], a[152:159], v1
    ds_read_b128 v[72:75], v4 offset:16512
    v_smfmac_f32_16x16x64_bf16 v[84:87], v[44:47], a[216:223], v1
    ds_read_b128 v[76:79], v4 offset:16576
    v_smfmac_f32_16x16x64_bf16 v[80:83], v[48:51], a[160:167], v1
    ds_read_b128 v[32:35], v5 offset:18560
    v_smfmac_f32_16x16x64_bf16 v[84:87], v[48:51], a[224:231], v1
    ds_read_b128 v[36:39], v5 offset:18624
    v_smfmac_f32_16x16x64_bf16 v[80:83], v[52:55], a[168:175], v1
    ds_read_b128 v[40:43], v5 offset:18688
    v_smfmac_f32_16x16x64_bf16 v[84:87], v[52:55], a[232:239], v1
    ds_read_b128 v[44:47], v5 offset:18752
    v_smfmac_f32_16x16x64_bf16 v[80:83], v[56:59], a[176:183], v1
    v_smfmac_f32_16x16x64_bf16 v[84:87], v[56:59], a[240:247], v1
    v_smfmac_f32_16x16x64_bf16 v[80:83], v[60:63], a[184:191], v1
    v_smfmac_f32_16x16x64_bf16 v[84:87], v[60:63], a[248:255], v1
    s_waitcnt lgkmcnt(7)
    v_mfma_f32_16x16x32_bf16 v[48:51], v[96:99], v[64:67], 0
    ds_read_b128 v[88:91], v2 offset:24960
    v_mfma_f32_16x16x32_bf16 v[52:55], v[112:115], v[64:67], 0
    s_waitcnt lgkmcnt(7)
    v_mfma_f32_16x16x32_bf16 v[48:51], v[100:103], v[68:71], v[48:51]
    v_mov_b64 v[92:93], 0
    v_mov_b64 v[94:95], 0
    v_mfma_f32_16x16x32_bf16 v[52:55], v[116:119], v[68:71], v[52:55]
    v_mov_b64 v[96:97], 0
    v_mov_b64 v[98:99], 0
    s_waitcnt lgkmcnt(6)
    v_mfma_f32_16x16x32_bf16 v[48:51], v[104:107], v[72:75], v[48:51]
    v_add_f32 v80, v80, v81
    v_add_f32 v82, v82, v83
    v_mfma_f32_16x16x32_bf16 v[52:55], v[120:123], v[72:75], v[52:55]
    v_add_f32 v84, v84, v85
    v_add_f32 v86, v86, v87
    s_waitcnt lgkmcnt(5)
    v_mfma_f32_16x16x32_bf16 v[48:51], v[108:111], v[76:79], v[48:51]
    v_cvt_pk_bf16_f32 v18, v80, v82
    v_mfma_f32_16x16x32_bf16 v[52:55], v[124:127], v[76:79], v[52:55]
    v_cvt_pk_bf16_f32 v26, v84, v86
    s_waitcnt lgkmcnt(4)
    v_mfma_f32_16x16x32_bf16 v[56:59], v[32:35], v[64:67], 0
    s_waitcnt lgkmcnt(3)
    v_mfma_f32_16x16x32_bf16 v[56:59], v[36:39], v[68:71], v[56:59]
    v_cndmask_b32 v60, v48, v52, s[30:31]
    v_cndmask_b32 v61, v49, v53, s[30:31]
    s_waitcnt lgkmcnt(2)
    v_mfma_f32_16x16x32_bf16 v[56:59], v[40:43], v[72:75], v[56:59]
    v_cndmask_b32 v62, v50, v54, s[30:31]
    v_cndmask_b32 v63, v51, v55, s[30:31]
    s_waitcnt lgkmcnt(1)
    v_mfma_f32_16x16x32_bf16 v[56:59], v[44:47], v[76:79], v[56:59]
    s_nop 0
    v_max3_f32 v80, v60, v61, v62
    s_cmp_eq_u32 s16, 63
    s_cbranch_scc1 L_done_m
    v_max_f32 v80, v80, v63
    v_mov_b64 v[104:105], 0
    v_mov_b64 v[106:107], 0
    v_mov_b64 v[108:109], 0
    v_max3_f32 v81, v56, v57, v58
    v_max3_f32 v80, v80, v81, v59
    v_mov_b64 v[110:111], 0
    v_mov_b64 v[112:113], 0
    v_max_f32_dpp v80, v80, v80 quad_perm:[1,0,3,2] row_mask:0xf bank_mask:0xf
    v_mov_b32 v81, v80
    v_mov_b64 v[114:115], 0
    v_mov_b64 v[116:117], 0
    v_permlane16_swap_b32 v80, v81
    v_max_f32 v80, v80, v81
    v_mov_b32 v81, v80
    v_mov_b64 v[118:119], 0
    s_nop 0
    v_permlane32_swap_b32 v80, v81
    v_max_f32 v80, v80, v81
    v_mul_f32 v80, s36, v80
    v_fma_f32 v64, v60, s36, -v80
    v_fma_f32 v65, v61, s36, -v80
    v_fma_f32 v66, v56, s36, -v80
    v_fma_f32 v67, v57, s36, -v80
    v_fma_f32 v68, v62, s36, -v80
    v_fma_f32 v69, v63, s36, -v80
    v_fma_f32 v70, v58, s36, -v80
    v_fma_f32 v71, v59, s36, -v80
    v_exp_f32 v64, v64
    v_exp_f32 v65, v65
    v_exp_f32 v66, v66
    v_exp_f32 v67, v67
    v_exp_f32 v68, v68
    v_exp_f32 v69, v69
    v_exp_f32 v70, v70
    v_exp_f32 v71, v71
    v_cvt_pk_bf16_f32 v48, v64, v65
    v_cvt_pk_bf16_f32 v49, v66, v67
    v_cvt_pk_bf16_f32 v50, v68, v69
    v_cvt_pk_bf16_f32 v51, v70, v71
    s_waitcnt lgkmcnt(0)
    s_waitcnt vmcnt(9)
    s_nop 0
    v_mfma_f32_16x16x32_bf16 v[100:103], v[48:51], v[88:91], 0
    v_smfmac_f32_16x16x64_bf16 v[92:95], v[48:51], v[16:23], v1
    v_smfmac_f32_16x16x64_bf16 v[96:99], v[48:51], v[24:31], v1
    s_nop 0
    v_add_f32 v100, v100, v101
    v_add_f32 v102, v102, v103
    v_rcp_f32 v100, v100
    v_rcp_f32 v102, v102
    s_nop 0
    v_add_f32 v92, v92, v93
    v_add_f32 v94, v94, v95
    v_add_f32 v96, v96, v97
    v_add_f32 v98, v98, v99
    v_mul_f32 v92, v92, v100
    v_mul_f32 v96, v96, v100
    v_mul_f32 v94, v94, v102
    v_mul_f32 v98, v98, v102
    v_cvt_pk_bf16_f32 v92, v92, v96
    v_cvt_pk_bf16_f32 v94, v94, v98
    ds_write_b32 v3, v92 offset:20736
    ds_write_b32 v3, v94 offset:21008
    s_waitcnt lgkmcnt(0)
    s_barrier
    ds_read_b128 v[64:67], v4 offset:20736
    ds_read_b128 v[68:71], v4 offset:20800
    ds_read_b128 v[72:75], v4 offset:20864
    ds_read_b128 v[76:79], v4 offset:20928
    ds_read_b128 v[32:35], v2 offset:23936
    s_waitcnt lgkmcnt(4)
    v_smfmac_f32_16x16x64_bf16 v[104:107], v[64:67], v[128:135], v1
    s_waitcnt lgkmcnt(3)
    v_smfmac_f32_16x16x64_bf16 v[104:107], v[68:71], v[136:143], v1
    s_mov_b32 m0, s45
    s_waitcnt lgkmcnt(2)
    v_smfmac_f32_16x16x64_bf16 v[104:107], v[72:75], v[144:151], v1
    s_waitcnt lgkmcnt(1)
    v_smfmac_f32_16x16x64_bf16 v[104:107], v[76:79], v[152:159], v1
    v_smfmac_f32_16x16x64_bf16 v[108:111], v[64:67], v[160:167], v1
    v_smfmac_f32_16x16x64_bf16 v[108:111], v[68:71], v[168:175], v1
    v_cvt_pk_bf16_f32 v104, v104, v105
    v_smfmac_f32_16x16x64_bf16 v[108:111], v[72:75], v[176:183], v1
    v_cvt_pk_bf16_f32 v106, v106, v107
    v_smfmac_f32_16x16x64_bf16 v[108:111], v[76:79], v[184:191], v1
    buffer_store_dword v104, v9, s[8:11], s20 offen offset:0
    v_smfmac_f32_16x16x64_bf16 v[112:115], v[64:67], v[192:199], v1
    buffer_store_dword v106, v9, s[8:11], s42 offen offset:0
    v_smfmac_f32_16x16x64_bf16 v[112:115], v[68:71], v[200:207], v1
    v_cvt_pk_bf16_f32 v108, v108, v109
    v_smfmac_f32_16x16x64_bf16 v[112:115], v[72:75], v[208:215], v1
    v_cvt_pk_bf16_f32 v110, v110, v111
    v_smfmac_f32_16x16x64_bf16 v[112:115], v[76:79], v[216:223], v1
    buffer_store_dword v108, v9, s[8:11], s20 offen offset:2048
    v_smfmac_f32_16x16x64_bf16 v[116:119], v[64:67], v[224:231], v1
    buffer_store_dword v110, v9, s[8:11], s42 offen offset:2048
    v_smfmac_f32_16x16x64_bf16 v[116:119], v[68:71], v[232:239], v1
    v_cvt_pk_bf16_f32 v112, v112, v113
    v_smfmac_f32_16x16x64_bf16 v[116:119], v[72:75], v[240:247], v1
    v_cvt_pk_bf16_f32 v114, v114, v115
    v_smfmac_f32_16x16x64_bf16 v[116:119], v[76:79], v[248:255], v1
    buffer_store_dword v112, v9, s[8:11], s21 offen offset:0
    buffer_store_dword v114, v9, s[8:11], s43 offen offset:0
    s_nop 5
    v_cvt_pk_bf16_f32 v116, v116, v117
    v_cvt_pk_bf16_f32 v118, v118, v119
    buffer_store_dword v116, v9, s[8:11], s21 offen offset:2048
    buffer_store_dword v118, v9, s[8:11], s43 offen offset:2048
    s_waitcnt lgkmcnt(0)
    s_cmp_eq_u32 s18, 3
    s_cbranch_scc1 L_m_t3
    s_cmp_eq_u32 s18, 2
    s_cbranch_scc1 L_m_t2
    s_cmp_eq_u32 s18, 1
    s_cbranch_scc1 L_m_t1
    s_nop 7
    s_branch L_m_td
L_m_t1:
    s_nop 15
    s_nop 3
    s_branch L_m_td
L_m_t2:
    s_nop 15
    s_nop 15
    s_branch L_m_td
L_m_t3:
    s_nop 15
    s_nop 15
    s_nop 11
L_m_td:
    buffer_load_dwordx4 v[40:43], v10, s[8:11], s20 offen sc1
    buffer_load_dwordx4 v[44:47], v10, s[8:11], s20 offen offset:1024 sc1
    s_nop 15
    s_nop 8
    buffer_load_dwordx4 v[40:43], v10, s[8:11], s20 offen sc1
    buffer_load_dwordx4 v[44:47], v10, s[8:11], s20 offen offset:1024 sc1
    s_waitcnt vmcnt(2)
    v_max_u32 v56, v40, v44
    v_cmp_eq_u32 vcc, -1, v56
    s_and_b64 vcc, vcc, s[12:13]
    s_cbranch_vccz L_m_p1_ok
    s_waitcnt vmcnt(0)
L_m_p1_chk:
    v_max_u32 v56, v40, v44
    v_cmp_eq_u32 vcc, -1, v56
    s_and_b64 vcc, vcc, s[12:13]
    s_cbranch_vccnz L_m_p1_retry
L_m_p1_ok:
    v_mfma_f32_16x16x32_bf16 v[36:39], v[32:35], v[40:43], 0
    v_mfma_f32_16x16x32_bf16 v[36:39], v[32:35], v[44:47], v[36:39]
    s_nop 7
    v_add_f32_dpp v36, v36, v36 row_ror:8 row_mask:0xf bank_mask:0xf
    v_add_f32_dpp v37, v37, v37 row_ror:8 row_mask:0xf bank_mask:0xf
    s_nop 0
    v_add_f32_dpp v36, v36, v36 row_ror:4 row_mask:0xf bank_mask:0xf
    v_add_f32_dpp v37, v37, v37 row_ror:4 row_mask:0xf bank_mask:0xf
    v_cvt_pk_bf16_f32 v36, v36, v37
    s_mov_b64 exec, s[32:33]
    buffer_store_dword v36, v11, s[8:11], s23 offen
    s_mov_b64 exec, -1
    buffer_load_dwordx4 v2, s[8:11], s26 offen sc1 lds
    buffer_load_dwordx4 v2, s[8:11], s26 offen offset:1024 sc1 lds
    s_add_u32 s26, s26, 262144
    s_nop 15
    s_nop 15
    s_nop 2
    buffer_load_dwordx4 v[48:51], v12, s[8:11], s23 offen sc1
    buffer_load_dwordx4 v[52:55], v12, s[8:11], s24 offen sc1
    ds_read_b128 v[88:91], v7 offset:0
    ds_read_b128 v[92:95], v7 offset:1024
    ds_read_b128 v[96:99], v7 offset:2048
    ds_read_b128 v[100:103], v7 offset:3072
    ds_read_b128 v[104:107], v7 offset:16384
    ds_read_b128 v[108:111], v7 offset:17408
    ds_read_b128 v[112:115], v7 offset:18432
    ds_read_b128 v[116:119], v7 offset:19456
    ds_read_b128 v[120:123], v7 offset:32768
    ds_read_b128 v[124:127], v7 offset:33792
    s_mov_b32 s28, s20
    s_mov_b32 s20, s22
    s_mov_b32 s22, s28
    s_add_u32 s21, s20, 4096
    s_add_u32 s42, s20, 8320
    s_add_u32 s43, s20, 12416
    s_add_u32 s25, s25, 8192
    s_and_b32 s25, s25, 0x87fff
    s_add_u32 s38, s38, 65536
    s_add_u32 s39, s39, 65536
    s_add_u32 s27, s27, 262144
    s_add_u32 s28, s34, 262144
    s_cmp_lt_u32 s16, 61
    s_cselect_b32 s34, s28, s34
    s_mov_b32 s74, s16
    s_add_u32 s16, s16, 1
    s_add_u32 s19, s23, 8192
    s_and_b32 s19, s19, 0x87fff
    s_add_u32 s29, s16, 3
    s_min_u32 s29, s29, 63
    s_lshr_b32 s72, s29, 2
    s_add_u32 s72, s72, 1
    s_and_b32 s29, s29, 3
    s_lshl_b32 s29, s29, 5
    s_add_u32 s29, s29, s17
    s_lshl_b32 s29, s29, 2
    s_add_u32 s73, s29, 589824
    v_mov_b64 v[64:65], 0
    v_mov_b64 v[66:67], 0
    v_mov_b64 v[68:69], 0
    v_mov_b64 v[70:71], 0
    v_mov_b64 v[72:73], 0
    v_mov_b64 v[74:75], 0
    v_mov_b64 v[76:77], 0
    v_mov_b64 v[78:79], 0
    v_mov_b64 v[80:81], 0
    v_mov_b64 v[82:83], 0
    v_mov_b64 v[84:85], 0
    v_mov_b64 v[86:87], 0
    buffer_load_dwordx4 v[48:51], v12, s[8:11], s23 offen sc1
    buffer_load_dwordx4 v[52:55], v12, s[8:11], s24 offen sc1
    s_waitcnt vmcnt(2)
    v_max_u32 v56, v48, v52
    v_cmp_eq_u32 vcc, -1, v56
    s_cbranch_vccz L_m_m2e_ok
    s_waitcnt vmcnt(0)
L_m_m2e_chk:
    v_max_u32 v56, v48, v52
    v_cmp_eq_u32 vcc, -1, v56
    s_cbranch_vccnz L_m_m2e_retry
L_m_m2e_ok:
    ds_write_b128 v12, v[48:51] offset:0
    ds_write_b128 v12, v[52:55] offset:4096
    s_branch L_step_m
L_kvw_m:
    buffer_load_dword v0, off, s[8:11], s40 sc1
    s_waitcnt vmcnt(0)
    v_readfirstlane_b32 s28, v0
    s_cmp_ge_u32 s28, s41
    s_cbranch_scc1 L_kvok_m
    s_sleep 2
    s_add_u32 s37, s37, 1
    s_cmp_lt_u32 s37, 1000000
    s_cbranch_scc1 L_kvw_m
    s_branch L_abort_m
L_m_p1_retry:
    s_lshl_b64 s[14:15], vcc, 1
    s_or_b64 vcc, vcc, s[14:15]
    s_lshl_b64 s[14:15], vcc, 2
    s_or_b64 vcc, vcc, s[14:15]
    s_mov_b64 exec, vcc
    buffer_load_dwordx4 v[40:43], v10, s[8:11], s20 offen sc1
    buffer_load_dwordx4 v[44:47], v10, s[8:11], s20 offen offset:1024 sc1
    s_add_u32 s37, s37, 1
    s_cmp_lt_u32 s37, 1000000
    s_cbranch_scc0 L_abort_m
    s_waitcnt vmcnt(0)
    s_mov_b64 exec, -1
    s_branch L_m_p1_chk
L_m_m2e_retry:
    s_mov_b64 exec, vcc
    buffer_load_dwordx4 v[48:51], v12, s[8:11], s23 offen sc1
    buffer_load_dwordx4 v[52:55], v12, s[8:11], s24 offen sc1
    s_add_u32 s37, s37, 1
    s_cmp_lt_u32 s37, 1000000
    s_cbranch_scc0 L_abort_m
    s_waitcnt vmcnt(0)
    s_mov_b64 exec, -1
    s_branch L_m_m2e_chk
L_abort_m:
    s_mov_b64 exec, -1
    s_endpgm
L_done_m:
    ds_read_b32 v60, v3 offset:18560
    ds_read_b32 v61, v3 offset:18832
    v_lshrrev_b32 v62, 2, v2
    s_add_u32 s38, s38, 65536
    s_add_u32 s39, s39, 65536
    buffer_store_dword v18, v62, s[8:11], s39 offen sc1
    buffer_store_dword v26, v62, s[8:11], s39 offen offset:256 sc1
    s_waitcnt lgkmcnt(0)
    buffer_store_dword v60, v14, s[8:11], s38 offen sc1
    buffer_store_dword v61, v14, s[8:11], s38 offen offset:64 sc1
    s_waitcnt vmcnt(0)
    s_barrier
    s_cmp_lg_u32 s18, 0
    s_cbranch_scc1 L_nopub2_m
    v_mov_b32 v62, 64
    s_mov_b64 exec, 1
    buffer_store_dword v62, off, s[8:11], s7 sc1
    s_mov_b64 exec, -1
L_nopub2_m:
    s_waitcnt vmcnt(0)
    s_endpgm
L_bulk:
    s_sub_u32 s25, s3, 1
    s_lshl_b32 s25, s25, 5
    s_add_u32 s60, s25, s17
    s_mov_b32 s24, s18
    s_mov_b32 s35, 0
    s_cmp_ge_u32 s60, 224
    s_cbranch_scc1 L_exit

    s_lshl_b32 s64, s60, 2
    s_add_u32 s64, s64, s24
    v_and_b32 v44, 63, v0
    v_lshlrev_b32 v45, 4, v44
    v_lshrrev_b32 v46, 4, v44
    v_lshlrev_b32 v46, 17, v46
    v_and_b32 v47, 15, v44
    v_lshlrev_b32 v47, 4, v47
    v_add_u32 v46, v46, v47
    s_load_dwordx2 s[12:13], s[0:1], 24
    s_mov_b32 s14, 0x400000
    s_mov_b32 s15, 0x20000
    s_lshl_b32 s65, s64, 10
    s_waitcnt lgkmcnt(0)
    buffer_load_dwordx4 v[64:67], v45, s[12:15], s65 offen
    s_add_u32 s65, s65, 917504
    buffer_load_dwordx4 v[68:71], v45, s[12:15], s65 offen
    s_add_u32 s65, s65, 917504
    buffer_load_dwordx4 v[72:75], v45, s[12:15], s65 offen
    s_add_u32 s65, s65, 917504
    buffer_load_dwordx4 v[76:79], v45, s[12:15], s65 offen
    s_add_u32 s65, s65, 917504
    buffer_load_dwordx4 v[80:83], v45, s[12:15], s65 offen
    s_load_dwordx2 s[12:13], s[0:1], 32
    s_mov_b32 s14, 0x400000
    s_mov_b32 s15, 0x20000
    s_lshl_b32 s65, s64, 10
    s_waitcnt lgkmcnt(0)
    buffer_load_dwordx4 v[84:87], v45, s[12:15], s65 offen
    s_add_u32 s65, s65, 917504
    buffer_load_dwordx4 v[88:91], v45, s[12:15], s65 offen
    s_add_u32 s65, s65, 917504
    buffer_load_dwordx4 v[92:95], v45, s[12:15], s65 offen
    s_add_u32 s65, s65, 917504
    buffer_load_dwordx4 v[96:99], v45, s[12:15], s65 offen
    s_add_u32 s65, s65, 917504
    buffer_load_dwordx4 v[100:103], v45, s[12:15], s65 offen
    s_load_dwordx2 s[12:13], s[0:1], 16
    s_mov_b32 s14, 0x400000
    s_mov_b32 s15, 0x20000
    s_lshl_b32 s65, s64, 10
    s_waitcnt lgkmcnt(0)
    buffer_load_dwordx4 v[104:107], v45, s[12:15], s65 offen
    s_add_u32 s65, s65, 917504
    buffer_load_dwordx4 v[108:111], v45, s[12:15], s65 offen
    s_add_u32 s65, s65, 917504
    buffer_load_dwordx4 v[112:115], v45, s[12:15], s65 offen
    s_add_u32 s65, s65, 917504
    buffer_load_dwordx4 v[116:119], v45, s[12:15], s65 offen
    s_add_u32 s65, s65, 917504
    buffer_load_dwordx4 v[120:123], v45, s[12:15], s65 offen
    v_mov_b32 v40, 196
L_bfw:
    global_load_dword v42, v40, s[4:5] sc1
    s_waitcnt vmcnt(0)
    v_readfirstlane_b32 s25, v42
    s_cmp_ge_u32 s25, 1
    s_cbranch_scc1 L_bfd
    s_add_u32 s35, s35, 1
    s_cmp_lt_u32 s35, 1000000
    s_cbranch_scc1 L_bfw
    s_endpgm

L_bfd:
    s_add_u32 s65, s64, 0
    s_and_b32 s66, s65, 7
    s_lshl_b32 s66, s66, 19
    s_lshr_b32 s65, s65, 3
    s_lshl_b32 s65, s65, 8
    s_add_u32 s65, s65, s66
    s_add_u32 s65, s65, 117440512
    buffer_store_dwordx4 v[64:67], v46, s[8:11], s65 offen sc1
    s_add_u32 s65, s64, 896
    s_and_b32 s66, s65, 7
    s_lshl_b32 s66, s66, 19
    s_lshr_b32 s65, s65, 3
    s_lshl_b32 s65, s65, 8
    s_add_u32 s65, s65, s66
    s_add_u32 s65, s65, 117440512
    buffer_store_dwordx4 v[68:71], v46, s[8:11], s65 offen sc1
    s_add_u32 s65, s64, 1792
    s_and_b32 s66, s65, 7
    s_lshl_b32 s66, s66, 19
    s_lshr_b32 s65, s65, 3
    s_lshl_b32 s65, s65, 8
    s_add_u32 s65, s65, s66
    s_add_u32 s65, s65, 117440512
    buffer_store_dwordx4 v[72:75], v46, s[8:11], s65 offen sc1
    s_add_u32 s65, s64, 2688
    s_and_b32 s66, s65, 7
    s_lshl_b32 s66, s66, 19
    s_lshr_b32 s65, s65, 3
    s_lshl_b32 s65, s65, 8
    s_add_u32 s65, s65, s66
    s_add_u32 s65, s65, 117440512
    buffer_store_dwordx4 v[76:79], v46, s[8:11], s65 offen sc1
    s_add_u32 s65, s64, 3584
    s_cmp_ge_u32 s65, 4096
    s_cbranch_scc1 L_rl_4
    s_and_b32 s66, s65, 7
    s_lshl_b32 s66, s66, 19
    s_lshr_b32 s65, s65, 3
    s_lshl_b32 s65, s65, 8
    s_add_u32 s65, s65, s66
    s_add_u32 s65, s65, 117440512
    buffer_store_dwordx4 v[80:83], v46, s[8:11], s65 offen sc1
L_rl_4:
    s_add_u32 s65, s64, 0
    s_and_b32 s66, s65, 7
    s_lshl_b32 s66, s66, 19
    s_lshr_b32 s65, s65, 3
    s_lshl_b32 s65, s65, 8
    s_add_u32 s65, s65, s66
    s_add_u32 s65, s65, 121634816
    buffer_store_dwordx4 v[84:87], v46, s[8:11], s65 offen sc1
    s_add_u32 s65, s64, 896
    s_and_b32 s66, s65, 7
    s_lshl_b32 s66, s66, 19
    s_lshr_b32 s65, s65, 3
    s_lshl_b32 s65, s65, 8
    s_add_u32 s65, s65, s66
    s_add_u32 s65, s65, 121634816
    buffer_store_dwordx4 v[88:91], v46, s[8:11], s65 offen sc1
    s_add_u32 s65, s64, 1792
    s_and_b32 s66, s65, 7
    s_lshl_b32 s66, s66, 19
    s_lshr_b32 s65, s65, 3
    s_lshl_b32 s65, s65, 8
    s_add_u32 s65, s65, s66
    s_add_u32 s65, s65, 121634816
    buffer_store_dwordx4 v[92:95], v46, s[8:11], s65 offen sc1
    s_add_u32 s65, s64, 2688
    s_and_b32 s66, s65, 7
    s_lshl_b32 s66, s66, 19
    s_lshr_b32 s65, s65, 3
    s_lshl_b32 s65, s65, 8
    s_add_u32 s65, s65, s66
    s_add_u32 s65, s65, 121634816
    buffer_store_dwordx4 v[96:99], v46, s[8:11], s65 offen sc1
    s_add_u32 s65, s64, 3584
    s_cmp_ge_u32 s65, 4096
    s_cbranch_scc1 L_rl_9
    s_and_b32 s66, s65, 7
    s_lshl_b32 s66, s66, 19
    s_lshr_b32 s65, s65, 3
    s_lshl_b32 s65, s65, 8
    s_add_u32 s65, s65, s66
    s_add_u32 s65, s65, 121634816
    buffer_store_dwordx4 v[100:103], v46, s[8:11], s65 offen sc1
L_rl_9:
    s_add_u32 s65, s64, 0
    s_and_b32 s66, s65, 7
    s_lshl_b32 s66, s66, 19
    s_lshr_b32 s65, s65, 3
    s_lshl_b32 s65, s65, 8
    s_add_u32 s65, s65, s66
    s_add_u32 s65, s65, 125829120
    buffer_store_dwordx4 v[104:107], v46, s[8:11], s65 offen sc1
    s_add_u32 s65, s64, 896
    s_and_b32 s66, s65, 7
    s_lshl_b32 s66, s66, 19
    s_lshr_b32 s65, s65, 3
    s_lshl_b32 s65, s65, 8
    s_add_u32 s65, s65, s66
    s_add_u32 s65, s65, 125829120
    buffer_store_dwordx4 v[108:111], v46, s[8:11], s65 offen sc1
    s_add_u32 s65, s64, 1792
    s_and_b32 s66, s65, 7
    s_lshl_b32 s66, s66, 19
    s_lshr_b32 s65, s65, 3
    s_lshl_b32 s65, s65, 8
    s_add_u32 s65, s65, s66
    s_add_u32 s65, s65, 125829120
    buffer_store_dwordx4 v[112:115], v46, s[8:11], s65 offen sc1
    s_add_u32 s65, s64, 2688
    s_and_b32 s66, s65, 7
    s_lshl_b32 s66, s66, 19
    s_lshr_b32 s65, s65, 3
    s_lshl_b32 s65, s65, 8
    s_add_u32 s65, s65, s66
    s_add_u32 s65, s65, 125829120
    buffer_store_dwordx4 v[116:119], v46, s[8:11], s65 offen sc1
    s_add_u32 s65, s64, 3584
    s_cmp_ge_u32 s65, 4096
    s_cbranch_scc1 L_rl_14
    s_and_b32 s66, s65, 7
    s_lshl_b32 s66, s66, 19
    s_lshr_b32 s65, s65, 3
    s_lshl_b32 s65, s65, 8
    s_add_u32 s65, s65, s66
    s_add_u32 s65, s65, 125829120
    buffer_store_dwordx4 v[120:123], v46, s[8:11], s65 offen sc1
L_rl_14:
    s_waitcnt vmcnt(0)
    s_barrier
    s_sub_u32 s65, s3, 1
    s_lshl_b32 s65, s65, 7
    s_add_u32 s65, s65, 602112
    s_cmp_lg_u32 s24, 0
    s_cbranch_scc1 L_rl_np
    v_mov_b32 v40, 1
    s_mov_b64 exec, 1
    buffer_atomic_add v40, off, s[8:11], s65 sc1
    s_mov_b64 exec, -1
L_rl_np:
    s_and_b32 s29, s60, 3
    s_cmp_lt_u32 s60, 128
    s_cbranch_scc1 L_p_kv
    v_mov_b32 v40, 200
L_cww:
    global_load_dword v42, v40, s[4:5] sc1
    s_waitcnt vmcnt(0)
    v_readfirstlane_b32 s25, v42
    s_cmp_ge_u32 s25, 0
    s_cbranch_scc1 L_cwd
    s_sleep 8
    s_add_u32 s35, s35, 1
    s_cmp_lt_u32 s35, 1000000
    s_cbranch_scc1 L_cww
    s_endpgm
L_cwd:
    s_cmp_ge_u32 s60, 208
    s_cbranch_scc1 L_spare
    v_mov_b32 v40, 204
L_dqw:
    global_load_dword v42, v40, s[4:5] sc1
    s_waitcnt vmcnt(0)
    v_readfirstlane_b32 s25, v42
    s_cmp_ge_u32 s25, 0
    s_cbranch_scc1 L_dqd
    s_sleep 16
    s_add_u32 s35, s35, 1
    s_cmp_lt_u32 s35, 1000000
    s_cbranch_scc1 L_dqw
    s_endpgm
L_dqd:
    s_cmp_ge_u32 s60, 208
    s_cbranch_scc1 L_spare
    s_cmp_lt_u32 s60, 192
    s_cbranch_scc1 L_p_q
    s_sub_u32 s30, s60, 192
    s_lshr_b32 s30, s30, 2

    v_and_b32 v1, 63, v0
    v_and_b32 v2, 31, v1
    v_lshrrev_b32 v3, 5, v1
    v_lshlrev_b32 v4, 4, v1
    s_lshl_b32 s25, s30, 2
    s_add_u32 s25, s25, s24
    s_lshl_b32 s25, s25, 15
    v_lshlrev_b32 v5, 10, v2
    v_lshlrev_b32 v6, 4, v3
    v_add3_u32 v5, v5, v6, s25
    s_load_dwordx2 s[16:17], s[0:1], 80
    s_mov_b32 s18, 524288
    s_mov_b32 s19, 0x20000
    s_waitcnt lgkmcnt(0)
    buffer_load_dwordx4 a[0:3], v5, s[16:19], 0 offen offset:0
    buffer_load_dwordx4 a[4:7], v5, s[16:19], 0 offen offset:32
    buffer_load_dwordx4 a[8:11], v5, s[16:19], 0 offen offset:64
    buffer_load_dwordx4 a[12:15], v5, s[16:19], 0 offen offset:96
    buffer_load_dwordx4 a[16:19], v5, s[16:19], 0 offen offset:128
    buffer_load_dwordx4 a[20:23], v5, s[16:19], 0 offen offset:160
    buffer_load_dwordx4 a[24:27], v5, s[16:19], 0 offen offset:192
    buffer_load_dwordx4 a[28:31], v5, s[16:19], 0 offen offset:224
    buffer_load_dwordx4 a[32:35], v5, s[16:19], 0 offen offset:256
    buffer_load_dwordx4 a[36:39], v5, s[16:19], 0 offen offset:288
    buffer_load_dwordx4 a[40:43], v5, s[16:19], 0 offen offset:320
    buffer_load_dwordx4 a[44:47], v5, s[16:19], 0 offen offset:352
    buffer_load_dwordx4 a[48:51], v5, s[16:19], 0 offen offset:384
    buffer_load_dwordx4 a[52:55], v5, s[16:19], 0 offen offset:416
    buffer_load_dwordx4 a[56:59], v5, s[16:19], 0 offen offset:448
    buffer_load_dwordx4 a[60:63], v5, s[16:19], 0 offen offset:480
    buffer_load_dwordx4 a[64:67], v5, s[16:19], 0 offen offset:512
    buffer_load_dwordx4 a[68:71], v5, s[16:19], 0 offen offset:544
    buffer_load_dwordx4 a[72:75], v5, s[16:19], 0 offen offset:576
    buffer_load_dwordx4 a[76:79], v5, s[16:19], 0 offen offset:608
    buffer_load_dwordx4 a[80:83], v5, s[16:19], 0 offen offset:640
    buffer_load_dwordx4 a[84:87], v5, s[16:19], 0 offen offset:672
    buffer_load_dwordx4 a[88:91], v5, s[16:19], 0 offen offset:704
    buffer_load_dwordx4 a[92:95], v5, s[16:19], 0 offen offset:736
    buffer_load_dwordx4 a[96:99], v5, s[16:19], 0 offen offset:768
    buffer_load_dwordx4 a[100:103], v5, s[16:19], 0 offen offset:800
    buffer_load_dwordx4 a[104:107], v5, s[16:19], 0 offen offset:832
    buffer_load_dwordx4 a[108:111], v5, s[16:19], 0 offen offset:864
    buffer_load_dwordx4 a[112:115], v5, s[16:19], 0 offen offset:896
    buffer_load_dwordx4 a[116:119], v5, s[16:19], 0 offen offset:928
    buffer_load_dwordx4 a[120:123], v5, s[16:19], 0 offen offset:960
    buffer_load_dwordx4 a[124:127], v5, s[16:19], 0 offen offset:992
    s_load_dwordx2 s[16:17], s[0:1], 88
    s_mov_b32 s18, 524288
    s_mov_b32 s19, 0x20000
    s_waitcnt lgkmcnt(0)
    buffer_load_dwordx4 a[128:131], v5, s[16:19], 0 offen offset:0
    buffer_load_dwordx4 a[132:135], v5, s[16:19], 0 offen offset:32
    buffer_load_dwordx4 a[136:139], v5, s[16:19], 0 offen offset:64
    buffer_load_dwordx4 a[140:143], v5, s[16:19], 0 offen offset:96
    buffer_load_dwordx4 a[144:147], v5, s[16:19], 0 offen offset:128
    buffer_load_dwordx4 a[148:151], v5, s[16:19], 0 offen offset:160
    buffer_load_dwordx4 a[152:155], v5, s[16:19], 0 offen offset:192
    buffer_load_dwordx4 a[156:159], v5, s[16:19], 0 offen offset:224
    buffer_load_dwordx4 a[160:163], v5, s[16:19], 0 offen offset:256
    buffer_load_dwordx4 a[164:167], v5, s[16:19], 0 offen offset:288
    buffer_load_dwordx4 a[168:171], v5, s[16:19], 0 offen offset:320
    buffer_load_dwordx4 a[172:175], v5, s[16:19], 0 offen offset:352
    buffer_load_dwordx4 a[176:179], v5, s[16:19], 0 offen offset:384
    buffer_load_dwordx4 a[180:183], v5, s[16:19], 0 offen offset:416
    buffer_load_dwordx4 a[184:187], v5, s[16:19], 0 offen offset:448
    buffer_load_dwordx4 a[188:191], v5, s[16:19], 0 offen offset:480
    buffer_load_dwordx4 a[192:195], v5, s[16:19], 0 offen offset:512
    buffer_load_dwordx4 a[196:199], v5, s[16:19], 0 offen offset:544
    buffer_load_dwordx4 a[200:203], v5, s[16:19], 0 offen offset:576
    buffer_load_dwordx4 a[204:207], v5, s[16:19], 0 offen offset:608
    buffer_load_dwordx4 a[208:211], v5, s[16:19], 0 offen offset:640
    buffer_load_dwordx4 a[212:215], v5, s[16:19], 0 offen offset:672
    buffer_load_dwordx4 a[216:219], v5, s[16:19], 0 offen offset:704
    buffer_load_dwordx4 a[220:223], v5, s[16:19], 0 offen offset:736
    buffer_load_dwordx4 a[224:227], v5, s[16:19], 0 offen offset:768
    buffer_load_dwordx4 a[228:231], v5, s[16:19], 0 offen offset:800
    buffer_load_dwordx4 a[232:235], v5, s[16:19], 0 offen offset:832
    buffer_load_dwordx4 a[236:239], v5, s[16:19], 0 offen offset:864
    buffer_load_dwordx4 a[240:243], v5, s[16:19], 0 offen offset:896
    buffer_load_dwordx4 a[244:247], v5, s[16:19], 0 offen offset:928
    buffer_load_dwordx4 a[248:251], v5, s[16:19], 0 offen offset:960
    buffer_load_dwordx4 a[252:255], v5, s[16:19], 0 offen offset:992
    s_waitcnt vmcnt(0)
    s_barrier
    s_load_dwordx2 s[12:13], s[0:1], 56
    s_mov_b32 s14, 2097152
    s_mov_b32 s15, 0x20000
    s_waitcnt lgkmcnt(0)
    v_bfe_u32 v6, v2, 2, 1
    v_lshlrev_b32 v6, 4, v6
    v_lshrrev_b32 v7, 3, v2
    v_lshlrev_b32 v7, 2, v7
    v_and_b32 v8, 3, v2
    v_add3_u32 v6, v6, v7, v8
    v_mul_u32_u24 v6, 1040, v6
    v_lshlrev_b32 v7, 4, v3
    v_add_u32 v6, v6, v7
    v_lshlrev_b32 v8, 16, v3
    v_lshlrev_b32 v9, 3, v2
    v_add_u32 v8, v8, v9
    s_lshl_b32 s25, s30, 2
    s_add_u32 s25, s25, s24
    s_lshl_b32 s25, s25, 8
    s_add_u32 s32, s25, 100663296
    s_mov_b32 s34, 591104
    s_mov_b32 s31, s29
    s_mov_b32 s33, 0
    s_lshl_b32 s25, s31, 15
    s_lshl_b32 s26, s24, 13
    s_add_u32 s25, s25, s26
    s_mul_i32 s26, s24, 8320
    s_add_u32 s26, s26, 0
    s_add_u32 m0, s26, 0
    s_add_u32 s27, s25, 0
    buffer_load_dwordx4 v4, s[12:15], s27 offen lds
    s_add_u32 m0, s26, 1040
    s_add_u32 s27, s25, 1024
    buffer_load_dwordx4 v4, s[12:15], s27 offen lds
    s_add_u32 m0, s26, 2080
    s_add_u32 s27, s25, 2048
    buffer_load_dwordx4 v4, s[12:15], s27 offen lds
    s_add_u32 m0, s26, 3120
    s_add_u32 s27, s25, 3072
    buffer_load_dwordx4 v4, s[12:15], s27 offen lds
    s_add_u32 m0, s26, 4160
    s_add_u32 s27, s25, 4096
    buffer_load_dwordx4 v4, s[12:15], s27 offen lds
    s_add_u32 m0, s26, 5200
    s_add_u32 s27, s25, 5120
    buffer_load_dwordx4 v4, s[12:15], s27 offen lds
    s_add_u32 m0, s26, 6240
    s_add_u32 s27, s25, 6144
    buffer_load_dwordx4 v4, s[12:15], s27 offen lds
    s_add_u32 m0, s26, 7280
    s_add_u32 s27, s25, 7168
    buffer_load_dwordx4 v4, s[12:15], s27 offen lds
L_pu_U_loop:
    s_cmp_eq_u32 s33, 0
    s_cbranch_scc1 L_pu_U_w0_0
    s_waitcnt vmcnt(16)
    s_branch L_pu_U_w1_0
L_pu_U_w0_0:
    s_waitcnt vmcnt(0)
L_pu_U_w1_0:
    s_barrier
    s_cmp_lt_u32 s33, 2
    s_cbranch_scc1 L_pu_U_pp0_np
    s_sub_u32 s36, s33, 1
    s_cmp_lg_u32 s24, 0
    s_cbranch_scc1 L_pu_U_pp0_np
    s_mov_b64 exec, 1
    v_mov_b32 v120, 0
    v_mov_b32 v121, 1
    buffer_atomic_add v121, v120, s[8:11], s34 offen sc1
    s_mov_b64 exec, -1
L_pu_U_pp0_np:
    s_lshl_b32 s28, s31, 17
    s_add_u32 s28, s28, s32
    s_add_u32 s31, s31, 4
    s_cmp_ge_u32 s31, 64
    s_cbranch_scc1 L_pu_U_nx0
    s_lshl_b32 s25, s31, 15
    s_lshl_b32 s26, s24, 13
    s_add_u32 s25, s25, s26
    s_mul_i32 s26, s24, 8320
    s_add_u32 s26, s26, 33280
    s_add_u32 m0, s26, 0
    s_add_u32 s27, s25, 0
    buffer_load_dwordx4 v4, s[12:15], s27 offen lds
    s_add_u32 m0, s26, 1040
    s_add_u32 s27, s25, 1024
    buffer_load_dwordx4 v4, s[12:15], s27 offen lds
    s_add_u32 m0, s26, 2080
    s_add_u32 s27, s25, 2048
    buffer_load_dwordx4 v4, s[12:15], s27 offen lds
    s_add_u32 m0, s26, 3120
    s_add_u32 s27, s25, 3072
    buffer_load_dwordx4 v4, s[12:15], s27 offen lds
    s_add_u32 m0, s26, 4160
    s_add_u32 s27, s25, 4096
    buffer_load_dwordx4 v4, s[12:15], s27 offen lds
    s_add_u32 m0, s26, 5200
    s_add_u32 s27, s25, 5120
    buffer_load_dwordx4 v4, s[12:15], s27 offen lds
    s_add_u32 m0, s26, 6240
    s_add_u32 s27, s25, 6144
    buffer_load_dwordx4 v4, s[12:15], s27 offen lds
    s_add_u32 m0, s26, 7280
    s_add_u32 s27, s25, 7168
    buffer_load_dwordx4 v4, s[12:15], s27 offen lds
L_pu_U_nx0:
    ds_read_b128 v[64:67], v6 offset:0
    ds_read_b128 v[68:71], v6 offset:32
    ds_read_b128 v[72:75], v6 offset:64
    ds_read_b128 v[76:79], v6 offset:96
    ds_read_b128 v[80:83], v6 offset:128
    ds_read_b128 v[84:87], v6 offset:160
    ds_read_b128 v[88:91], v6 offset:192
    ds_read_b128 v[92:95], v6 offset:224
    s_waitcnt lgkmcnt(7)
    v_mfma_f32_32x32x16_bf16 v[32:47], v[64:67], a[0:3], 0
    v_mfma_f32_32x32x16_bf16 v[48:63], v[64:67], a[128:131], 0
    ds_read_b128 v[64:67], v6 offset:256
    s_waitcnt lgkmcnt(7)
    v_mfma_f32_32x32x16_bf16 v[32:47], v[68:71], a[4:7], v[32:47]
    v_mfma_f32_32x32x16_bf16 v[48:63], v[68:71], a[132:135], v[48:63]
    ds_read_b128 v[68:71], v6 offset:288
    s_waitcnt lgkmcnt(7)
    v_mfma_f32_32x32x16_bf16 v[32:47], v[72:75], a[8:11], v[32:47]
    v_mfma_f32_32x32x16_bf16 v[48:63], v[72:75], a[136:139], v[48:63]
    ds_read_b128 v[72:75], v6 offset:320
    s_waitcnt lgkmcnt(7)
    v_mfma_f32_32x32x16_bf16 v[32:47], v[76:79], a[12:15], v[32:47]
    v_mfma_f32_32x32x16_bf16 v[48:63], v[76:79], a[140:143], v[48:63]
    ds_read_b128 v[76:79], v6 offset:352
    s_waitcnt lgkmcnt(7)
    v_mfma_f32_32x32x16_bf16 v[32:47], v[80:83], a[16:19], v[32:47]
    v_mfma_f32_32x32x16_bf16 v[48:63], v[80:83], a[144:147], v[48:63]
    ds_read_b128 v[80:83], v6 offset:384
    s_waitcnt lgkmcnt(7)
    v_mfma_f32_32x32x16_bf16 v[32:47], v[84:87], a[20:23], v[32:47]
    v_mfma_f32_32x32x16_bf16 v[48:63], v[84:87], a[148:151], v[48:63]
    ds_read_b128 v[84:87], v6 offset:416
    s_waitcnt lgkmcnt(7)
    v_mfma_f32_32x32x16_bf16 v[32:47], v[88:91], a[24:27], v[32:47]
    v_mfma_f32_32x32x16_bf16 v[48:63], v[88:91], a[152:155], v[48:63]
    ds_read_b128 v[88:91], v6 offset:448
    s_waitcnt lgkmcnt(7)
    v_mfma_f32_32x32x16_bf16 v[32:47], v[92:95], a[28:31], v[32:47]
    v_mfma_f32_32x32x16_bf16 v[48:63], v[92:95], a[156:159], v[48:63]
    ds_read_b128 v[92:95], v6 offset:480
    s_waitcnt lgkmcnt(7)
    v_mfma_f32_32x32x16_bf16 v[32:47], v[64:67], a[32:35], v[32:47]
    v_mfma_f32_32x32x16_bf16 v[48:63], v[64:67], a[160:163], v[48:63]
    ds_read_b128 v[64:67], v6 offset:512
    s_waitcnt lgkmcnt(7)
    v_mfma_f32_32x32x16_bf16 v[32:47], v[68:71], a[36:39], v[32:47]
    v_mfma_f32_32x32x16_bf16 v[48:63], v[68:71], a[164:167], v[48:63]
    ds_read_b128 v[68:71], v6 offset:544
    s_waitcnt lgkmcnt(7)
    v_mfma_f32_32x32x16_bf16 v[32:47], v[72:75], a[40:43], v[32:47]
    v_mfma_f32_32x32x16_bf16 v[48:63], v[72:75], a[168:171], v[48:63]
    ds_read_b128 v[72:75], v6 offset:576
    s_waitcnt lgkmcnt(7)
    v_mfma_f32_32x32x16_bf16 v[32:47], v[76:79], a[44:47], v[32:47]
    v_mfma_f32_32x32x16_bf16 v[48:63], v[76:79], a[172:175], v[48:63]
    ds_read_b128 v[76:79], v6 offset:608
    s_waitcnt lgkmcnt(7)
    v_mfma_f32_32x32x16_bf16 v[32:47], v[80:83], a[48:51], v[32:47]
    v_mfma_f32_32x32x16_bf16 v[48:63], v[80:83], a[176:179], v[48:63]
    ds_read_b128 v[80:83], v6 offset:640
    s_waitcnt lgkmcnt(7)
    v_mfma_f32_32x32x16_bf16 v[32:47], v[84:87], a[52:55], v[32:47]
    v_mfma_f32_32x32x16_bf16 v[48:63], v[84:87], a[180:183], v[48:63]
    ds_read_b128 v[84:87], v6 offset:672
    s_waitcnt lgkmcnt(7)
    v_mfma_f32_32x32x16_bf16 v[32:47], v[88:91], a[56:59], v[32:47]
    v_mfma_f32_32x32x16_bf16 v[48:63], v[88:91], a[184:187], v[48:63]
    ds_read_b128 v[88:91], v6 offset:704
    s_waitcnt lgkmcnt(7)
    v_mfma_f32_32x32x16_bf16 v[32:47], v[92:95], a[60:63], v[32:47]
    v_mfma_f32_32x32x16_bf16 v[48:63], v[92:95], a[188:191], v[48:63]
    ds_read_b128 v[92:95], v6 offset:736
    s_waitcnt lgkmcnt(7)
    v_mfma_f32_32x32x16_bf16 v[32:47], v[64:67], a[64:67], v[32:47]
    v_mfma_f32_32x32x16_bf16 v[48:63], v[64:67], a[192:195], v[48:63]
    ds_read_b128 v[64:67], v6 offset:768
    s_waitcnt lgkmcnt(7)
    v_mfma_f32_32x32x16_bf16 v[32:47], v[68:71], a[68:71], v[32:47]
    v_mfma_f32_32x32x16_bf16 v[48:63], v[68:71], a[196:199], v[48:63]
    ds_read_b128 v[68:71], v6 offset:800
    s_waitcnt lgkmcnt(7)
    v_mfma_f32_32x32x16_bf16 v[32:47], v[72:75], a[72:75], v[32:47]
    v_mfma_f32_32x32x16_bf16 v[48:63], v[72:75], a[200:203], v[48:63]
    ds_read_b128 v[72:75], v6 offset:832
    s_waitcnt lgkmcnt(7)
    v_mfma_f32_32x32x16_bf16 v[32:47], v[76:79], a[76:79], v[32:47]
    v_mfma_f32_32x32x16_bf16 v[48:63], v[76:79], a[204:207], v[48:63]
    ds_read_b128 v[76:79], v6 offset:864
    s_waitcnt lgkmcnt(7)
    v_mfma_f32_32x32x16_bf16 v[32:47], v[80:83], a[80:83], v[32:47]
    v_mfma_f32_32x32x16_bf16 v[48:63], v[80:83], a[208:211], v[48:63]
    ds_read_b128 v[80:83], v6 offset:896
    s_waitcnt lgkmcnt(7)
    v_mfma_f32_32x32x16_bf16 v[32:47], v[84:87], a[84:87], v[32:47]
    v_mfma_f32_32x32x16_bf16 v[48:63], v[84:87], a[212:215], v[48:63]
    ds_read_b128 v[84:87], v6 offset:928
    s_waitcnt lgkmcnt(7)
    v_mfma_f32_32x32x16_bf16 v[32:47], v[88:91], a[88:91], v[32:47]
    v_mfma_f32_32x32x16_bf16 v[48:63], v[88:91], a[216:219], v[48:63]
    ds_read_b128 v[88:91], v6 offset:960
    s_waitcnt lgkmcnt(7)
    v_mfma_f32_32x32x16_bf16 v[32:47], v[92:95], a[92:95], v[32:47]
    v_mfma_f32_32x32x16_bf16 v[48:63], v[92:95], a[220:223], v[48:63]
    ds_read_b128 v[92:95], v6 offset:992
    s_waitcnt lgkmcnt(7)
    v_mfma_f32_32x32x16_bf16 v[32:47], v[64:67], a[96:99], v[32:47]
    v_mfma_f32_32x32x16_bf16 v[48:63], v[64:67], a[224:227], v[48:63]
    s_waitcnt lgkmcnt(6)
    v_mfma_f32_32x32x16_bf16 v[32:47], v[68:71], a[100:103], v[32:47]
    v_mfma_f32_32x32x16_bf16 v[48:63], v[68:71], a[228:231], v[48:63]
    s_waitcnt lgkmcnt(5)
    v_mfma_f32_32x32x16_bf16 v[32:47], v[72:75], a[104:107], v[32:47]
    v_mfma_f32_32x32x16_bf16 v[48:63], v[72:75], a[232:235], v[48:63]
    s_waitcnt lgkmcnt(4)
    v_mfma_f32_32x32x16_bf16 v[32:47], v[76:79], a[108:111], v[32:47]
    v_mfma_f32_32x32x16_bf16 v[48:63], v[76:79], a[236:239], v[48:63]
    s_waitcnt lgkmcnt(3)
    v_mfma_f32_32x32x16_bf16 v[32:47], v[80:83], a[112:115], v[32:47]
    v_mfma_f32_32x32x16_bf16 v[48:63], v[80:83], a[240:243], v[48:63]
    s_waitcnt lgkmcnt(2)
    v_mfma_f32_32x32x16_bf16 v[32:47], v[84:87], a[116:119], v[32:47]
    v_mfma_f32_32x32x16_bf16 v[48:63], v[84:87], a[244:247], v[48:63]
    s_waitcnt lgkmcnt(1)
    v_mfma_f32_32x32x16_bf16 v[32:47], v[88:91], a[120:123], v[32:47]
    v_mfma_f32_32x32x16_bf16 v[48:63], v[88:91], a[248:251], v[48:63]
    s_waitcnt lgkmcnt(0)
    v_mfma_f32_32x32x16_bf16 v[32:47], v[92:95], a[124:127], v[32:47]
    v_mfma_f32_32x32x16_bf16 v[48:63], v[92:95], a[252:255], v[48:63]
    s_nop 15
    v_mov_b32 v96, v32
    v_mov_b32 v97, v48
    s_add_u32 s27, s28, 0
    buffer_store_dwordx2 v[96:97], v8, s[8:11], s27 offen sc1
    v_mov_b32 v98, v33
    v_mov_b32 v99, v49
    s_add_u32 s27, s28, 4096
    buffer_store_dwordx2 v[98:99], v8, s[8:11], s27 offen sc1
    v_mov_b32 v100, v34
    v_mov_b32 v101, v50
    s_add_u32 s27, s28, 8192
    buffer_store_dwordx2 v[100:101], v8, s[8:11], s27 offen sc1
    v_mov_b32 v102, v35
    v_mov_b32 v103, v51
    s_add_u32 s27, s28, 12288
    buffer_store_dwordx2 v[102:103], v8, s[8:11], s27 offen sc1
    v_mov_b32 v104, v36
    v_mov_b32 v105, v52
    s_add_u32 s27, s28, 16384
    buffer_store_dwordx2 v[104:105], v8, s[8:11], s27 offen sc1
    v_mov_b32 v106, v37
    v_mov_b32 v107, v53
    s_add_u32 s27, s28, 20480
    buffer_store_dwordx2 v[106:107], v8, s[8:11], s27 offen sc1
    v_mov_b32 v108, v38
    v_mov_b32 v109, v54
    s_add_u32 s27, s28, 24576
    buffer_store_dwordx2 v[108:109], v8, s[8:11], s27 offen sc1
    v_mov_b32 v110, v39
    v_mov_b32 v111, v55
    s_add_u32 s27, s28, 28672
    buffer_store_dwordx2 v[110:111], v8, s[8:11], s27 offen sc1
    v_mov_b32 v96, v40
    v_mov_b32 v97, v56
    s_add_u32 s27, s28, 32768
    buffer_store_dwordx2 v[96:97], v8, s[8:11], s27 offen sc1
    v_mov_b32 v98, v41
    v_mov_b32 v99, v57
    s_add_u32 s27, s28, 36864
    buffer_store_dwordx2 v[98:99], v8, s[8:11], s27 offen sc1
    v_mov_b32 v100, v42
    v_mov_b32 v101, v58
    s_add_u32 s27, s28, 40960
    buffer_store_dwordx2 v[100:101], v8, s[8:11], s27 offen sc1
    v_mov_b32 v102, v43
    v_mov_b32 v103, v59
    s_add_u32 s27, s28, 45056
    buffer_store_dwordx2 v[102:103], v8, s[8:11], s27 offen sc1
    v_mov_b32 v104, v44
    v_mov_b32 v105, v60
    s_add_u32 s27, s28, 49152
    buffer_store_dwordx2 v[104:105], v8, s[8:11], s27 offen sc1
    v_mov_b32 v106, v45
    v_mov_b32 v107, v61
    s_add_u32 s27, s28, 53248
    buffer_store_dwordx2 v[106:107], v8, s[8:11], s27 offen sc1
    v_mov_b32 v108, v46
    v_mov_b32 v109, v62
    s_add_u32 s27, s28, 57344
    buffer_store_dwordx2 v[108:109], v8, s[8:11], s27 offen sc1
    v_mov_b32 v110, v47
    v_mov_b32 v111, v63
    s_add_u32 s27, s28, 61440
    buffer_store_dwordx2 v[110:111], v8, s[8:11], s27 offen sc1
    s_add_u32 s33, s33, 1
    s_cmp_ge_u32 s33, 16
    s_cbranch_scc1 L_pu_U_fin
    s_cmp_eq_u32 s33, 0
    s_cbranch_scc1 L_pu_U_w0_1
    s_waitcnt vmcnt(16)
    s_branch L_pu_U_w1_1
L_pu_U_w0_1:
    s_waitcnt vmcnt(0)
L_pu_U_w1_1:
    s_barrier
    s_cmp_lt_u32 s33, 2
    s_cbranch_scc1 L_pu_U_pp1_np
    s_sub_u32 s36, s33, 1
    s_cmp_lg_u32 s24, 0
    s_cbranch_scc1 L_pu_U_pp1_np
    s_mov_b64 exec, 1
    v_mov_b32 v120, 0
    v_mov_b32 v121, 1
    buffer_atomic_add v121, v120, s[8:11], s34 offen sc1
    s_mov_b64 exec, -1
L_pu_U_pp1_np:
    s_lshl_b32 s28, s31, 17
    s_add_u32 s28, s28, s32
    s_add_u32 s31, s31, 4
    s_cmp_ge_u32 s31, 64
    s_cbranch_scc1 L_pu_U_nx1
    s_lshl_b32 s25, s31, 15
    s_lshl_b32 s26, s24, 13
    s_add_u32 s25, s25, s26
    s_mul_i32 s26, s24, 8320
    s_add_u32 s26, s26, 0
    s_add_u32 m0, s26, 0
    s_add_u32 s27, s25, 0
    buffer_load_dwordx4 v4, s[12:15], s27 offen lds
    s_add_u32 m0, s26, 1040
    s_add_u32 s27, s25, 1024
    buffer_load_dwordx4 v4, s[12:15], s27 offen lds
    s_add_u32 m0, s26, 2080
    s_add_u32 s27, s25, 2048
    buffer_load_dwordx4 v4, s[12:15], s27 offen lds
    s_add_u32 m0, s26, 3120
    s_add_u32 s27, s25, 3072
    buffer_load_dwordx4 v4, s[12:15], s27 offen lds
    s_add_u32 m0, s26, 4160
    s_add_u32 s27, s25, 4096
    buffer_load_dwordx4 v4, s[12:15], s27 offen lds
    s_add_u32 m0, s26, 5200
    s_add_u32 s27, s25, 5120
    buffer_load_dwordx4 v4, s[12:15], s27 offen lds
    s_add_u32 m0, s26, 6240
    s_add_u32 s27, s25, 6144
    buffer_load_dwordx4 v4, s[12:15], s27 offen lds
    s_add_u32 m0, s26, 7280
    s_add_u32 s27, s25, 7168
    buffer_load_dwordx4 v4, s[12:15], s27 offen lds
L_pu_U_nx1:
    ds_read_b128 v[64:67], v6 offset:33280
    ds_read_b128 v[68:71], v6 offset:33312
    ds_read_b128 v[72:75], v6 offset:33344
    ds_read_b128 v[76:79], v6 offset:33376
    ds_read_b128 v[80:83], v6 offset:33408
    ds_read_b128 v[84:87], v6 offset:33440
    ds_read_b128 v[88:91], v6 offset:33472
    ds_read_b128 v[92:95], v6 offset:33504
    s_waitcnt lgkmcnt(7)
    v_mfma_f32_32x32x16_bf16 v[32:47], v[64:67], a[0:3], 0
    v_mfma_f32_32x32x16_bf16 v[48:63], v[64:67], a[128:131], 0
    ds_read_b128 v[64:67], v6 offset:33536
    s_waitcnt lgkmcnt(7)
    v_mfma_f32_32x32x16_bf16 v[32:47], v[68:71], a[4:7], v[32:47]
    v_mfma_f32_32x32x16_bf16 v[48:63], v[68:71], a[132:135], v[48:63]
    ds_read_b128 v[68:71], v6 offset:33568
    s_waitcnt lgkmcnt(7)
    v_mfma_f32_32x32x16_bf16 v[32:47], v[72:75], a[8:11], v[32:47]
    v_mfma_f32_32x32x16_bf16 v[48:63], v[72:75], a[136:139], v[48:63]
    ds_read_b128 v[72:75], v6 offset:33600
    s_waitcnt lgkmcnt(7)
    v_mfma_f32_32x32x16_bf16 v[32:47], v[76:79], a[12:15], v[32:47]
    v_mfma_f32_32x32x16_bf16 v[48:63], v[76:79], a[140:143], v[48:63]
    ds_read_b128 v[76:79], v6 offset:33632
    s_waitcnt lgkmcnt(7)
    v_mfma_f32_32x32x16_bf16 v[32:47], v[80:83], a[16:19], v[32:47]
    v_mfma_f32_32x32x16_bf16 v[48:63], v[80:83], a[144:147], v[48:63]
    ds_read_b128 v[80:83], v6 offset:33664
    s_waitcnt lgkmcnt(7)
    v_mfma_f32_32x32x16_bf16 v[32:47], v[84:87], a[20:23], v[32:47]
    v_mfma_f32_32x32x16_bf16 v[48:63], v[84:87], a[148:151], v[48:63]
    ds_read_b128 v[84:87], v6 offset:33696
    s_waitcnt lgkmcnt(7)
    v_mfma_f32_32x32x16_bf16 v[32:47], v[88:91], a[24:27], v[32:47]
    v_mfma_f32_32x32x16_bf16 v[48:63], v[88:91], a[152:155], v[48:63]
    ds_read_b128 v[88:91], v6 offset:33728
    s_waitcnt lgkmcnt(7)
    v_mfma_f32_32x32x16_bf16 v[32:47], v[92:95], a[28:31], v[32:47]
    v_mfma_f32_32x32x16_bf16 v[48:63], v[92:95], a[156:159], v[48:63]
    ds_read_b128 v[92:95], v6 offset:33760
    s_waitcnt lgkmcnt(7)
    v_mfma_f32_32x32x16_bf16 v[32:47], v[64:67], a[32:35], v[32:47]
    v_mfma_f32_32x32x16_bf16 v[48:63], v[64:67], a[160:163], v[48:63]
    ds_read_b128 v[64:67], v6 offset:33792
    s_waitcnt lgkmcnt(7)
    v_mfma_f32_32x32x16_bf16 v[32:47], v[68:71], a[36:39], v[32:47]
    v_mfma_f32_32x32x16_bf16 v[48:63], v[68:71], a[164:167], v[48:63]
    ds_read_b128 v[68:71], v6 offset:33824
    s_waitcnt lgkmcnt(7)
    v_mfma_f32_32x32x16_bf16 v[32:47], v[72:75], a[40:43], v[32:47]
    v_mfma_f32_32x32x16_bf16 v[48:63], v[72:75], a[168:171], v[48:63]
    ds_read_b128 v[72:75], v6 offset:33856
    s_waitcnt lgkmcnt(7)
    v_mfma_f32_32x32x16_bf16 v[32:47], v[76:79], a[44:47], v[32:47]
    v_mfma_f32_32x32x16_bf16 v[48:63], v[76:79], a[172:175], v[48:63]
    ds_read_b128 v[76:79], v6 offset:33888
    s_waitcnt lgkmcnt(7)
    v_mfma_f32_32x32x16_bf16 v[32:47], v[80:83], a[48:51], v[32:47]
    v_mfma_f32_32x32x16_bf16 v[48:63], v[80:83], a[176:179], v[48:63]
    ds_read_b128 v[80:83], v6 offset:33920
    s_waitcnt lgkmcnt(7)
    v_mfma_f32_32x32x16_bf16 v[32:47], v[84:87], a[52:55], v[32:47]
    v_mfma_f32_32x32x16_bf16 v[48:63], v[84:87], a[180:183], v[48:63]
    ds_read_b128 v[84:87], v6 offset:33952
    s_waitcnt lgkmcnt(7)
    v_mfma_f32_32x32x16_bf16 v[32:47], v[88:91], a[56:59], v[32:47]
    v_mfma_f32_32x32x16_bf16 v[48:63], v[88:91], a[184:187], v[48:63]
    ds_read_b128 v[88:91], v6 offset:33984
    s_waitcnt lgkmcnt(7)
    v_mfma_f32_32x32x16_bf16 v[32:47], v[92:95], a[60:63], v[32:47]
    v_mfma_f32_32x32x16_bf16 v[48:63], v[92:95], a[188:191], v[48:63]
    ds_read_b128 v[92:95], v6 offset:34016
    s_waitcnt lgkmcnt(7)
    v_mfma_f32_32x32x16_bf16 v[32:47], v[64:67], a[64:67], v[32:47]
    v_mfma_f32_32x32x16_bf16 v[48:63], v[64:67], a[192:195], v[48:63]
    ds_read_b128 v[64:67], v6 offset:34048
    s_waitcnt lgkmcnt(7)
    v_mfma_f32_32x32x16_bf16 v[32:47], v[68:71], a[68:71], v[32:47]
    v_mfma_f32_32x32x16_bf16 v[48:63], v[68:71], a[196:199], v[48:63]
    ds_read_b128 v[68:71], v6 offset:34080
    s_waitcnt lgkmcnt(7)
    v_mfma_f32_32x32x16_bf16 v[32:47], v[72:75], a[72:75], v[32:47]
    v_mfma_f32_32x32x16_bf16 v[48:63], v[72:75], a[200:203], v[48:63]
    ds_read_b128 v[72:75], v6 offset:34112
    s_waitcnt lgkmcnt(7)
    v_mfma_f32_32x32x16_bf16 v[32:47], v[76:79], a[76:79], v[32:47]
    v_mfma_f32_32x32x16_bf16 v[48:63], v[76:79], a[204:207], v[48:63]
    ds_read_b128 v[76:79], v6 offset:34144
    s_waitcnt lgkmcnt(7)
    v_mfma_f32_32x32x16_bf16 v[32:47], v[80:83], a[80:83], v[32:47]
    v_mfma_f32_32x32x16_bf16 v[48:63], v[80:83], a[208:211], v[48:63]
    ds_read_b128 v[80:83], v6 offset:34176
    s_waitcnt lgkmcnt(7)
    v_mfma_f32_32x32x16_bf16 v[32:47], v[84:87], a[84:87], v[32:47]
    v_mfma_f32_32x32x16_bf16 v[48:63], v[84:87], a[212:215], v[48:63]
    ds_read_b128 v[84:87], v6 offset:34208
    s_waitcnt lgkmcnt(7)
    v_mfma_f32_32x32x16_bf16 v[32:47], v[88:91], a[88:91], v[32:47]
    v_mfma_f32_32x32x16_bf16 v[48:63], v[88:91], a[216:219], v[48:63]
    ds_read_b128 v[88:91], v6 offset:34240
    s_waitcnt lgkmcnt(7)
    v_mfma_f32_32x32x16_bf16 v[32:47], v[92:95], a[92:95], v[32:47]
    v_mfma_f32_32x32x16_bf16 v[48:63], v[92:95], a[220:223], v[48:63]
    ds_read_b128 v[92:95], v6 offset:34272
    s_waitcnt lgkmcnt(7)
    v_mfma_f32_32x32x16_bf16 v[32:47], v[64:67], a[96:99], v[32:47]
    v_mfma_f32_32x32x16_bf16 v[48:63], v[64:67], a[224:227], v[48:63]
    s_waitcnt lgkmcnt(6)
    v_mfma_f32_32x32x16_bf16 v[32:47], v[68:71], a[100:103], v[32:47]
    v_mfma_f32_32x32x16_bf16 v[48:63], v[68:71], a[228:231], v[48:63]
    s_waitcnt lgkmcnt(5)
    v_mfma_f32_32x32x16_bf16 v[32:47], v[72:75], a[104:107], v[32:47]
    v_mfma_f32_32x32x16_bf16 v[48:63], v[72:75], a[232:235], v[48:63]
    s_waitcnt lgkmcnt(4)
    v_mfma_f32_32x32x16_bf16 v[32:47], v[76:79], a[108:111], v[32:47]
    v_mfma_f32_32x32x16_bf16 v[48:63], v[76:79], a[236:239], v[48:63]
    s_waitcnt lgkmcnt(3)
    v_mfma_f32_32x32x16_bf16 v[32:47], v[80:83], a[112:115], v[32:47]
    v_mfma_f32_32x32x16_bf16 v[48:63], v[80:83], a[240:243], v[48:63]
    s_waitcnt lgkmcnt(2)
    v_mfma_f32_32x32x16_bf16 v[32:47], v[84:87], a[116:119], v[32:47]
    v_mfma_f32_32x32x16_bf16 v[48:63], v[84:87], a[244:247], v[48:63]
    s_waitcnt lgkmcnt(1)
    v_mfma_f32_32x32x16_bf16 v[32:47], v[88:91], a[120:123], v[32:47]
    v_mfma_f32_32x32x16_bf16 v[48:63], v[88:91], a[248:251], v[48:63]
    s_waitcnt lgkmcnt(0)
    v_mfma_f32_32x32x16_bf16 v[32:47], v[92:95], a[124:127], v[32:47]
    v_mfma_f32_32x32x16_bf16 v[48:63], v[92:95], a[252:255], v[48:63]
    s_nop 15
    v_mov_b32 v96, v32
    v_mov_b32 v97, v48
    s_add_u32 s27, s28, 0
    buffer_store_dwordx2 v[96:97], v8, s[8:11], s27 offen sc1
    v_mov_b32 v98, v33
    v_mov_b32 v99, v49
    s_add_u32 s27, s28, 4096
    buffer_store_dwordx2 v[98:99], v8, s[8:11], s27 offen sc1
    v_mov_b32 v100, v34
    v_mov_b32 v101, v50
    s_add_u32 s27, s28, 8192
    buffer_store_dwordx2 v[100:101], v8, s[8:11], s27 offen sc1
    v_mov_b32 v102, v35
    v_mov_b32 v103, v51
    s_add_u32 s27, s28, 12288
    buffer_store_dwordx2 v[102:103], v8, s[8:11], s27 offen sc1
    v_mov_b32 v104, v36
    v_mov_b32 v105, v52
    s_add_u32 s27, s28, 16384
    buffer_store_dwordx2 v[104:105], v8, s[8:11], s27 offen sc1
    v_mov_b32 v106, v37
    v_mov_b32 v107, v53
    s_add_u32 s27, s28, 20480
    buffer_store_dwordx2 v[106:107], v8, s[8:11], s27 offen sc1
    v_mov_b32 v108, v38
    v_mov_b32 v109, v54
    s_add_u32 s27, s28, 24576
    buffer_store_dwordx2 v[108:109], v8, s[8:11], s27 offen sc1
    v_mov_b32 v110, v39
    v_mov_b32 v111, v55
    s_add_u32 s27, s28, 28672
    buffer_store_dwordx2 v[110:111], v8, s[8:11], s27 offen sc1
    v_mov_b32 v96, v40
    v_mov_b32 v97, v56
    s_add_u32 s27, s28, 32768
    buffer_store_dwordx2 v[96:97], v8, s[8:11], s27 offen sc1
    v_mov_b32 v98, v41
    v_mov_b32 v99, v57
    s_add_u32 s27, s28, 36864
    buffer_store_dwordx2 v[98:99], v8, s[8:11], s27 offen sc1
    v_mov_b32 v100, v42
    v_mov_b32 v101, v58
    s_add_u32 s27, s28, 40960
    buffer_store_dwordx2 v[100:101], v8, s[8:11], s27 offen sc1
    v_mov_b32 v102, v43
    v_mov_b32 v103, v59
    s_add_u32 s27, s28, 45056
    buffer_store_dwordx2 v[102:103], v8, s[8:11], s27 offen sc1
    v_mov_b32 v104, v44
    v_mov_b32 v105, v60
    s_add_u32 s27, s28, 49152
    buffer_store_dwordx2 v[104:105], v8, s[8:11], s27 offen sc1
    v_mov_b32 v106, v45
    v_mov_b32 v107, v61
    s_add_u32 s27, s28, 53248
    buffer_store_dwordx2 v[106:107], v8, s[8:11], s27 offen sc1
    v_mov_b32 v108, v46
    v_mov_b32 v109, v62
    s_add_u32 s27, s28, 57344
    buffer_store_dwordx2 v[108:109], v8, s[8:11], s27 offen sc1
    v_mov_b32 v110, v47
    v_mov_b32 v111, v63
    s_add_u32 s27, s28, 61440
    buffer_store_dwordx2 v[110:111], v8, s[8:11], s27 offen sc1
    s_add_u32 s33, s33, 1
    s_cmp_ge_u32 s33, 16
    s_cbranch_scc1 L_pu_U_fin
    s_branch L_pu_U_loop
L_pu_U_fin:
    s_waitcnt vmcnt(0)
    s_barrier
    s_cmp_lg_u32 s24, 0
    s_cbranch_scc1 L_pu_U_ppf_np
    s_mov_b64 exec, 1
    v_mov_b32 v120, 0
    v_mov_b32 v121, 2
    buffer_atomic_add v121, v120, s[8:11], s34 offen sc1
    s_mov_b64 exec, -1
L_pu_U_ppf_np:
L_pu_end:
    s_branch L_phase2
L_p_q:
    s_sub_u32 s30, s60, 128
    s_lshr_b32 s30, s30, 2
    v_and_b32 v1, 63, v0
    v_and_b32 v2, 31, v1
    v_lshrrev_b32 v3, 5, v1
    v_lshlrev_b32 v4, 4, v1
    s_load_dwordx2 s[16:17], s[0:1], 16
    s_mov_b32 s18, 0x400000
    s_mov_b32 s19, 0x20000
    s_lshr_b32 s25, s24, 1
    s_lshl_b32 s26, s30, 1
    s_add_u32 s26, s26, s25
    s_lshl_b32 s26, s26, 8
    s_waitcnt lgkmcnt(0)
    s_and_b32 s25, s24, 1
    s_lshl_b32 s25, s25, 7
    s_add_u32 s26, s26, s25
    v_lshrrev_b32 v5, 3, v1
    v_lshlrev_b32 v5, 13, v5
    v_and_b32 v6, 7, v1
    v_lshlrev_b32 v6, 4, v6
    v_add3_u32 v5, v5, v6, s26
    v_and_b32 v6, 15, v1
    v_lshrrev_b32 v7, 2, v6
    v_and_b32 v6, 3, v6
    v_lshrrev_b32 v8, 5, v1
    v_lshlrev_b32 v8, 3, v8
    v_add_u32 v7, v7, v8
    v_lshlrev_b32 v7, 7, v7
    v_bfe_u32 v8, v1, 4, 1
    v_lshlrev_b32 v8, 5, v8
    v_lshlrev_b32 v6, 3, v6
    v_add3_u32 v7, v7, v8, v6
    s_lshl_b32 s27, s24, 15
    v_add_u32 v7, s27, v7
    s_add_u32 m0, s27, 0
    s_mov_b32 s28, 0
    buffer_load_dwordx4 v5, s[16:19], s28 offen lds
    s_add_u32 m0, s27, 1024
    s_mov_b32 s28, 65536
    buffer_load_dwordx4 v5, s[16:19], s28 offen lds
    s_add_u32 m0, s27, 2048
    s_mov_b32 s28, 131072
    buffer_load_dwordx4 v5, s[16:19], s28 offen lds
    s_add_u32 m0, s27, 3072
    s_mov_b32 s28, 196608
    buffer_load_dwordx4 v5, s[16:19], s28 offen lds
    s_add_u32 m0, s27, 4096
    s_mov_b32 s28, 262144
    buffer_load_dwordx4 v5, s[16:19], s28 offen lds
    s_add_u32 m0, s27, 5120
    s_mov_b32 s28, 327680
    buffer_load_dwordx4 v5, s[16:19], s28 offen lds
    s_add_u32 m0, s27, 6144
    s_mov_b32 s28, 393216
    buffer_load_dwordx4 v5, s[16:19], s28 offen lds
    s_add_u32 m0, s27, 7168
    s_mov_b32 s28, 458752
    buffer_load_dwordx4 v5, s[16:19], s28 offen lds
    s_add_u32 m0, s27, 8192
    s_mov_b32 s28, 524288
    buffer_load_dwordx4 v5, s[16:19], s28 offen lds
    s_add_u32 m0, s27, 9216
    s_mov_b32 s28, 589824
    buffer_load_dwordx4 v5, s[16:19], s28 offen lds
    s_add_u32 m0, s27, 10240
    s_mov_b32 s28, 655360
    buffer_load_dwordx4 v5, s[16:19], s28 offen lds
    s_add_u32 m0, s27, 11264
    s_mov_b32 s28, 720896
    buffer_load_dwordx4 v5, s[16:19], s28 offen lds
    s_add_u32 m0, s27, 12288
    s_mov_b32 s28, 786432
    buffer_load_dwordx4 v5, s[16:19], s28 offen lds
    s_add_u32 m0, s27, 13312
    s_mov_b32 s28, 851968
    buffer_load_dwordx4 v5, s[16:19], s28 offen lds
    s_add_u32 m0, s27, 14336
    s_mov_b32 s28, 917504
    buffer_load_dwordx4 v5, s[16:19], s28 offen lds
    s_add_u32 m0, s27, 15360
    s_mov_b32 s28, 983040
    buffer_load_dwordx4 v5, s[16:19], s28 offen lds
    s_add_u32 m0, s27, 16384
    s_mov_b32 s28, 1048576
    buffer_load_dwordx4 v5, s[16:19], s28 offen lds
    s_add_u32 m0, s27, 17408
    s_mov_b32 s28, 1114112
    buffer_load_dwordx4 v5, s[16:19], s28 offen lds
    s_add_u32 m0, s27, 18432
    s_mov_b32 s28, 1179648
    buffer_load_dwordx4 v5, s[16:19], s28 offen lds
    s_add_u32 m0, s27, 19456
    s_mov_b32 s28, 1245184
    buffer_load_dwordx4 v5, s[16:19], s28 offen lds
    s_add_u32 m0, s27, 20480
    s_mov_b32 s28, 1310720
    buffer_load_dwordx4 v5, s[16:19], s28 offen lds
    s_add_u32 m0, s27, 21504
    s_mov_b32 s28, 1376256
    buffer_load_dwordx4 v5, s[16:19], s28 offen lds
    s_add_u32 m0, s27, 22528
    s_mov_b32 s28, 1441792
    buffer_load_dwordx4 v5, s[16:19], s28 offen lds
    s_add_u32 m0, s27, 23552
    s_mov_b32 s28, 1507328
    buffer_load_dwordx4 v5, s[16:19], s28 offen lds
    s_add_u32 m0, s27, 24576
    s_mov_b32 s28, 1572864
    buffer_load_dwordx4 v5, s[16:19], s28 offen lds
    s_add_u32 m0, s27, 25600
    s_mov_b32 s28, 1638400
    buffer_load_dwordx4 v5, s[16:19], s28 offen lds
    s_add_u32 m0, s27, 26624
    s_mov_b32 s28, 1703936
    buffer_load_dwordx4 v5, s[16:19], s28 offen lds
    s_add_u32 m0, s27, 27648
    s_mov_b32 s28, 1769472
    buffer_load_dwordx4 v5, s[16:19], s28 offen lds
    s_add_u32 m0, s27, 28672
    s_mov_b32 s28, 1835008
    buffer_load_dwordx4 v5, s[16:19], s28 offen lds
    s_add_u32 m0, s27, 29696
    s_mov_b32 s28, 1900544
    buffer_load_dwordx4 v5, s[16:19], s28 offen lds
    s_add_u32 m0, s27, 30720
    s_mov_b32 s28, 1966080
    buffer_load_dwordx4 v5, s[16:19], s28 offen lds
    s_add_u32 m0, s27, 31744
    s_mov_b32 s28, 2031616
    buffer_load_dwordx4 v5, s[16:19], s28 offen lds
    s_waitcnt vmcnt(16)
    ds_read_b64_tr_b16 a[0:1], v7 offset:0
    ds_read_b64_tr_b16 a[2:3], v7 offset:512
    ds_read_b64_tr_b16 a[128:129], v7 offset:64
    ds_read_b64_tr_b16 a[130:131], v7 offset:576
    ds_read_b64_tr_b16 a[4:5], v7 offset:2048
    ds_read_b64_tr_b16 a[6:7], v7 offset:2560
    ds_read_b64_tr_b16 a[132:133], v7 offset:2112
    ds_read_b64_tr_b16 a[134:135], v7 offset:2624
    s_waitcnt lgkmcnt(4)
    ds_read_b64_tr_b16 a[8:9], v7 offset:4096
    ds_read_b64_tr_b16 a[10:11], v7 offset:4608
    ds_read_b64_tr_b16 a[136:137], v7 offset:4160
    ds_read_b64_tr_b16 a[138:139], v7 offset:4672
    ds_read_b64_tr_b16 a[12:13], v7 offset:6144
    ds_read_b64_tr_b16 a[14:15], v7 offset:6656
    ds_read_b64_tr_b16 a[140:141], v7 offset:6208
    ds_read_b64_tr_b16 a[142:143], v7 offset:6720
    s_waitcnt lgkmcnt(4)
    ds_read_b64_tr_b16 a[16:17], v7 offset:8192
    ds_read_b64_tr_b16 a[18:19], v7 offset:8704
    ds_read_b64_tr_b16 a[144:145], v7 offset:8256
    ds_read_b64_tr_b16 a[146:147], v7 offset:8768
    ds_read_b64_tr_b16 a[20:21], v7 offset:10240
    ds_read_b64_tr_b16 a[22:23], v7 offset:10752
    ds_read_b64_tr_b16 a[148:149], v7 offset:10304
    ds_read_b64_tr_b16 a[150:151], v7 offset:10816
    s_waitcnt lgkmcnt(4)
    ds_read_b64_tr_b16 a[24:25], v7 offset:12288
    ds_read_b64_tr_b16 a[26:27], v7 offset:12800
    ds_read_b64_tr_b16 a[152:153], v7 offset:12352
    ds_read_b64_tr_b16 a[154:155], v7 offset:12864
    ds_read_b64_tr_b16 a[28:29], v7 offset:14336
    ds_read_b64_tr_b16 a[30:31], v7 offset:14848
    ds_read_b64_tr_b16 a[156:157], v7 offset:14400
    ds_read_b64_tr_b16 a[158:159], v7 offset:14912
    s_waitcnt lgkmcnt(4)
    s_waitcnt lgkmcnt(0)
    s_add_u32 m0, s27, 0
    s_mov_b32 s28, 2097152
    buffer_load_dwordx4 v5, s[16:19], s28 offen lds
    s_add_u32 m0, s27, 1024
    s_mov_b32 s28, 2162688
    buffer_load_dwordx4 v5, s[16:19], s28 offen lds
    s_add_u32 m0, s27, 2048
    s_mov_b32 s28, 2228224
    buffer_load_dwordx4 v5, s[16:19], s28 offen lds
    s_add_u32 m0, s27, 3072
    s_mov_b32 s28, 2293760
    buffer_load_dwordx4 v5, s[16:19], s28 offen lds
    s_add_u32 m0, s27, 4096
    s_mov_b32 s28, 2359296
    buffer_load_dwordx4 v5, s[16:19], s28 offen lds
    s_add_u32 m0, s27, 5120
    s_mov_b32 s28, 2424832
    buffer_load_dwordx4 v5, s[16:19], s28 offen lds
    s_add_u32 m0, s27, 6144
    s_mov_b32 s28, 2490368
    buffer_load_dwordx4 v5, s[16:19], s28 offen lds
    s_add_u32 m0, s27, 7168
    s_mov_b32 s28, 2555904
    buffer_load_dwordx4 v5, s[16:19], s28 offen lds
    s_add_u32 m0, s27, 8192
    s_mov_b32 s28, 2621440
    buffer_load_dwordx4 v5, s[16:19], s28 offen lds
    s_add_u32 m0, s27, 9216
    s_mov_b32 s28, 2686976
    buffer_load_dwordx4 v5, s[16:19], s28 offen lds
    s_add_u32 m0, s27, 10240
    s_mov_b32 s28, 2752512
    buffer_load_dwordx4 v5, s[16:19], s28 offen lds
    s_add_u32 m0, s27, 11264
    s_mov_b32 s28, 2818048
    buffer_load_dwordx4 v5, s[16:19], s28 offen lds
    s_add_u32 m0, s27, 12288
    s_mov_b32 s28, 2883584
    buffer_load_dwordx4 v5, s[16:19], s28 offen lds
    s_add_u32 m0, s27, 13312
    s_mov_b32 s28, 2949120
    buffer_load_dwordx4 v5, s[16:19], s28 offen lds
    s_add_u32 m0, s27, 14336
    s_mov_b32 s28, 3014656
    buffer_load_dwordx4 v5, s[16:19], s28 offen lds
    s_add_u32 m0, s27, 15360
    s_mov_b32 s28, 3080192
    buffer_load_dwordx4 v5, s[16:19], s28 offen lds
    s_waitcnt vmcnt(16)
    ds_read_b64_tr_b16 a[32:33], v7 offset:16384
    ds_read_b64_tr_b16 a[34:35], v7 offset:16896
    ds_read_b64_tr_b16 a[160:161], v7 offset:16448
    ds_read_b64_tr_b16 a[162:163], v7 offset:16960
    ds_read_b64_tr_b16 a[36:37], v7 offset:18432
    ds_read_b64_tr_b16 a[38:39], v7 offset:18944
    ds_read_b64_tr_b16 a[164:165], v7 offset:18496
    ds_read_b64_tr_b16 a[166:167], v7 offset:19008
    s_waitcnt lgkmcnt(4)
    ds_read_b64_tr_b16 a[40:41], v7 offset:20480
    ds_read_b64_tr_b16 a[42:43], v7 offset:20992
    ds_read_b64_tr_b16 a[168:169], v7 offset:20544
    ds_read_b64_tr_b16 a[170:171], v7 offset:21056
    ds_read_b64_tr_b16 a[44:45], v7 offset:22528
    ds_read_b64_tr_b16 a[46:47], v7 offset:23040
    ds_read_b64_tr_b16 a[172:173], v7 offset:22592
    ds_read_b64_tr_b16 a[174:175], v7 offset:23104
    s_waitcnt lgkmcnt(4)
    ds_read_b64_tr_b16 a[48:49], v7 offset:24576
    ds_read_b64_tr_b16 a[50:51], v7 offset:25088
    ds_read_b64_tr_b16 a[176:177], v7 offset:24640
    ds_read_b64_tr_b16 a[178:179], v7 offset:25152
    ds_read_b64_tr_b16 a[52:53], v7 offset:26624
    ds_read_b64_tr_b16 a[54:55], v7 offset:27136
    ds_read_b64_tr_b16 a[180:181], v7 offset:26688
    ds_read_b64_tr_b16 a[182:183], v7 offset:27200
    s_waitcnt lgkmcnt(4)
    ds_read_b64_tr_b16 a[56:57], v7 offset:28672
    ds_read_b64_tr_b16 a[58:59], v7 offset:29184
    ds_read_b64_tr_b16 a[184:185], v7 offset:28736
    ds_read_b64_tr_b16 a[186:187], v7 offset:29248
    ds_read_b64_tr_b16 a[60:61], v7 offset:30720
    ds_read_b64_tr_b16 a[62:63], v7 offset:31232
    ds_read_b64_tr_b16 a[188:189], v7 offset:30784
    ds_read_b64_tr_b16 a[190:191], v7 offset:31296
    s_waitcnt lgkmcnt(4)
    s_waitcnt lgkmcnt(0)
    s_add_u32 m0, s27, 16384
    s_mov_b32 s28, 3145728
    buffer_load_dwordx4 v5, s[16:19], s28 offen lds
    s_add_u32 m0, s27, 17408
    s_mov_b32 s28, 3211264
    buffer_load_dwordx4 v5, s[16:19], s28 offen lds
    s_add_u32 m0, s27, 18432
    s_mov_b32 s28, 3276800
    buffer_load_dwordx4 v5, s[16:19], s28 offen lds
    s_add_u32 m0, s27, 19456
    s_mov_b32 s28, 3342336
    buffer_load_dwordx4 v5, s[16:19], s28 offen lds
    s_add_u32 m0, s27, 20480
    s_mov_b32 s28, 3407872
    buffer_load_dwordx4 v5, s[16:19], s28 offen lds
    s_add_u32 m0, s27, 21504
    s_mov_b32 s28, 3473408
    buffer_load_dwordx4 v5, s[16:19], s28 offen lds
    s_add_u32 m0, s27, 22528
    s_mov_b32 s28, 3538944
    buffer_load_dwordx4 v5, s[16:19], s28 offen lds
    s_add_u32 m0, s27, 23552
    s_mov_b32 s28, 3604480
    buffer_load_dwordx4 v5, s[16:19], s28 offen lds
    s_add_u32 m0, s27, 24576
    s_mov_b32 s28, 3670016
    buffer_load_dwordx4 v5, s[16:19], s28 offen lds
    s_add_u32 m0, s27, 25600
    s_mov_b32 s28, 3735552
    buffer_load_dwordx4 v5, s[16:19], s28 offen lds
    s_add_u32 m0, s27, 26624
    s_mov_b32 s28, 3801088
    buffer_load_dwordx4 v5, s[16:19], s28 offen lds
    s_add_u32 m0, s27, 27648
    s_mov_b32 s28, 3866624
    buffer_load_dwordx4 v5, s[16:19], s28 offen lds
    s_add_u32 m0, s27, 28672
    s_mov_b32 s28, 3932160
    buffer_load_dwordx4 v5, s[16:19], s28 offen lds
    s_add_u32 m0, s27, 29696
    s_mov_b32 s28, 3997696
    buffer_load_dwordx4 v5, s[16:19], s28 offen lds
    s_add_u32 m0, s27, 30720
    s_mov_b32 s28, 4063232
    buffer_load_dwordx4 v5, s[16:19], s28 offen lds
    s_add_u32 m0, s27, 31744
    s_mov_b32 s28, 4128768
    buffer_load_dwordx4 v5, s[16:19], s28 offen lds
    s_waitcnt vmcnt(16)
    ds_read_b64_tr_b16 a[64:65], v7 offset:0
    ds_read_b64_tr_b16 a[66:67], v7 offset:512
    ds_read_b64_tr_b16 a[192:193], v7 offset:64
    ds_read_b64_tr_b16 a[194:195], v7 offset:576
    ds_read_b64_tr_b16 a[68:69], v7 offset:2048
    ds_read_b64_tr_b16 a[70:71], v7 offset:2560
    ds_read_b64_tr_b16 a[196:197], v7 offset:2112
    ds_read_b64_tr_b16 a[198:199], v7 offset:2624
    s_waitcnt lgkmcnt(4)
    ds_read_b64_tr_b16 a[72:73], v7 offset:4096
    ds_read_b64_tr_b16 a[74:75], v7 offset:4608
    ds_read_b64_tr_b16 a[200:201], v7 offset:4160
    ds_read_b64_tr_b16 a[202:203], v7 offset:4672
    ds_read_b64_tr_b16 a[76:77], v7 offset:6144
    ds_read_b64_tr_b16 a[78:79], v7 offset:6656
    ds_read_b64_tr_b16 a[204:205], v7 offset:6208
    ds_read_b64_tr_b16 a[206:207], v7 offset:6720
    s_waitcnt lgkmcnt(4)
    ds_read_b64_tr_b16 a[80:81], v7 offset:8192
    ds_read_b64_tr_b16 a[82:83], v7 offset:8704
    ds_read_b64_tr_b16 a[208:209], v7 offset:8256
    ds_read_b64_tr_b16 a[210:211], v7 offset:8768
    ds_read_b64_tr_b16 a[84:85], v7 offset:10240
    ds_read_b64_tr_b16 a[86:87], v7 offset:10752
    ds_read_b64_tr_b16 a[212:213], v7 offset:10304
    ds_read_b64_tr_b16 a[214:215], v7 offset:10816
    s_waitcnt lgkmcnt(4)
    ds_read_b64_tr_b16 a[88:89], v7 offset:12288
    ds_read_b64_tr_b16 a[90:91], v7 offset:12800
    ds_read_b64_tr_b16 a[216:217], v7 offset:12352
    ds_read_b64_tr_b16 a[218:219], v7 offset:12864
    ds_read_b64_tr_b16 a[92:93], v7 offset:14336
    ds_read_b64_tr_b16 a[94:95], v7 offset:14848
    ds_read_b64_tr_b16 a[220:221], v7 offset:14400
    ds_read_b64_tr_b16 a[222:223], v7 offset:14912
    s_waitcnt lgkmcnt(4)
    s_waitcnt lgkmcnt(0)
    s_waitcnt vmcnt(0)
    ds_read_b64_tr_b16 a[96:97], v7 offset:16384
    ds_read_b64_tr_b16 a[98:99], v7 offset:16896
    ds_read_b64_tr_b16 a[224:225], v7 offset:16448
    ds_read_b64_tr_b16 a[226:227], v7 offset:16960
    ds_read_b64_tr_b16 a[100:101], v7 offset:18432
    ds_read_b64_tr_b16 a[102:103], v7 offset:18944
    ds_read_b64_tr_b16 a[228:229], v7 offset:18496
    ds_read_b64_tr_b16 a[230:231], v7 offset:19008
    s_waitcnt lgkmcnt(4)
    ds_read_b64_tr_b16 a[104:105], v7 offset:20480
    ds_read_b64_tr_b16 a[106:107], v7 offset:20992
    ds_read_b64_tr_b16 a[232:233], v7 offset:20544
    ds_read_b64_tr_b16 a[234:235], v7 offset:21056
    ds_read_b64_tr_b16 a[108:109], v7 offset:22528
    ds_read_b64_tr_b16 a[110:111], v7 offset:23040
    ds_read_b64_tr_b16 a[236:237], v7 offset:22592
    ds_read_b64_tr_b16 a[238:239], v7 offset:23104
    s_waitcnt lgkmcnt(4)
    ds_read_b64_tr_b16 a[112:113], v7 offset:24576
    ds_read_b64_tr_b16 a[114:115], v7 offset:25088
    ds_read_b64_tr_b16 a[240:241], v7 offset:24640
    ds_read_b64_tr_b16 a[242:243], v7 offset:25152
    ds_read_b64_tr_b16 a[116:117], v7 offset:26624
    ds_read_b64_tr_b16 a[118:119], v7 offset:27136
    ds_read_b64_tr_b16 a[244:245], v7 offset:26688
    ds_read_b64_tr_b16 a[246:247], v7 offset:27200
    s_waitcnt lgkmcnt(4)
    ds_read_b64_tr_b16 a[120:121], v7 offset:28672
    ds_read_b64_tr_b16 a[122:123], v7 offset:29184
    ds_read_b64_tr_b16 a[248:249], v7 offset:28736
    ds_read_b64_tr_b16 a[250:251], v7 offset:29248
    ds_read_b64_tr_b16 a[124:125], v7 offset:30720
    ds_read_b64_tr_b16 a[126:127], v7 offset:31232
    ds_read_b64_tr_b16 a[252:253], v7 offset:30784
    ds_read_b64_tr_b16 a[254:255], v7 offset:31296
    s_waitcnt lgkmcnt(4)
    s_waitcnt lgkmcnt(0)
    s_barrier
    s_load_dwordx2 s[12:13], s[0:1], 0
    s_mov_b32 s14, 2097152
    s_mov_b32 s15, 0x20000
    s_waitcnt lgkmcnt(0)
    v_mov_b32 v6, v2
    v_mul_u32_u24 v6, 1040, v6
    v_lshlrev_b32 v7, 4, v3
    v_add_u32 v6, v6, v7
    v_lshrrev_b32 v8, 4, v2
    v_and_b32 v9, 15, v2
    v_lshlrev_b32 v9, 4, v9
    v_lshlrev_b32 v10, 8, v3
    v_add_u32 v9, v9, v10
    v_lshlrev_b32 v10, 12, v8
    v_add_u32 v10, v10, v9
    v_lshlrev_b32 v11, 10, v8
    v_add_u32 v11, v11, v9
    v_mov_b32 v8, v10
    s_and_b32 s25, s24, 1
    s_lshl_b32 s25, s25, 11
    s_lshr_b32 s26, s24, 1
    s_lshl_b32 s27, s30, 1
    s_add_u32 s26, s26, s27
    s_lshl_b32 s26, s26, 13
    s_add_u32 s32, s25, s26
    s_add_u32 s32, s32, 50331648
    s_lshl_b32 s25, s29, 4
    s_add_u32 s25, s25, s30
    s_lshl_b32 s25, s25, 2
    s_add_u32 s34, s25, 590336
    s_mov_b32 s31, s29
    s_mov_b32 s33, 0
    s_lshl_b32 s25, s31, 15
    s_lshl_b32 s26, s24, 13
    s_add_u32 s25, s25, s26
    s_mul_i32 s26, s24, 8320
    s_add_u32 s26, s26, 0
    s_add_u32 m0, s26, 0
    s_add_u32 s27, s25, 0
    buffer_load_dwordx4 v4, s[12:15], s27 offen lds
    s_add_u32 m0, s26, 1040
    s_add_u32 s27, s25, 1024
    buffer_load_dwordx4 v4, s[12:15], s27 offen lds
    s_add_u32 m0, s26, 2080
    s_add_u32 s27, s25, 2048
    buffer_load_dwordx4 v4, s[12:15], s27 offen lds
    s_add_u32 m0, s26, 3120
    s_add_u32 s27, s25, 3072
    buffer_load_dwordx4 v4, s[12:15], s27 offen lds
    s_add_u32 m0, s26, 4160
    s_add_u32 s27, s25, 4096
    buffer_load_dwordx4 v4, s[12:15], s27 offen lds
    s_add_u32 m0, s26, 5200
    s_add_u32 s27, s25, 5120
    buffer_load_dwordx4 v4, s[12:15], s27 offen lds
    s_add_u32 m0, s26, 6240
    s_add_u32 s27, s25, 6144
    buffer_load_dwordx4 v4, s[12:15], s27 offen lds
    s_add_u32 m0, s26, 7280
    s_add_u32 s27, s25, 7168
    buffer_load_dwordx4 v4, s[12:15], s27 offen lds
L_pq_Q_loop:
    s_cmp_eq_u32 s33, 0
    s_cbranch_scc1 L_pq_Q_w0_0
    s_waitcnt vmcnt(4)
    s_branch L_pq_Q_w1_0
L_pq_Q_w0_0:
    s_waitcnt vmcnt(0)
L_pq_Q_w1_0:
    s_barrier
    s_cmp_lt_u32 s33, 2
    s_cbranch_scc1 L_pq_Q_pp0_np
    s_sub_u32 s36, s33, 1
    s_cmp_lg_u32 s24, 0
    s_cbranch_scc1 L_pq_Q_pp0_np
    s_mov_b64 exec, 1
    v_mov_b32 v120, 0
    v_mov_b32 v121, s36
    buffer_store_dword v121, v120, s[8:11], s34 offen sc1
    s_mov_b64 exec, -1
L_pq_Q_pp0_np:
    s_lshl_b32 s28, s31, 18
    s_add_u32 s28, s28, s32
    s_add_u32 s31, s31, 4
    s_cmp_ge_u32 s31, 64
    s_cbranch_scc1 L_pq_Q_nx0
    s_lshl_b32 s25, s31, 15
    s_lshl_b32 s26, s24, 13
    s_add_u32 s25, s25, s26
    s_mul_i32 s26, s24, 8320
    s_add_u32 s26, s26, 33280
    s_add_u32 m0, s26, 0
    s_add_u32 s27, s25, 0
    buffer_load_dwordx4 v4, s[12:15], s27 offen lds
    s_add_u32 m0, s26, 1040
    s_add_u32 s27, s25, 1024
    buffer_load_dwordx4 v4, s[12:15], s27 offen lds
    s_add_u32 m0, s26, 2080
    s_add_u32 s27, s25, 2048
    buffer_load_dwordx4 v4, s[12:15], s27 offen lds
    s_add_u32 m0, s26, 3120
    s_add_u32 s27, s25, 3072
    buffer_load_dwordx4 v4, s[12:15], s27 offen lds
    s_add_u32 m0, s26, 4160
    s_add_u32 s27, s25, 4096
    buffer_load_dwordx4 v4, s[12:15], s27 offen lds
    s_add_u32 m0, s26, 5200
    s_add_u32 s27, s25, 5120
    buffer_load_dwordx4 v4, s[12:15], s27 offen lds
    s_add_u32 m0, s26, 6240
    s_add_u32 s27, s25, 6144
    buffer_load_dwordx4 v4, s[12:15], s27 offen lds
    s_add_u32 m0, s26, 7280
    s_add_u32 s27, s25, 7168
    buffer_load_dwordx4 v4, s[12:15], s27 offen lds
L_pq_Q_nx0:
    ds_read_b128 v[64:67], v6 offset:0
    ds_read_b128 v[68:71], v6 offset:32
    ds_read_b128 v[72:75], v6 offset:64
    ds_read_b128 v[76:79], v6 offset:96
    ds_read_b128 v[80:83], v6 offset:128
    ds_read_b128 v[84:87], v6 offset:160
    ds_read_b128 v[88:91], v6 offset:192
    ds_read_b128 v[92:95], v6 offset:224
    s_waitcnt lgkmcnt(7)
    v_mfma_f32_32x32x16_bf16 v[32:47], a[0:3], v[64:67], 0
    v_mfma_f32_32x32x16_bf16 v[48:63], a[128:131], v[64:67], 0
    ds_read_b128 v[64:67], v6 offset:256
    s_waitcnt lgkmcnt(7)
    v_mfma_f32_32x32x16_bf16 v[32:47], a[4:7], v[68:71], v[32:47]
    v_mfma_f32_32x32x16_bf16 v[48:63], a[132:135], v[68:71], v[48:63]
    ds_read_b128 v[68:71], v6 offset:288
    s_waitcnt lgkmcnt(7)
    v_mfma_f32_32x32x16_bf16 v[32:47], a[8:11], v[72:75], v[32:47]
    v_mfma_f32_32x32x16_bf16 v[48:63], a[136:139], v[72:75], v[48:63]
    ds_read_b128 v[72:75], v6 offset:320
    s_waitcnt lgkmcnt(7)
    v_mfma_f32_32x32x16_bf16 v[32:47], a[12:15], v[76:79], v[32:47]
    v_mfma_f32_32x32x16_bf16 v[48:63], a[140:143], v[76:79], v[48:63]
    ds_read_b128 v[76:79], v6 offset:352
    s_waitcnt lgkmcnt(7)
    v_mfma_f32_32x32x16_bf16 v[32:47], a[16:19], v[80:83], v[32:47]
    v_mfma_f32_32x32x16_bf16 v[48:63], a[144:147], v[80:83], v[48:63]
    ds_read_b128 v[80:83], v6 offset:384
    s_waitcnt lgkmcnt(7)
    v_mfma_f32_32x32x16_bf16 v[32:47], a[20:23], v[84:87], v[32:47]
    v_mfma_f32_32x32x16_bf16 v[48:63], a[148:151], v[84:87], v[48:63]
    ds_read_b128 v[84:87], v6 offset:416
    s_waitcnt lgkmcnt(7)
    v_mfma_f32_32x32x16_bf16 v[32:47], a[24:27], v[88:91], v[32:47]
    v_mfma_f32_32x32x16_bf16 v[48:63], a[152:155], v[88:91], v[48:63]
    ds_read_b128 v[88:91], v6 offset:448
    s_waitcnt lgkmcnt(7)
    v_mfma_f32_32x32x16_bf16 v[32:47], a[28:31], v[92:95], v[32:47]
    v_mfma_f32_32x32x16_bf16 v[48:63], a[156:159], v[92:95], v[48:63]
    ds_read_b128 v[92:95], v6 offset:480
    s_waitcnt lgkmcnt(7)
    v_mfma_f32_32x32x16_bf16 v[32:47], a[32:35], v[64:67], v[32:47]
    v_mfma_f32_32x32x16_bf16 v[48:63], a[160:163], v[64:67], v[48:63]
    ds_read_b128 v[64:67], v6 offset:512
    s_waitcnt lgkmcnt(7)
    v_mfma_f32_32x32x16_bf16 v[32:47], a[36:39], v[68:71], v[32:47]
    v_mfma_f32_32x32x16_bf16 v[48:63], a[164:167], v[68:71], v[48:63]
    ds_read_b128 v[68:71], v6 offset:544
    s_waitcnt lgkmcnt(7)
    v_mfma_f32_32x32x16_bf16 v[32:47], a[40:43], v[72:75], v[32:47]
    v_mfma_f32_32x32x16_bf16 v[48:63], a[168:171], v[72:75], v[48:63]
    ds_read_b128 v[72:75], v6 offset:576
    s_waitcnt lgkmcnt(7)
    v_mfma_f32_32x32x16_bf16 v[32:47], a[44:47], v[76:79], v[32:47]
    v_mfma_f32_32x32x16_bf16 v[48:63], a[172:175], v[76:79], v[48:63]
    ds_read_b128 v[76:79], v6 offset:608
    s_waitcnt lgkmcnt(7)
    v_mfma_f32_32x32x16_bf16 v[32:47], a[48:51], v[80:83], v[32:47]
    v_mfma_f32_32x32x16_bf16 v[48:63], a[176:179], v[80:83], v[48:63]
    ds_read_b128 v[80:83], v6 offset:640
    s_waitcnt lgkmcnt(7)
    v_mfma_f32_32x32x16_bf16 v[32:47], a[52:55], v[84:87], v[32:47]
    v_mfma_f32_32x32x16_bf16 v[48:63], a[180:183], v[84:87], v[48:63]
    ds_read_b128 v[84:87], v6 offset:672
    s_waitcnt lgkmcnt(7)
    v_mfma_f32_32x32x16_bf16 v[32:47], a[56:59], v[88:91], v[32:47]
    v_mfma_f32_32x32x16_bf16 v[48:63], a[184:187], v[88:91], v[48:63]
    ds_read_b128 v[88:91], v6 offset:704
    s_waitcnt lgkmcnt(7)
    v_mfma_f32_32x32x16_bf16 v[32:47], a[60:63], v[92:95], v[32:47]
    v_mfma_f32_32x32x16_bf16 v[48:63], a[188:191], v[92:95], v[48:63]
    ds_read_b128 v[92:95], v6 offset:736
    s_waitcnt lgkmcnt(7)
    v_mfma_f32_32x32x16_bf16 v[32:47], a[64:67], v[64:67], v[32:47]
    v_mfma_f32_32x32x16_bf16 v[48:63], a[192:195], v[64:67], v[48:63]
    ds_read_b128 v[64:67], v6 offset:768
    s_waitcnt lgkmcnt(7)
    v_mfma_f32_32x32x16_bf16 v[32:47], a[68:71], v[68:71], v[32:47]
    v_mfma_f32_32x32x16_bf16 v[48:63], a[196:199], v[68:71], v[48:63]
    ds_read_b128 v[68:71], v6 offset:800
    s_waitcnt lgkmcnt(7)
    v_mfma_f32_32x32x16_bf16 v[32:47], a[72:75], v[72:75], v[32:47]
    v_mfma_f32_32x32x16_bf16 v[48:63], a[200:203], v[72:75], v[48:63]
    ds_read_b128 v[72:75], v6 offset:832
    s_waitcnt lgkmcnt(7)
    v_mfma_f32_32x32x16_bf16 v[32:47], a[76:79], v[76:79], v[32:47]
    v_mfma_f32_32x32x16_bf16 v[48:63], a[204:207], v[76:79], v[48:63]
    ds_read_b128 v[76:79], v6 offset:864
    s_waitcnt lgkmcnt(7)
    v_mfma_f32_32x32x16_bf16 v[32:47], a[80:83], v[80:83], v[32:47]
    v_mfma_f32_32x32x16_bf16 v[48:63], a[208:211], v[80:83], v[48:63]
    ds_read_b128 v[80:83], v6 offset:896
    s_waitcnt lgkmcnt(7)
    v_mfma_f32_32x32x16_bf16 v[32:47], a[84:87], v[84:87], v[32:47]
    v_mfma_f32_32x32x16_bf16 v[48:63], a[212:215], v[84:87], v[48:63]
    ds_read_b128 v[84:87], v6 offset:928
    s_waitcnt lgkmcnt(7)
    v_mfma_f32_32x32x16_bf16 v[32:47], a[88:91], v[88:91], v[32:47]
    v_mfma_f32_32x32x16_bf16 v[48:63], a[216:219], v[88:91], v[48:63]
    ds_read_b128 v[88:91], v6 offset:960
    s_waitcnt lgkmcnt(7)
    v_mfma_f32_32x32x16_bf16 v[32:47], a[92:95], v[92:95], v[32:47]
    v_mfma_f32_32x32x16_bf16 v[48:63], a[220:223], v[92:95], v[48:63]
    ds_read_b128 v[92:95], v6 offset:992
    s_waitcnt lgkmcnt(7)
    v_mfma_f32_32x32x16_bf16 v[32:47], a[96:99], v[64:67], v[32:47]
    v_mfma_f32_32x32x16_bf16 v[48:63], a[224:227], v[64:67], v[48:63]
    s_waitcnt lgkmcnt(6)
    v_mfma_f32_32x32x16_bf16 v[32:47], a[100:103], v[68:71], v[32:47]
    v_mfma_f32_32x32x16_bf16 v[48:63], a[228:231], v[68:71], v[48:63]
    s_waitcnt lgkmcnt(5)
    v_mfma_f32_32x32x16_bf16 v[32:47], a[104:107], v[72:75], v[32:47]
    v_mfma_f32_32x32x16_bf16 v[48:63], a[232:235], v[72:75], v[48:63]
    s_waitcnt lgkmcnt(4)
    v_mfma_f32_32x32x16_bf16 v[32:47], a[108:111], v[76:79], v[32:47]
    v_mfma_f32_32x32x16_bf16 v[48:63], a[236:239], v[76:79], v[48:63]
    s_waitcnt lgkmcnt(3)
    v_mfma_f32_32x32x16_bf16 v[32:47], a[112:115], v[80:83], v[32:47]
    v_mfma_f32_32x32x16_bf16 v[48:63], a[240:243], v[80:83], v[48:63]
    s_waitcnt lgkmcnt(2)
    v_mfma_f32_32x32x16_bf16 v[32:47], a[116:119], v[84:87], v[32:47]
    v_mfma_f32_32x32x16_bf16 v[48:63], a[244:247], v[84:87], v[48:63]
    s_waitcnt lgkmcnt(1)
    v_mfma_f32_32x32x16_bf16 v[32:47], a[120:123], v[88:91], v[32:47]
    v_mfma_f32_32x32x16_bf16 v[48:63], a[248:251], v[88:91], v[48:63]
    s_waitcnt lgkmcnt(0)
    v_mfma_f32_32x32x16_bf16 v[32:47], a[124:127], v[92:95], v[32:47]
    v_mfma_f32_32x32x16_bf16 v[48:63], a[252:255], v[92:95], v[48:63]
    s_nop 15
    v_cvt_pk_bf16_f32 v96, v32, v40
    v_cvt_pk_bf16_f32 v97, v33, v41
    v_cvt_pk_bf16_f32 v98, v34, v42
    v_cvt_pk_bf16_f32 v99, v35, v43
    buffer_store_dwordx4 v[96:99], v8, s[8:11], s28 offen offset:0 sc1
    v_cvt_pk_bf16_f32 v100, v36, v44
    v_cvt_pk_bf16_f32 v101, v37, v45
    v_cvt_pk_bf16_f32 v102, v38, v46
    v_cvt_pk_bf16_f32 v103, v39, v47
    buffer_store_dwordx4 v[100:103], v8, s[8:11], s28 offen offset:512 sc1
    v_cvt_pk_bf16_f32 v104, v48, v56
    v_cvt_pk_bf16_f32 v105, v49, v57
    v_cvt_pk_bf16_f32 v106, v50, v58
    v_cvt_pk_bf16_f32 v107, v51, v59
    buffer_store_dwordx4 v[104:107], v8, s[8:11], s28 offen offset:1024 sc1
    v_cvt_pk_bf16_f32 v108, v52, v60
    v_cvt_pk_bf16_f32 v109, v53, v61
    v_cvt_pk_bf16_f32 v110, v54, v62
    v_cvt_pk_bf16_f32 v111, v55, v63
    buffer_store_dwordx4 v[108:111], v8, s[8:11], s28 offen offset:1536 sc1
    s_add_u32 s33, s33, 1
    s_cmp_ge_u32 s33, 16
    s_cbranch_scc1 L_pq_Q_fin
    s_cmp_eq_u32 s33, 0
    s_cbranch_scc1 L_pq_Q_w0_1
    s_waitcnt vmcnt(4)
    s_branch L_pq_Q_w1_1
L_pq_Q_w0_1:
    s_waitcnt vmcnt(0)
L_pq_Q_w1_1:
    s_barrier
    s_cmp_lt_u32 s33, 2
    s_cbranch_scc1 L_pq_Q_pp1_np
    s_sub_u32 s36, s33, 1
    s_cmp_lg_u32 s24, 0
    s_cbranch_scc1 L_pq_Q_pp1_np
    s_mov_b64 exec, 1
    v_mov_b32 v120, 0
    v_mov_b32 v121, s36
    buffer_store_dword v121, v120, s[8:11], s34 offen sc1
    s_mov_b64 exec, -1
L_pq_Q_pp1_np:
    s_lshl_b32 s28, s31, 18
    s_add_u32 s28, s28, s32
    s_add_u32 s31, s31, 4
    s_cmp_ge_u32 s31, 64
    s_cbranch_scc1 L_pq_Q_nx1
    s_lshl_b32 s25, s31, 15
    s_lshl_b32 s26, s24, 13
    s_add_u32 s25, s25, s26
    s_mul_i32 s26, s24, 8320
    s_add_u32 s26, s26, 0
    s_add_u32 m0, s26, 0
    s_add_u32 s27, s25, 0
    buffer_load_dwordx4 v4, s[12:15], s27 offen lds
    s_add_u32 m0, s26, 1040
    s_add_u32 s27, s25, 1024
    buffer_load_dwordx4 v4, s[12:15], s27 offen lds
    s_add_u32 m0, s26, 2080
    s_add_u32 s27, s25, 2048
    buffer_load_dwordx4 v4, s[12:15], s27 offen lds
    s_add_u32 m0, s26, 3120
    s_add_u32 s27, s25, 3072
    buffer_load_dwordx4 v4, s[12:15], s27 offen lds
    s_add_u32 m0, s26, 4160
    s_add_u32 s27, s25, 4096
    buffer_load_dwordx4 v4, s[12:15], s27 offen lds
    s_add_u32 m0, s26, 5200
    s_add_u32 s27, s25, 5120
    buffer_load_dwordx4 v4, s[12:15], s27 offen lds
    s_add_u32 m0, s26, 6240
    s_add_u32 s27, s25, 6144
    buffer_load_dwordx4 v4, s[12:15], s27 offen lds
    s_add_u32 m0, s26, 7280
    s_add_u32 s27, s25, 7168
    buffer_load_dwordx4 v4, s[12:15], s27 offen lds
L_pq_Q_nx1:
    ds_read_b128 v[64:67], v6 offset:33280
    ds_read_b128 v[68:71], v6 offset:33312
    ds_read_b128 v[72:75], v6 offset:33344
    ds_read_b128 v[76:79], v6 offset:33376
    ds_read_b128 v[80:83], v6 offset:33408
    ds_read_b128 v[84:87], v6 offset:33440
    ds_read_b128 v[88:91], v6 offset:33472
    ds_read_b128 v[92:95], v6 offset:33504
    s_waitcnt lgkmcnt(7)
    v_mfma_f32_32x32x16_bf16 v[32:47], a[0:3], v[64:67], 0
    v_mfma_f32_32x32x16_bf16 v[48:63], a[128:131], v[64:67], 0
    ds_read_b128 v[64:67], v6 offset:33536
    s_waitcnt lgkmcnt(7)
    v_mfma_f32_32x32x16_bf16 v[32:47], a[4:7], v[68:71], v[32:47]
    v_mfma_f32_32x32x16_bf16 v[48:63], a[132:135], v[68:71], v[48:63]
    ds_read_b128 v[68:71], v6 offset:33568
    s_waitcnt lgkmcnt(7)
    v_mfma_f32_32x32x16_bf16 v[32:47], a[8:11], v[72:75], v[32:47]
    v_mfma_f32_32x32x16_bf16 v[48:63], a[136:139], v[72:75], v[48:63]
    ds_read_b128 v[72:75], v6 offset:33600
    s_waitcnt lgkmcnt(7)
    v_mfma_f32_32x32x16_bf16 v[32:47], a[12:15], v[76:79], v[32:47]
    v_mfma_f32_32x32x16_bf16 v[48:63], a[140:143], v[76:79], v[48:63]
    ds_read_b128 v[76:79], v6 offset:33632
    s_waitcnt lgkmcnt(7)
    v_mfma_f32_32x32x16_bf16 v[32:47], a[16:19], v[80:83], v[32:47]
    v_mfma_f32_32x32x16_bf16 v[48:63], a[144:147], v[80:83], v[48:63]
    ds_read_b128 v[80:83], v6 offset:33664
    s_waitcnt lgkmcnt(7)
    v_mfma_f32_32x32x16_bf16 v[32:47], a[20:23], v[84:87], v[32:47]
    v_mfma_f32_32x32x16_bf16 v[48:63], a[148:151], v[84:87], v[48:63]
    ds_read_b128 v[84:87], v6 offset:33696
    s_waitcnt lgkmcnt(7)
    v_mfma_f32_32x32x16_bf16 v[32:47], a[24:27], v[88:91], v[32:47]
    v_mfma_f32_32x32x16_bf16 v[48:63], a[152:155], v[88:91], v[48:63]
    ds_read_b128 v[88:91], v6 offset:33728
    s_waitcnt lgkmcnt(7)
    v_mfma_f32_32x32x16_bf16 v[32:47], a[28:31], v[92:95], v[32:47]
    v_mfma_f32_32x32x16_bf16 v[48:63], a[156:159], v[92:95], v[48:63]
    ds_read_b128 v[92:95], v6 offset:33760
    s_waitcnt lgkmcnt(7)
    v_mfma_f32_32x32x16_bf16 v[32:47], a[32:35], v[64:67], v[32:47]
    v_mfma_f32_32x32x16_bf16 v[48:63], a[160:163], v[64:67], v[48:63]
    ds_read_b128 v[64:67], v6 offset:33792
    s_waitcnt lgkmcnt(7)
    v_mfma_f32_32x32x16_bf16 v[32:47], a[36:39], v[68:71], v[32:47]
    v_mfma_f32_32x32x16_bf16 v[48:63], a[164:167], v[68:71], v[48:63]
    ds_read_b128 v[68:71], v6 offset:33824
    s_waitcnt lgkmcnt(7)
    v_mfma_f32_32x32x16_bf16 v[32:47], a[40:43], v[72:75], v[32:47]
    v_mfma_f32_32x32x16_bf16 v[48:63], a[168:171], v[72:75], v[48:63]
    ds_read_b128 v[72:75], v6 offset:33856
    s_waitcnt lgkmcnt(7)
    v_mfma_f32_32x32x16_bf16 v[32:47], a[44:47], v[76:79], v[32:47]
    v_mfma_f32_32x32x16_bf16 v[48:63], a[172:175], v[76:79], v[48:63]
    ds_read_b128 v[76:79], v6 offset:33888
    s_waitcnt lgkmcnt(7)
    v_mfma_f32_32x32x16_bf16 v[32:47], a[48:51], v[80:83], v[32:47]
    v_mfma_f32_32x32x16_bf16 v[48:63], a[176:179], v[80:83], v[48:63]
    ds_read_b128 v[80:83], v6 offset:33920
    s_waitcnt lgkmcnt(7)
    v_mfma_f32_32x32x16_bf16 v[32:47], a[52:55], v[84:87], v[32:47]
    v_mfma_f32_32x32x16_bf16 v[48:63], a[180:183], v[84:87], v[48:63]
    ds_read_b128 v[84:87], v6 offset:33952
    s_waitcnt lgkmcnt(7)
    v_mfma_f32_32x32x16_bf16 v[32:47], a[56:59], v[88:91], v[32:47]
    v_mfma_f32_32x32x16_bf16 v[48:63], a[184:187], v[88:91], v[48:63]
    ds_read_b128 v[88:91], v6 offset:33984
    s_waitcnt lgkmcnt(7)
    v_mfma_f32_32x32x16_bf16 v[32:47], a[60:63], v[92:95], v[32:47]
    v_mfma_f32_32x32x16_bf16 v[48:63], a[188:191], v[92:95], v[48:63]
    ds_read_b128 v[92:95], v6 offset:34016
    s_waitcnt lgkmcnt(7)
    v_mfma_f32_32x32x16_bf16 v[32:47], a[64:67], v[64:67], v[32:47]
    v_mfma_f32_32x32x16_bf16 v[48:63], a[192:195], v[64:67], v[48:63]
    ds_read_b128 v[64:67], v6 offset:34048
    s_waitcnt lgkmcnt(7)
    v_mfma_f32_32x32x16_bf16 v[32:47], a[68:71], v[68:71], v[32:47]
    v_mfma_f32_32x32x16_bf16 v[48:63], a[196:199], v[68:71], v[48:63]
    ds_read_b128 v[68:71], v6 offset:34080
    s_waitcnt lgkmcnt(7)
    v_mfma_f32_32x32x16_bf16 v[32:47], a[72:75], v[72:75], v[32:47]
    v_mfma_f32_32x32x16_bf16 v[48:63], a[200:203], v[72:75], v[48:63]
    ds_read_b128 v[72:75], v6 offset:34112
    s_waitcnt lgkmcnt(7)
    v_mfma_f32_32x32x16_bf16 v[32:47], a[76:79], v[76:79], v[32:47]
    v_mfma_f32_32x32x16_bf16 v[48:63], a[204:207], v[76:79], v[48:63]
    ds_read_b128 v[76:79], v6 offset:34144
    s_waitcnt lgkmcnt(7)
    v_mfma_f32_32x32x16_bf16 v[32:47], a[80:83], v[80:83], v[32:47]
    v_mfma_f32_32x32x16_bf16 v[48:63], a[208:211], v[80:83], v[48:63]
    ds_read_b128 v[80:83], v6 offset:34176
    s_waitcnt lgkmcnt(7)
    v_mfma_f32_32x32x16_bf16 v[32:47], a[84:87], v[84:87], v[32:47]
    v_mfma_f32_32x32x16_bf16 v[48:63], a[212:215], v[84:87], v[48:63]
    ds_read_b128 v[84:87], v6 offset:34208
    s_waitcnt lgkmcnt(7)
    v_mfma_f32_32x32x16_bf16 v[32:47], a[88:91], v[88:91], v[32:47]
    v_mfma_f32_32x32x16_bf16 v[48:63], a[216:219], v[88:91], v[48:63]
    ds_read_b128 v[88:91], v6 offset:34240
    s_waitcnt lgkmcnt(7)
    v_mfma_f32_32x32x16_bf16 v[32:47], a[92:95], v[92:95], v[32:47]
    v_mfma_f32_32x32x16_bf16 v[48:63], a[220:223], v[92:95], v[48:63]
    ds_read_b128 v[92:95], v6 offset:34272
    s_waitcnt lgkmcnt(7)
    v_mfma_f32_32x32x16_bf16 v[32:47], a[96:99], v[64:67], v[32:47]
    v_mfma_f32_32x32x16_bf16 v[48:63], a[224:227], v[64:67], v[48:63]
    s_waitcnt lgkmcnt(6)
    v_mfma_f32_32x32x16_bf16 v[32:47], a[100:103], v[68:71], v[32:47]
    v_mfma_f32_32x32x16_bf16 v[48:63], a[228:231], v[68:71], v[48:63]
    s_waitcnt lgkmcnt(5)
    v_mfma_f32_32x32x16_bf16 v[32:47], a[104:107], v[72:75], v[32:47]
    v_mfma_f32_32x32x16_bf16 v[48:63], a[232:235], v[72:75], v[48:63]
    s_waitcnt lgkmcnt(4)
    v_mfma_f32_32x32x16_bf16 v[32:47], a[108:111], v[76:79], v[32:47]
    v_mfma_f32_32x32x16_bf16 v[48:63], a[236:239], v[76:79], v[48:63]
    s_waitcnt lgkmcnt(3)
    v_mfma_f32_32x32x16_bf16 v[32:47], a[112:115], v[80:83], v[32:47]
    v_mfma_f32_32x32x16_bf16 v[48:63], a[240:243], v[80:83], v[48:63]
    s_waitcnt lgkmcnt(2)
    v_mfma_f32_32x32x16_bf16 v[32:47], a[116:119], v[84:87], v[32:47]
    v_mfma_f32_32x32x16_bf16 v[48:63], a[244:247], v[84:87], v[48:63]
    s_waitcnt lgkmcnt(1)
    v_mfma_f32_32x32x16_bf16 v[32:47], a[120:123], v[88:91], v[32:47]
    v_mfma_f32_32x32x16_bf16 v[48:63], a[248:251], v[88:91], v[48:63]
    s_waitcnt lgkmcnt(0)
    v_mfma_f32_32x32x16_bf16 v[32:47], a[124:127], v[92:95], v[32:47]
    v_mfma_f32_32x32x16_bf16 v[48:63], a[252:255], v[92:95], v[48:63]
    s_nop 15
    v_cvt_pk_bf16_f32 v96, v32, v40
    v_cvt_pk_bf16_f32 v97, v33, v41
    v_cvt_pk_bf16_f32 v98, v34, v42
    v_cvt_pk_bf16_f32 v99, v35, v43
    buffer_store_dwordx4 v[96:99], v8, s[8:11], s28 offen offset:0 sc1
    v_cvt_pk_bf16_f32 v100, v36, v44
    v_cvt_pk_bf16_f32 v101, v37, v45
    v_cvt_pk_bf16_f32 v102, v38, v46
    v_cvt_pk_bf16_f32 v103, v39, v47
    buffer_store_dwordx4 v[100:103], v8, s[8:11], s28 offen offset:512 sc1
    v_cvt_pk_bf16_f32 v104, v48, v56
    v_cvt_pk_bf16_f32 v105, v49, v57
    v_cvt_pk_bf16_f32 v106, v50, v58
    v_cvt_pk_bf16_f32 v107, v51, v59
    buffer_store_dwordx4 v[104:107], v8, s[8:11], s28 offen offset:1024 sc1
    v_cvt_pk_bf16_f32 v108, v52, v60
    v_cvt_pk_bf16_f32 v109, v53, v61
    v_cvt_pk_bf16_f32 v110, v54, v62
    v_cvt_pk_bf16_f32 v111, v55, v63
    buffer_store_dwordx4 v[108:111], v8, s[8:11], s28 offen offset:1536 sc1
    s_add_u32 s33, s33, 1
    s_cmp_ge_u32 s33, 16
    s_cbranch_scc1 L_pq_Q_fin
    s_branch L_pq_Q_loop
L_pq_Q_fin:
    s_waitcnt vmcnt(0)
    s_barrier
    s_cmp_lg_u32 s24, 0
    s_cbranch_scc1 L_pq_Q_ppf_np
    s_mov_b64 exec, 1
    v_mov_b32 v120, 0
    v_mov_b32 v121, s33
    buffer_store_dword v121, v120, s[8:11], s34 offen sc1
    s_mov_b64 exec, -1
L_pq_Q_ppf_np:
L_pq_end:
    s_branch L_phase2
L_p_kv:
    s_lshr_b32 s30, s60, 2
    v_and_b32 v1, 63, v0
    v_and_b32 v2, 31, v1
    v_lshrrev_b32 v3, 5, v1
    v_lshlrev_b32 v4, 4, v1
    s_cmp_lt_u32 s24, 2
    s_cselect_b32 s25, 24, 32
    s_load_dwordx2 s[16:17], s[0:1], s25
    s_mov_b32 s18, 0x400000
    s_mov_b32 s19, 0x20000
    s_lshl_b32 s26, s30, 8
    s_waitcnt lgkmcnt(0)
    s_and_b32 s25, s24, 1
    s_lshl_b32 s25, s25, 7
    s_add_u32 s26, s26, s25
    v_lshrrev_b32 v5, 3, v1
    v_lshlrev_b32 v5, 13, v5
    v_and_b32 v6, 7, v1
    v_lshlrev_b32 v6, 4, v6
    v_add3_u32 v5, v5, v6, s26
    v_and_b32 v6, 15, v1
    v_lshrrev_b32 v7, 2, v6
    v_and_b32 v6, 3, v6
    v_lshrrev_b32 v8, 5, v1
    v_lshlrev_b32 v8, 3, v8
    v_add_u32 v7, v7, v8
    v_lshlrev_b32 v7, 7, v7
    v_bfe_u32 v8, v1, 4, 1
    v_lshlrev_b32 v8, 5, v8
    v_lshlrev_b32 v6, 3, v6
    v_add3_u32 v7, v7, v8, v6
    s_lshl_b32 s27, s24, 15
    v_add_u32 v7, s27, v7
    s_add_u32 m0, s27, 0
    s_mov_b32 s28, 0
    buffer_load_dwordx4 v5, s[16:19], s28 offen lds
    s_add_u32 m0, s27, 1024
    s_mov_b32 s28, 65536
    buffer_load_dwordx4 v5, s[16:19], s28 offen lds
    s_add_u32 m0, s27, 2048
    s_mov_b32 s28, 131072
    buffer_load_dwordx4 v5, s[16:19], s28 offen lds
    s_add_u32 m0, s27, 3072
    s_mov_b32 s28, 196608
    buffer_load_dwordx4 v5, s[16:19], s28 offen lds
    s_add_u32 m0, s27, 4096
    s_mov_b32 s28, 262144
    buffer_load_dwordx4 v5, s[16:19], s28 offen lds
    s_add_u32 m0, s27, 5120
    s_mov_b32 s28, 327680
    buffer_load_dwordx4 v5, s[16:19], s28 offen lds
    s_add_u32 m0, s27, 6144
    s_mov_b32 s28, 393216
    buffer_load_dwordx4 v5, s[16:19], s28 offen lds
    s_add_u32 m0, s27, 7168
    s_mov_b32 s28, 458752
    buffer_load_dwordx4 v5, s[16:19], s28 offen lds
    s_add_u32 m0, s27, 8192
    s_mov_b32 s28, 524288
    buffer_load_dwordx4 v5, s[16:19], s28 offen lds
    s_add_u32 m0, s27, 9216
    s_mov_b32 s28, 589824
    buffer_load_dwordx4 v5, s[16:19], s28 offen lds
    s_add_u32 m0, s27, 10240
    s_mov_b32 s28, 655360
    buffer_load_dwordx4 v5, s[16:19], s28 offen lds
    s_add_u32 m0, s27, 11264
    s_mov_b32 s28, 720896
    buffer_load_dwordx4 v5, s[16:19], s28 offen lds
    s_add_u32 m0, s27, 12288
    s_mov_b32 s28, 786432
    buffer_load_dwordx4 v5, s[16:19], s28 offen lds
    s_add_u32 m0, s27, 13312
    s_mov_b32 s28, 851968
    buffer_load_dwordx4 v5, s[16:19], s28 offen lds
    s_add_u32 m0, s27, 14336
    s_mov_b32 s28, 917504
    buffer_load_dwordx4 v5, s[16:19], s28 offen lds
    s_add_u32 m0, s27, 15360
    s_mov_b32 s28, 983040
    buffer_load_dwordx4 v5, s[16:19], s28 offen lds
    s_add_u32 m0, s27, 16384
    s_mov_b32 s28, 1048576
    buffer_load_dwordx4 v5, s[16:19], s28 offen lds
    s_add_u32 m0, s27, 17408
    s_mov_b32 s28, 1114112
    buffer_load_dwordx4 v5, s[16:19], s28 offen lds
    s_add_u32 m0, s27, 18432
    s_mov_b32 s28, 1179648
    buffer_load_dwordx4 v5, s[16:19], s28 offen lds
    s_add_u32 m0, s27, 19456
    s_mov_b32 s28, 1245184
    buffer_load_dwordx4 v5, s[16:19], s28 offen lds
    s_add_u32 m0, s27, 20480
    s_mov_b32 s28, 1310720
    buffer_load_dwordx4 v5, s[16:19], s28 offen lds
    s_add_u32 m0, s27, 21504
    s_mov_b32 s28, 1376256
    buffer_load_dwordx4 v5, s[16:19], s28 offen lds
    s_add_u32 m0, s27, 22528
    s_mov_b32 s28, 1441792
    buffer_load_dwordx4 v5, s[16:19], s28 offen lds
    s_add_u32 m0, s27, 23552
    s_mov_b32 s28, 1507328
    buffer_load_dwordx4 v5, s[16:19], s28 offen lds
    s_add_u32 m0, s27, 24576
    s_mov_b32 s28, 1572864
    buffer_load_dwordx4 v5, s[16:19], s28 offen lds
    s_add_u32 m0, s27, 25600
    s_mov_b32 s28, 1638400
    buffer_load_dwordx4 v5, s[16:19], s28 offen lds
    s_add_u32 m0, s27, 26624
    s_mov_b32 s28, 1703936
    buffer_load_dwordx4 v5, s[16:19], s28 offen lds
    s_add_u32 m0, s27, 27648
    s_mov_b32 s28, 1769472
    buffer_load_dwordx4 v5, s[16:19], s28 offen lds
    s_add_u32 m0, s27, 28672
    s_mov_b32 s28, 1835008
    buffer_load_dwordx4 v5, s[16:19], s28 offen lds
    s_add_u32 m0, s27, 29696
    s_mov_b32 s28, 1900544
    buffer_load_dwordx4 v5, s[16:19], s28 offen lds
    s_add_u32 m0, s27, 30720
    s_mov_b32 s28, 1966080
    buffer_load_dwordx4 v5, s[16:19], s28 offen lds
    s_add_u32 m0, s27, 31744
    s_mov_b32 s28, 2031616
    buffer_load_dwordx4 v5, s[16:19], s28 offen lds
    s_waitcnt vmcnt(16)
    ds_read_b64_tr_b16 a[0:1], v7 offset:0
    ds_read_b64_tr_b16 a[2:3], v7 offset:512
    ds_read_b64_tr_b16 a[128:129], v7 offset:64
    ds_read_b64_tr_b16 a[130:131], v7 offset:576
    ds_read_b64_tr_b16 a[4:5], v7 offset:2048
    ds_read_b64_tr_b16 a[6:7], v7 offset:2560
    ds_read_b64_tr_b16 a[132:133], v7 offset:2112
    ds_read_b64_tr_b16 a[134:135], v7 offset:2624
    s_waitcnt lgkmcnt(4)
    ds_read_b64_tr_b16 a[8:9], v7 offset:4096
    ds_read_b64_tr_b16 a[10:11], v7 offset:4608
    ds_read_b64_tr_b16 a[136:137], v7 offset:4160
    ds_read_b64_tr_b16 a[138:139], v7 offset:4672
    ds_read_b64_tr_b16 a[12:13], v7 offset:6144
    ds_read_b64_tr_b16 a[14:15], v7 offset:6656
    ds_read_b64_tr_b16 a[140:141], v7 offset:6208
    ds_read_b64_tr_b16 a[142:143], v7 offset:6720
    s_waitcnt lgkmcnt(4)
    ds_read_b64_tr_b16 a[16:17], v7 offset:8192
    ds_read_b64_tr_b16 a[18:19], v7 offset:8704
    ds_read_b64_tr_b16 a[144:145], v7 offset:8256
    ds_read_b64_tr_b16 a[146:147], v7 offset:8768
    ds_read_b64_tr_b16 a[20:21], v7 offset:10240
    ds_read_b64_tr_b16 a[22:23], v7 offset:10752
    ds_read_b64_tr_b16 a[148:149], v7 offset:10304
    ds_read_b64_tr_b16 a[150:151], v7 offset:10816
    s_waitcnt lgkmcnt(4)
    ds_read_b64_tr_b16 a[24:25], v7 offset:12288
    ds_read_b64_tr_b16 a[26:27], v7 offset:12800
    ds_read_b64_tr_b16 a[152:153], v7 offset:12352
    ds_read_b64_tr_b16 a[154:155], v7 offset:12864
    ds_read_b64_tr_b16 a[28:29], v7 offset:14336
    ds_read_b64_tr_b16 a[30:31], v7 offset:14848
    ds_read_b64_tr_b16 a[156:157], v7 offset:14400
    ds_read_b64_tr_b16 a[158:159], v7 offset:14912
    s_waitcnt lgkmcnt(4)
    s_waitcnt lgkmcnt(0)
    s_add_u32 m0, s27, 0
    s_mov_b32 s28, 2097152
    buffer_load_dwordx4 v5, s[16:19], s28 offen lds
    s_add_u32 m0, s27, 1024
    s_mov_b32 s28, 2162688
    buffer_load_dwordx4 v5, s[16:19], s28 offen lds
    s_add_u32 m0, s27, 2048
    s_mov_b32 s28, 2228224
    buffer_load_dwordx4 v5, s[16:19], s28 offen lds
    s_add_u32 m0, s27, 3072
    s_mov_b32 s28, 2293760
    buffer_load_dwordx4 v5, s[16:19], s28 offen lds
    s_add_u32 m0, s27, 4096
    s_mov_b32 s28, 2359296
    buffer_load_dwordx4 v5, s[16:19], s28 offen lds
    s_add_u32 m0, s27, 5120
    s_mov_b32 s28, 2424832
    buffer_load_dwordx4 v5, s[16:19], s28 offen lds
    s_add_u32 m0, s27, 6144
    s_mov_b32 s28, 2490368
    buffer_load_dwordx4 v5, s[16:19], s28 offen lds
    s_add_u32 m0, s27, 7168
    s_mov_b32 s28, 2555904
    buffer_load_dwordx4 v5, s[16:19], s28 offen lds
    s_add_u32 m0, s27, 8192
    s_mov_b32 s28, 2621440
    buffer_load_dwordx4 v5, s[16:19], s28 offen lds
    s_add_u32 m0, s27, 9216
    s_mov_b32 s28, 2686976
    buffer_load_dwordx4 v5, s[16:19], s28 offen lds
    s_add_u32 m0, s27, 10240
    s_mov_b32 s28, 2752512
    buffer_load_dwordx4 v5, s[16:19], s28 offen lds
    s_add_u32 m0, s27, 11264
    s_mov_b32 s28, 2818048
    buffer_load_dwordx4 v5, s[16:19], s28 offen lds
    s_add_u32 m0, s27, 12288
    s_mov_b32 s28, 2883584
    buffer_load_dwordx4 v5, s[16:19], s28 offen lds
    s_add_u32 m0, s27, 13312
    s_mov_b32 s28, 2949120
    buffer_load_dwordx4 v5, s[16:19], s28 offen lds
    s_add_u32 m0, s27, 14336
    s_mov_b32 s28, 3014656
    buffer_load_dwordx4 v5, s[16:19], s28 offen lds
    s_add_u32 m0, s27, 15360
    s_mov_b32 s28, 3080192
    buffer_load_dwordx4 v5, s[16:19], s28 offen lds
    s_waitcnt vmcnt(16)
    ds_read_b64_tr_b16 a[32:33], v7 offset:16384
    ds_read_b64_tr_b16 a[34:35], v7 offset:16896
    ds_read_b64_tr_b16 a[160:161], v7 offset:16448
    ds_read_b64_tr_b16 a[162:163], v7 offset:16960
    ds_read_b64_tr_b16 a[36:37], v7 offset:18432
    ds_read_b64_tr_b16 a[38:39], v7 offset:18944
    ds_read_b64_tr_b16 a[164:165], v7 offset:18496
    ds_read_b64_tr_b16 a[166:167], v7 offset:19008
    s_waitcnt lgkmcnt(4)
    ds_read_b64_tr_b16 a[40:41], v7 offset:20480
    ds_read_b64_tr_b16 a[42:43], v7 offset:20992
    ds_read_b64_tr_b16 a[168:169], v7 offset:20544
    ds_read_b64_tr_b16 a[170:171], v7 offset:21056
    ds_read_b64_tr_b16 a[44:45], v7 offset:22528
    ds_read_b64_tr_b16 a[46:47], v7 offset:23040
    ds_read_b64_tr_b16 a[172:173], v7 offset:22592
    ds_read_b64_tr_b16 a[174:175], v7 offset:23104
    s_waitcnt lgkmcnt(4)
    ds_read_b64_tr_b16 a[48:49], v7 offset:24576
    ds_read_b64_tr_b16 a[50:51], v7 offset:25088
    ds_read_b64_tr_b16 a[176:177], v7 offset:24640
    ds_read_b64_tr_b16 a[178:179], v7 offset:25152
    ds_read_b64_tr_b16 a[52:53], v7 offset:26624
    ds_read_b64_tr_b16 a[54:55], v7 offset:27136
    ds_read_b64_tr_b16 a[180:181], v7 offset:26688
    ds_read_b64_tr_b16 a[182:183], v7 offset:27200
    s_waitcnt lgkmcnt(4)
    ds_read_b64_tr_b16 a[56:57], v7 offset:28672
    ds_read_b64_tr_b16 a[58:59], v7 offset:29184
    ds_read_b64_tr_b16 a[184:185], v7 offset:28736
    ds_read_b64_tr_b16 a[186:187], v7 offset:29248
    ds_read_b64_tr_b16 a[60:61], v7 offset:30720
    ds_read_b64_tr_b16 a[62:63], v7 offset:31232
    ds_read_b64_tr_b16 a[188:189], v7 offset:30784
    ds_read_b64_tr_b16 a[190:191], v7 offset:31296
    s_waitcnt lgkmcnt(4)
    s_waitcnt lgkmcnt(0)
    s_add_u32 m0, s27, 16384
    s_mov_b32 s28, 3145728
    buffer_load_dwordx4 v5, s[16:19], s28 offen lds
    s_add_u32 m0, s27, 17408
    s_mov_b32 s28, 3211264
    buffer_load_dwordx4 v5, s[16:19], s28 offen lds
    s_add_u32 m0, s27, 18432
    s_mov_b32 s28, 3276800
    buffer_load_dwordx4 v5, s[16:19], s28 offen lds
    s_add_u32 m0, s27, 19456
    s_mov_b32 s28, 3342336
    buffer_load_dwordx4 v5, s[16:19], s28 offen lds
    s_add_u32 m0, s27, 20480
    s_mov_b32 s28, 3407872
    buffer_load_dwordx4 v5, s[16:19], s28 offen lds
    s_add_u32 m0, s27, 21504
    s_mov_b32 s28, 3473408
    buffer_load_dwordx4 v5, s[16:19], s28 offen lds
    s_add_u32 m0, s27, 22528
    s_mov_b32 s28, 3538944
    buffer_load_dwordx4 v5, s[16:19], s28 offen lds
    s_add_u32 m0, s27, 23552
    s_mov_b32 s28, 3604480
    buffer_load_dwordx4 v5, s[16:19], s28 offen lds
    s_add_u32 m0, s27, 24576
    s_mov_b32 s28, 3670016
    buffer_load_dwordx4 v5, s[16:19], s28 offen lds
    s_add_u32 m0, s27, 25600
    s_mov_b32 s28, 3735552
    buffer_load_dwordx4 v5, s[16:19], s28 offen lds
    s_add_u32 m0, s27, 26624
    s_mov_b32 s28, 3801088
    buffer_load_dwordx4 v5, s[16:19], s28 offen lds
    s_add_u32 m0, s27, 27648
    s_mov_b32 s28, 3866624
    buffer_load_dwordx4 v5, s[16:19], s28 offen lds
    s_add_u32 m0, s27, 28672
    s_mov_b32 s28, 3932160
    buffer_load_dwordx4 v5, s[16:19], s28 offen lds
    s_add_u32 m0, s27, 29696
    s_mov_b32 s28, 3997696
    buffer_load_dwordx4 v5, s[16:19], s28 offen lds
    s_add_u32 m0, s27, 30720
    s_mov_b32 s28, 4063232
    buffer_load_dwordx4 v5, s[16:19], s28 offen lds
    s_add_u32 m0, s27, 31744
    s_mov_b32 s28, 4128768
    buffer_load_dwordx4 v5, s[16:19], s28 offen lds
    s_waitcnt vmcnt(16)
    ds_read_b64_tr_b16 a[64:65], v7 offset:0
    ds_read_b64_tr_b16 a[66:67], v7 offset:512
    ds_read_b64_tr_b16 a[192:193], v7 offset:64
    ds_read_b64_tr_b16 a[194:195], v7 offset:576
    ds_read_b64_tr_b16 a[68:69], v7 offset:2048
    ds_read_b64_tr_b16 a[70:71], v7 offset:2560
    ds_read_b64_tr_b16 a[196:197], v7 offset:2112
    ds_read_b64_tr_b16 a[198:199], v7 offset:2624
    s_waitcnt lgkmcnt(4)
    ds_read_b64_tr_b16 a[72:73], v7 offset:4096
    ds_read_b64_tr_b16 a[74:75], v7 offset:4608
    ds_read_b64_tr_b16 a[200:201], v7 offset:4160
    ds_read_b64_tr_b16 a[202:203], v7 offset:4672
    ds_read_b64_tr_b16 a[76:77], v7 offset:6144
    ds_read_b64_tr_b16 a[78:79], v7 offset:6656
    ds_read_b64_tr_b16 a[204:205], v7 offset:6208
    ds_read_b64_tr_b16 a[206:207], v7 offset:6720
    s_waitcnt lgkmcnt(4)
    ds_read_b64_tr_b16 a[80:81], v7 offset:8192
    ds_read_b64_tr_b16 a[82:83], v7 offset:8704
    ds_read_b64_tr_b16 a[208:209], v7 offset:8256
    ds_read_b64_tr_b16 a[210:211], v7 offset:8768
    ds_read_b64_tr_b16 a[84:85], v7 offset:10240
    ds_read_b64_tr_b16 a[86:87], v7 offset:10752
    ds_read_b64_tr_b16 a[212:213], v7 offset:10304
    ds_read_b64_tr_b16 a[214:215], v7 offset:10816
    s_waitcnt lgkmcnt(4)
    ds_read_b64_tr_b16 a[88:89], v7 offset:12288
    ds_read_b64_tr_b16 a[90:91], v7 offset:12800
    ds_read_b64_tr_b16 a[216:217], v7 offset:12352
    ds_read_b64_tr_b16 a[218:219], v7 offset:12864
    ds_read_b64_tr_b16 a[92:93], v7 offset:14336
    ds_read_b64_tr_b16 a[94:95], v7 offset:14848
    ds_read_b64_tr_b16 a[220:221], v7 offset:14400
    ds_read_b64_tr_b16 a[222:223], v7 offset:14912
    s_waitcnt lgkmcnt(4)
    s_waitcnt lgkmcnt(0)
    s_waitcnt vmcnt(0)
    ds_read_b64_tr_b16 a[96:97], v7 offset:16384
    ds_read_b64_tr_b16 a[98:99], v7 offset:16896
    ds_read_b64_tr_b16 a[224:225], v7 offset:16448
    ds_read_b64_tr_b16 a[226:227], v7 offset:16960
    ds_read_b64_tr_b16 a[100:101], v7 offset:18432
    ds_read_b64_tr_b16 a[102:103], v7 offset:18944
    ds_read_b64_tr_b16 a[228:229], v7 offset:18496
    ds_read_b64_tr_b16 a[230:231], v7 offset:19008
    s_waitcnt lgkmcnt(4)
    ds_read_b64_tr_b16 a[104:105], v7 offset:20480
    ds_read_b64_tr_b16 a[106:107], v7 offset:20992
    ds_read_b64_tr_b16 a[232:233], v7 offset:20544
    ds_read_b64_tr_b16 a[234:235], v7 offset:21056
    ds_read_b64_tr_b16 a[108:109], v7 offset:22528
    ds_read_b64_tr_b16 a[110:111], v7 offset:23040
    ds_read_b64_tr_b16 a[236:237], v7 offset:22592
    ds_read_b64_tr_b16 a[238:239], v7 offset:23104
    s_waitcnt lgkmcnt(4)
    ds_read_b64_tr_b16 a[112:113], v7 offset:24576
    ds_read_b64_tr_b16 a[114:115], v7 offset:25088
    ds_read_b64_tr_b16 a[240:241], v7 offset:24640
    ds_read_b64_tr_b16 a[242:243], v7 offset:25152
    ds_read_b64_tr_b16 a[116:117], v7 offset:26624
    ds_read_b64_tr_b16 a[118:119], v7 offset:27136
    ds_read_b64_tr_b16 a[244:245], v7 offset:26688
    ds_read_b64_tr_b16 a[246:247], v7 offset:27200
    s_waitcnt lgkmcnt(4)
    ds_read_b64_tr_b16 a[120:121], v7 offset:28672
    ds_read_b64_tr_b16 a[122:123], v7 offset:29184
    ds_read_b64_tr_b16 a[248:249], v7 offset:28736
    ds_read_b64_tr_b16 a[250:251], v7 offset:29248
    ds_read_b64_tr_b16 a[124:125], v7 offset:30720
    ds_read_b64_tr_b16 a[126:127], v7 offset:31232
    ds_read_b64_tr_b16 a[252:253], v7 offset:30784
    ds_read_b64_tr_b16 a[254:255], v7 offset:31296
    s_waitcnt lgkmcnt(4)
    s_waitcnt lgkmcnt(0)
    s_barrier
    s_load_dwordx2 s[12:13], s[0:1], 0
    s_mov_b32 s14, 2097152
    s_mov_b32 s15, 0x20000
    s_waitcnt lgkmcnt(0)
    v_mov_b32 v6, v2
    v_mul_u32_u24 v6, 1040, v6
    v_lshlrev_b32 v7, 4, v3
    v_add_u32 v6, v6, v7
    v_lshrrev_b32 v8, 4, v2
    v_and_b32 v9, 15, v2
    v_lshlrev_b32 v9, 4, v9
    v_lshlrev_b32 v10, 8, v3
    v_add_u32 v9, v9, v10
    v_lshlrev_b32 v10, 12, v8
    v_add_u32 v10, v10, v9
    v_lshlrev_b32 v11, 10, v8
    v_add_u32 v11, v11, v9
    s_cmp_lt_u32 s24, 2
    s_cselect_b64 vcc, -1, 0
    s_nop 1
    v_cndmask_b32 v8, v11, v10, vcc
    s_and_b32 s25, s24, 1
    s_cmp_lt_u32 s24, 2
    s_cselect_b32 s26, 11, 12
    s_lshl_b32 s25, s25, s26
    s_cmp_lt_u32 s24, 2
    s_cselect_b32 s26, 0, 16777216
    s_add_u32 s26, s26, 16777216
    s_add_u32 s32, s25, s26
    s_lshl_b32 s25, s30, 13
    s_add_u32 s32, s32, s25
    s_lshl_b32 s25, s29, 5
    s_add_u32 s25, s25, s30
    s_lshl_b32 s25, s25, 2
    s_add_u32 s34, s25, 589824
    s_cmp_lt_u32 s24, 2
    s_cbranch_scc0 L_pk_V
    s_mov_b32 s31, s29
    s_mov_b32 s33, 0
    s_lshl_b32 s25, s31, 15
    s_lshl_b32 s26, s24, 13
    s_add_u32 s25, s25, s26
    s_mul_i32 s26, s24, 8320
    s_add_u32 s26, s26, 0
    s_add_u32 m0, s26, 0
    s_add_u32 s27, s25, 0
    buffer_load_dwordx4 v4, s[12:15], s27 offen lds
    s_add_u32 m0, s26, 1040
    s_add_u32 s27, s25, 1024
    buffer_load_dwordx4 v4, s[12:15], s27 offen lds
    s_add_u32 m0, s26, 2080
    s_add_u32 s27, s25, 2048
    buffer_load_dwordx4 v4, s[12:15], s27 offen lds
    s_add_u32 m0, s26, 3120
    s_add_u32 s27, s25, 3072
    buffer_load_dwordx4 v4, s[12:15], s27 offen lds
    s_add_u32 m0, s26, 4160
    s_add_u32 s27, s25, 4096
    buffer_load_dwordx4 v4, s[12:15], s27 offen lds
    s_add_u32 m0, s26, 5200
    s_add_u32 s27, s25, 5120
    buffer_load_dwordx4 v4, s[12:15], s27 offen lds
    s_add_u32 m0, s26, 6240
    s_add_u32 s27, s25, 6144
    buffer_load_dwordx4 v4, s[12:15], s27 offen lds
    s_add_u32 m0, s26, 7280
    s_add_u32 s27, s25, 7168
    buffer_load_dwordx4 v4, s[12:15], s27 offen lds
L_pk_K_loop:
    s_cmp_eq_u32 s33, 0
    s_cbranch_scc1 L_pk_K_w0_0
    s_waitcnt vmcnt(4)
    s_branch L_pk_K_w1_0
L_pk_K_w0_0:
    s_waitcnt vmcnt(0)
L_pk_K_w1_0:
    s_barrier
    s_cmp_lt_u32 s33, 2
    s_cbranch_scc1 L_pk_K_pp0_np
    s_sub_u32 s36, s33, 1
    s_cmp_lg_u32 s24, 0
    s_cbranch_scc1 L_pk_K_pp0_np
    s_mov_b64 exec, 1
    v_mov_b32 v120, 0
    v_mov_b32 v121, s36
    buffer_store_dword v121, v120, s[8:11], s34 offen sc1
    s_mov_b64 exec, -1
L_pk_K_pp0_np:
    s_lshl_b32 s28, s31, 18
    s_add_u32 s28, s28, s32
    s_add_u32 s31, s31, 4
    s_cmp_ge_u32 s31, 64
    s_cbranch_scc1 L_pk_K_nx0
    s_lshl_b32 s25, s31, 15
    s_lshl_b32 s26, s24, 13
    s_add_u32 s25, s25, s26
    s_mul_i32 s26, s24, 8320
    s_add_u32 s26, s26, 33280
    s_add_u32 m0, s26, 0
    s_add_u32 s27, s25, 0
    buffer_load_dwordx4 v4, s[12:15], s27 offen lds
    s_add_u32 m0, s26, 1040
    s_add_u32 s27, s25, 1024
    buffer_load_dwordx4 v4, s[12:15], s27 offen lds
    s_add_u32 m0, s26, 2080
    s_add_u32 s27, s25, 2048
    buffer_load_dwordx4 v4, s[12:15], s27 offen lds
    s_add_u32 m0, s26, 3120
    s_add_u32 s27, s25, 3072
    buffer_load_dwordx4 v4, s[12:15], s27 offen lds
    s_add_u32 m0, s26, 4160
    s_add_u32 s27, s25, 4096
    buffer_load_dwordx4 v4, s[12:15], s27 offen lds
    s_add_u32 m0, s26, 5200
    s_add_u32 s27, s25, 5120
    buffer_load_dwordx4 v4, s[12:15], s27 offen lds
    s_add_u32 m0, s26, 6240
    s_add_u32 s27, s25, 6144
    buffer_load_dwordx4 v4, s[12:15], s27 offen lds
    s_add_u32 m0, s26, 7280
    s_add_u32 s27, s25, 7168
    buffer_load_dwordx4 v4, s[12:15], s27 offen lds
L_pk_K_nx0:
    ds_read_b128 v[64:67], v6 offset:0
    ds_read_b128 v[68:71], v6 offset:32
    ds_read_b128 v[72:75], v6 offset:64
    ds_read_b128 v[76:79], v6 offset:96
    ds_read_b128 v[80:83], v6 offset:128
    ds_read_b128 v[84:87], v6 offset:160
    ds_read_b128 v[88:91], v6 offset:192
    ds_read_b128 v[92:95], v6 offset:224
    s_waitcnt lgkmcnt(7)
    v_mfma_f32_32x32x16_bf16 v[32:47], a[0:3], v[64:67], 0
    v_mfma_f32_32x32x16_bf16 v[48:63], a[128:131], v[64:67], 0
    ds_read_b128 v[64:67], v6 offset:256
    s_waitcnt lgkmcnt(7)
    v_mfma_f32_32x32x16_bf16 v[32:47], a[4:7], v[68:71], v[32:47]
    v_mfma_f32_32x32x16_bf16 v[48:63], a[132:135], v[68:71], v[48:63]
    ds_read_b128 v[68:71], v6 offset:288
    s_waitcnt lgkmcnt(7)
    v_mfma_f32_32x32x16_bf16 v[32:47], a[8:11], v[72:75], v[32:47]
    v_mfma_f32_32x32x16_bf16 v[48:63], a[136:139], v[72:75], v[48:63]
    ds_read_b128 v[72:75], v6 offset:320
    s_waitcnt lgkmcnt(7)
    v_mfma_f32_32x32x16_bf16 v[32:47], a[12:15], v[76:79], v[32:47]
    v_mfma_f32_32x32x16_bf16 v[48:63], a[140:143], v[76:79], v[48:63]
    ds_read_b128 v[76:79], v6 offset:352
    s_waitcnt lgkmcnt(7)
    v_mfma_f32_32x32x16_bf16 v[32:47], a[16:19], v[80:83], v[32:47]
    v_mfma_f32_32x32x16_bf16 v[48:63], a[144:147], v[80:83], v[48:63]
    ds_read_b128 v[80:83], v6 offset:384
    s_waitcnt lgkmcnt(7)
    v_mfma_f32_32x32x16_bf16 v[32:47], a[20:23], v[84:87], v[32:47]
    v_mfma_f32_32x32x16_bf16 v[48:63], a[148:151], v[84:87], v[48:63]
    ds_read_b128 v[84:87], v6 offset:416
    s_waitcnt lgkmcnt(7)
    v_mfma_f32_32x32x16_bf16 v[32:47], a[24:27], v[88:91], v[32:47]
    v_mfma_f32_32x32x16_bf16 v[48:63], a[152:155], v[88:91], v[48:63]
    ds_read_b128 v[88:91], v6 offset:448
    s_waitcnt lgkmcnt(7)
    v_mfma_f32_32x32x16_bf16 v[32:47], a[28:31], v[92:95], v[32:47]
    v_mfma_f32_32x32x16_bf16 v[48:63], a[156:159], v[92:95], v[48:63]
    ds_read_b128 v[92:95], v6 offset:480
    s_waitcnt lgkmcnt(7)
    v_mfma_f32_32x32x16_bf16 v[32:47], a[32:35], v[64:67], v[32:47]
    v_mfma_f32_32x32x16_bf16 v[48:63], a[160:163], v[64:67], v[48:63]
    ds_read_b128 v[64:67], v6 offset:512
    s_waitcnt lgkmcnt(7)
    v_mfma_f32_32x32x16_bf16 v[32:47], a[36:39], v[68:71], v[32:47]
    v_mfma_f32_32x32x16_bf16 v[48:63], a[164:167], v[68:71], v[48:63]
    ds_read_b128 v[68:71], v6 offset:544
    s_waitcnt lgkmcnt(7)
    v_mfma_f32_32x32x16_bf16 v[32:47], a[40:43], v[72:75], v[32:47]
    v_mfma_f32_32x32x16_bf16 v[48:63], a[168:171], v[72:75], v[48:63]
    ds_read_b128 v[72:75], v6 offset:576
    s_waitcnt lgkmcnt(7)
    v_mfma_f32_32x32x16_bf16 v[32:47], a[44:47], v[76:79], v[32:47]
    v_mfma_f32_32x32x16_bf16 v[48:63], a[172:175], v[76:79], v[48:63]
    ds_read_b128 v[76:79], v6 offset:608
    s_waitcnt lgkmcnt(7)
    v_mfma_f32_32x32x16_bf16 v[32:47], a[48:51], v[80:83], v[32:47]
    v_mfma_f32_32x32x16_bf16 v[48:63], a[176:179], v[80:83], v[48:63]
    ds_read_b128 v[80:83], v6 offset:640
    s_waitcnt lgkmcnt(7)
    v_mfma_f32_32x32x16_bf16 v[32:47], a[52:55], v[84:87], v[32:47]
    v_mfma_f32_32x32x16_bf16 v[48:63], a[180:183], v[84:87], v[48:63]
    ds_read_b128 v[84:87], v6 offset:672
    s_waitcnt lgkmcnt(7)
    v_mfma_f32_32x32x16_bf16 v[32:47], a[56:59], v[88:91], v[32:47]
    v_mfma_f32_32x32x16_bf16 v[48:63], a[184:187], v[88:91], v[48:63]
    ds_read_b128 v[88:91], v6 offset:704
    s_waitcnt lgkmcnt(7)
    v_mfma_f32_32x32x16_bf16 v[32:47], a[60:63], v[92:95], v[32:47]
    v_mfma_f32_32x32x16_bf16 v[48:63], a[188:191], v[92:95], v[48:63]
    ds_read_b128 v[92:95], v6 offset:736
    s_waitcnt lgkmcnt(7)
    v_mfma_f32_32x32x16_bf16 v[32:47], a[64:67], v[64:67], v[32:47]
    v_mfma_f32_32x32x16_bf16 v[48:63], a[192:195], v[64:67], v[48:63]
    ds_read_b128 v[64:67], v6 offset:768
    s_waitcnt lgkmcnt(7)
    v_mfma_f32_32x32x16_bf16 v[32:47], a[68:71], v[68:71], v[32:47]
    v_mfma_f32_32x32x16_bf16 v[48:63], a[196:199], v[68:71], v[48:63]
    ds_read_b128 v[68:71], v6 offset:800
    s_waitcnt lgkmcnt(7)
    v_mfma_f32_32x32x16_bf16 v[32:47], a[72:75], v[72:75], v[32:47]
    v_mfma_f32_32x32x16_bf16 v[48:63], a[200:203], v[72:75], v[48:63]
    ds_read_b128 v[72:75], v6 offset:832
    s_waitcnt lgkmcnt(7)
    v_mfma_f32_32x32x16_bf16 v[32:47], a[76:79], v[76:79], v[32:47]
    v_mfma_f32_32x32x16_bf16 v[48:63], a[204:207], v[76:79], v[48:63]
    ds_read_b128 v[76:79], v6 offset:864
    s_waitcnt lgkmcnt(7)
    v_mfma_f32_32x32x16_bf16 v[32:47], a[80:83], v[80:83], v[32:47]
    v_mfma_f32_32x32x16_bf16 v[48:63], a[208:211], v[80:83], v[48:63]
    ds_read_b128 v[80:83], v6 offset:896
    s_waitcnt lgkmcnt(7)
    v_mfma_f32_32x32x16_bf16 v[32:47], a[84:87], v[84:87], v[32:47]
    v_mfma_f32_32x32x16_bf16 v[48:63], a[212:215], v[84:87], v[48:63]
    ds_read_b128 v[84:87], v6 offset:928
    s_waitcnt lgkmcnt(7)
    v_mfma_f32_32x32x16_bf16 v[32:47], a[88:91], v[88:91], v[32:47]
    v_mfma_f32_32x32x16_bf16 v[48:63], a[216:219], v[88:91], v[48:63]
    ds_read_b128 v[88:91], v6 offset:960
    s_waitcnt lgkmcnt(7)
    v_mfma_f32_32x32x16_bf16 v[32:47], a[92:95], v[92:95], v[32:47]
    v_mfma_f32_32x32x16_bf16 v[48:63], a[220:223], v[92:95], v[48:63]
    ds_read_b128 v[92:95], v6 offset:992
    s_waitcnt lgkmcnt(7)
    v_mfma_f32_32x32x16_bf16 v[32:47], a[96:99], v[64:67], v[32:47]
    v_mfma_f32_32x32x16_bf16 v[48:63], a[224:227], v[64:67], v[48:63]
    s_waitcnt lgkmcnt(6)
    v_mfma_f32_32x32x16_bf16 v[32:47], a[100:103], v[68:71], v[32:47]
    v_mfma_f32_32x32x16_bf16 v[48:63], a[228:231], v[68:71], v[48:63]
    s_waitcnt lgkmcnt(5)
    v_mfma_f32_32x32x16_bf16 v[32:47], a[104:107], v[72:75], v[32:47]
    v_mfma_f32_32x32x16_bf16 v[48:63], a[232:235], v[72:75], v[48:63]
    s_waitcnt lgkmcnt(4)
    v_mfma_f32_32x32x16_bf16 v[32:47], a[108:111], v[76:79], v[32:47]
    v_mfma_f32_32x32x16_bf16 v[48:63], a[236:239], v[76:79], v[48:63]
    s_waitcnt lgkmcnt(3)
    v_mfma_f32_32x32x16_bf16 v[32:47], a[112:115], v[80:83], v[32:47]
    v_mfma_f32_32x32x16_bf16 v[48:63], a[240:243], v[80:83], v[48:63]
    s_waitcnt lgkmcnt(2)
    v_mfma_f32_32x32x16_bf16 v[32:47], a[116:119], v[84:87], v[32:47]
    v_mfma_f32_32x32x16_bf16 v[48:63], a[244:247], v[84:87], v[48:63]
    s_waitcnt lgkmcnt(1)
    v_mfma_f32_32x32x16_bf16 v[32:47], a[120:123], v[88:91], v[32:47]
    v_mfma_f32_32x32x16_bf16 v[48:63], a[248:251], v[88:91], v[48:63]
    s_waitcnt lgkmcnt(0)
    v_mfma_f32_32x32x16_bf16 v[32:47], a[124:127], v[92:95], v[32:47]
    v_mfma_f32_32x32x16_bf16 v[48:63], a[252:255], v[92:95], v[48:63]
    s_nop 15
    v_cvt_pk_bf16_f32 v96, v32, v40
    v_cvt_pk_bf16_f32 v97, v33, v41
    v_cvt_pk_bf16_f32 v98, v34, v42
    v_cvt_pk_bf16_f32 v99, v35, v43
    buffer_store_dwordx4 v[96:99], v8, s[8:11], s28 offen offset:0 sc1
    v_cvt_pk_bf16_f32 v100, v36, v44
    v_cvt_pk_bf16_f32 v101, v37, v45
    v_cvt_pk_bf16_f32 v102, v38, v46
    v_cvt_pk_bf16_f32 v103, v39, v47
    buffer_store_dwordx4 v[100:103], v8, s[8:11], s28 offen offset:512 sc1
    v_cvt_pk_bf16_f32 v104, v48, v56
    v_cvt_pk_bf16_f32 v105, v49, v57
    v_cvt_pk_bf16_f32 v106, v50, v58
    v_cvt_pk_bf16_f32 v107, v51, v59
    buffer_store_dwordx4 v[104:107], v8, s[8:11], s28 offen offset:1024 sc1
    v_cvt_pk_bf16_f32 v108, v52, v60
    v_cvt_pk_bf16_f32 v109, v53, v61
    v_cvt_pk_bf16_f32 v110, v54, v62
    v_cvt_pk_bf16_f32 v111, v55, v63
    buffer_store_dwordx4 v[108:111], v8, s[8:11], s28 offen offset:1536 sc1
    s_add_u32 s33, s33, 1
    s_cmp_ge_u32 s33, 16
    s_cbranch_scc1 L_pk_K_fin
    s_cmp_eq_u32 s33, 0
    s_cbranch_scc1 L_pk_K_w0_1
    s_waitcnt vmcnt(4)
    s_branch L_pk_K_w1_1
L_pk_K_w0_1:
    s_waitcnt vmcnt(0)
L_pk_K_w1_1:
    s_barrier
    s_cmp_lt_u32 s33, 2
    s_cbranch_scc1 L_pk_K_pp1_np
    s_sub_u32 s36, s33, 1
    s_cmp_lg_u32 s24, 0
    s_cbranch_scc1 L_pk_K_pp1_np
    s_mov_b64 exec, 1
    v_mov_b32 v120, 0
    v_mov_b32 v121, s36
    buffer_store_dword v121, v120, s[8:11], s34 offen sc1
    s_mov_b64 exec, -1
L_pk_K_pp1_np:
    s_lshl_b32 s28, s31, 18
    s_add_u32 s28, s28, s32
    s_add_u32 s31, s31, 4
    s_cmp_ge_u32 s31, 64
    s_cbranch_scc1 L_pk_K_nx1
    s_lshl_b32 s25, s31, 15
    s_lshl_b32 s26, s24, 13
    s_add_u32 s25, s25, s26
    s_mul_i32 s26, s24, 8320
    s_add_u32 s26, s26, 0
    s_add_u32 m0, s26, 0
    s_add_u32 s27, s25, 0
    buffer_load_dwordx4 v4, s[12:15], s27 offen lds
    s_add_u32 m0, s26, 1040
    s_add_u32 s27, s25, 1024
    buffer_load_dwordx4 v4, s[12:15], s27 offen lds
    s_add_u32 m0, s26, 2080
    s_add_u32 s27, s25, 2048
    buffer_load_dwordx4 v4, s[12:15], s27 offen lds
    s_add_u32 m0, s26, 3120
    s_add_u32 s27, s25, 3072
    buffer_load_dwordx4 v4, s[12:15], s27 offen lds
    s_add_u32 m0, s26, 4160
    s_add_u32 s27, s25, 4096
    buffer_load_dwordx4 v4, s[12:15], s27 offen lds
    s_add_u32 m0, s26, 5200
    s_add_u32 s27, s25, 5120
    buffer_load_dwordx4 v4, s[12:15], s27 offen lds
    s_add_u32 m0, s26, 6240
    s_add_u32 s27, s25, 6144
    buffer_load_dwordx4 v4, s[12:15], s27 offen lds
    s_add_u32 m0, s26, 7280
    s_add_u32 s27, s25, 7168
    buffer_load_dwordx4 v4, s[12:15], s27 offen lds
L_pk_K_nx1:
    ds_read_b128 v[64:67], v6 offset:33280
    ds_read_b128 v[68:71], v6 offset:33312
    ds_read_b128 v[72:75], v6 offset:33344
    ds_read_b128 v[76:79], v6 offset:33376
    ds_read_b128 v[80:83], v6 offset:33408
    ds_read_b128 v[84:87], v6 offset:33440
    ds_read_b128 v[88:91], v6 offset:33472
    ds_read_b128 v[92:95], v6 offset:33504
    s_waitcnt lgkmcnt(7)
    v_mfma_f32_32x32x16_bf16 v[32:47], a[0:3], v[64:67], 0
    v_mfma_f32_32x32x16_bf16 v[48:63], a[128:131], v[64:67], 0
    ds_read_b128 v[64:67], v6 offset:33536
    s_waitcnt lgkmcnt(7)
    v_mfma_f32_32x32x16_bf16 v[32:47], a[4:7], v[68:71], v[32:47]
    v_mfma_f32_32x32x16_bf16 v[48:63], a[132:135], v[68:71], v[48:63]
    ds_read_b128 v[68:71], v6 offset:33568
    s_waitcnt lgkmcnt(7)
    v_mfma_f32_32x32x16_bf16 v[32:47], a[8:11], v[72:75], v[32:47]
    v_mfma_f32_32x32x16_bf16 v[48:63], a[136:139], v[72:75], v[48:63]
    ds_read_b128 v[72:75], v6 offset:33600
    s_waitcnt lgkmcnt(7)
    v_mfma_f32_32x32x16_bf16 v[32:47], a[12:15], v[76:79], v[32:47]
    v_mfma_f32_32x32x16_bf16 v[48:63], a[140:143], v[76:79], v[48:63]
    ds_read_b128 v[76:79], v6 offset:33632
    s_waitcnt lgkmcnt(7)
    v_mfma_f32_32x32x16_bf16 v[32:47], a[16:19], v[80:83], v[32:47]
    v_mfma_f32_32x32x16_bf16 v[48:63], a[144:147], v[80:83], v[48:63]
    ds_read_b128 v[80:83], v6 offset:33664
    s_waitcnt lgkmcnt(7)
    v_mfma_f32_32x32x16_bf16 v[32:47], a[20:23], v[84:87], v[32:47]
    v_mfma_f32_32x32x16_bf16 v[48:63], a[148:151], v[84:87], v[48:63]
    ds_read_b128 v[84:87], v6 offset:33696
    s_waitcnt lgkmcnt(7)
    v_mfma_f32_32x32x16_bf16 v[32:47], a[24:27], v[88:91], v[32:47]
    v_mfma_f32_32x32x16_bf16 v[48:63], a[152:155], v[88:91], v[48:63]
    ds_read_b128 v[88:91], v6 offset:33728
    s_waitcnt lgkmcnt(7)
    v_mfma_f32_32x32x16_bf16 v[32:47], a[28:31], v[92:95], v[32:47]
    v_mfma_f32_32x32x16_bf16 v[48:63], a[156:159], v[92:95], v[48:63]
    ds_read_b128 v[92:95], v6 offset:33760
    s_waitcnt lgkmcnt(7)
    v_mfma_f32_32x32x16_bf16 v[32:47], a[32:35], v[64:67], v[32:47]
    v_mfma_f32_32x32x16_bf16 v[48:63], a[160:163], v[64:67], v[48:63]
    ds_read_b128 v[64:67], v6 offset:33792
    s_waitcnt lgkmcnt(7)
    v_mfma_f32_32x32x16_bf16 v[32:47], a[36:39], v[68:71], v[32:47]
    v_mfma_f32_32x32x16_bf16 v[48:63], a[164:167], v[68:71], v[48:63]
    ds_read_b128 v[68:71], v6 offset:33824
    s_waitcnt lgkmcnt(7)
    v_mfma_f32_32x32x16_bf16 v[32:47], a[40:43], v[72:75], v[32:47]
    v_mfma_f32_32x32x16_bf16 v[48:63], a[168:171], v[72:75], v[48:63]
    ds_read_b128 v[72:75], v6 offset:33856
    s_waitcnt lgkmcnt(7)
    v_mfma_f32_32x32x16_bf16 v[32:47], a[44:47], v[76:79], v[32:47]
    v_mfma_f32_32x32x16_bf16 v[48:63], a[172:175], v[76:79], v[48:63]
    ds_read_b128 v[76:79], v6 offset:33888
    s_waitcnt lgkmcnt(7)
    v_mfma_f32_32x32x16_bf16 v[32:47], a[48:51], v[80:83], v[32:47]
    v_mfma_f32_32x32x16_bf16 v[48:63], a[176:179], v[80:83], v[48:63]
    ds_read_b128 v[80:83], v6 offset:33920
    s_waitcnt lgkmcnt(7)
    v_mfma_f32_32x32x16_bf16 v[32:47], a[52:55], v[84:87], v[32:47]
    v_mfma_f32_32x32x16_bf16 v[48:63], a[180:183], v[84:87], v[48:63]
    ds_read_b128 v[84:87], v6 offset:33952
    s_waitcnt lgkmcnt(7)
    v_mfma_f32_32x32x16_bf16 v[32:47], a[56:59], v[88:91], v[32:47]
    v_mfma_f32_32x32x16_bf16 v[48:63], a[184:187], v[88:91], v[48:63]
    ds_read_b128 v[88:91], v6 offset:33984
    s_waitcnt lgkmcnt(7)
    v_mfma_f32_32x32x16_bf16 v[32:47], a[60:63], v[92:95], v[32:47]
    v_mfma_f32_32x32x16_bf16 v[48:63], a[188:191], v[92:95], v[48:63]
    ds_read_b128 v[92:95], v6 offset:34016
    s_waitcnt lgkmcnt(7)
    v_mfma_f32_32x32x16_bf16 v[32:47], a[64:67], v[64:67], v[32:47]
    v_mfma_f32_32x32x16_bf16 v[48:63], a[192:195], v[64:67], v[48:63]
    ds_read_b128 v[64:67], v6 offset:34048
    s_waitcnt lgkmcnt(7)
    v_mfma_f32_32x32x16_bf16 v[32:47], a[68:71], v[68:71], v[32:47]
    v_mfma_f32_32x32x16_bf16 v[48:63], a[196:199], v[68:71], v[48:63]
    ds_read_b128 v[68:71], v6 offset:34080
    s_waitcnt lgkmcnt(7)
    v_mfma_f32_32x32x16_bf16 v[32:47], a[72:75], v[72:75], v[32:47]
    v_mfma_f32_32x32x16_bf16 v[48:63], a[200:203], v[72:75], v[48:63]
    ds_read_b128 v[72:75], v6 offset:34112
    s_waitcnt lgkmcnt(7)
    v_mfma_f32_32x32x16_bf16 v[32:47], a[76:79], v[76:79], v[32:47]
    v_mfma_f32_32x32x16_bf16 v[48:63], a[204:207], v[76:79], v[48:63]
    ds_read_b128 v[76:79], v6 offset:34144
    s_waitcnt lgkmcnt(7)
    v_mfma_f32_32x32x16_bf16 v[32:47], a[80:83], v[80:83], v[32:47]
    v_mfma_f32_32x32x16_bf16 v[48:63], a[208:211], v[80:83], v[48:63]
    ds_read_b128 v[80:83], v6 offset:34176
    s_waitcnt lgkmcnt(7)
    v_mfma_f32_32x32x16_bf16 v[32:47], a[84:87], v[84:87], v[32:47]
    v_mfma_f32_32x32x16_bf16 v[48:63], a[212:215], v[84:87], v[48:63]
    ds_read_b128 v[84:87], v6 offset:34208
    s_waitcnt lgkmcnt(7)
    v_mfma_f32_32x32x16_bf16 v[32:47], a[88:91], v[88:91], v[32:47]
    v_mfma_f32_32x32x16_bf16 v[48:63], a[216:219], v[88:91], v[48:63]
    ds_read_b128 v[88:91], v6 offset:34240
    s_waitcnt lgkmcnt(7)
    v_mfma_f32_32x32x16_bf16 v[32:47], a[92:95], v[92:95], v[32:47]
    v_mfma_f32_32x32x16_bf16 v[48:63], a[220:223], v[92:95], v[48:63]
    ds_read_b128 v[92:95], v6 offset:34272
    s_waitcnt lgkmcnt(7)
    v_mfma_f32_32x32x16_bf16 v[32:47], a[96:99], v[64:67], v[32:47]
    v_mfma_f32_32x32x16_bf16 v[48:63], a[224:227], v[64:67], v[48:63]
    s_waitcnt lgkmcnt(6)
    v_mfma_f32_32x32x16_bf16 v[32:47], a[100:103], v[68:71], v[32:47]
    v_mfma_f32_32x32x16_bf16 v[48:63], a[228:231], v[68:71], v[48:63]
    s_waitcnt lgkmcnt(5)
    v_mfma_f32_32x32x16_bf16 v[32:47], a[104:107], v[72:75], v[32:47]
    v_mfma_f32_32x32x16_bf16 v[48:63], a[232:235], v[72:75], v[48:63]
    s_waitcnt lgkmcnt(4)
    v_mfma_f32_32x32x16_bf16 v[32:47], a[108:111], v[76:79], v[32:47]
    v_mfma_f32_32x32x16_bf16 v[48:63], a[236:239], v[76:79], v[48:63]
    s_waitcnt lgkmcnt(3)
    v_mfma_f32_32x32x16_bf16 v[32:47], a[112:115], v[80:83], v[32:47]
    v_mfma_f32_32x32x16_bf16 v[48:63], a[240:243], v[80:83], v[48:63]
    s_waitcnt lgkmcnt(2)
    v_mfma_f32_32x32x16_bf16 v[32:47], a[116:119], v[84:87], v[32:47]
    v_mfma_f32_32x32x16_bf16 v[48:63], a[244:247], v[84:87], v[48:63]
    s_waitcnt lgkmcnt(1)
    v_mfma_f32_32x32x16_bf16 v[32:47], a[120:123], v[88:91], v[32:47]
    v_mfma_f32_32x32x16_bf16 v[48:63], a[248:251], v[88:91], v[48:63]
    s_waitcnt lgkmcnt(0)
    v_mfma_f32_32x32x16_bf16 v[32:47], a[124:127], v[92:95], v[32:47]
    v_mfma_f32_32x32x16_bf16 v[48:63], a[252:255], v[92:95], v[48:63]
    s_nop 15
    v_cvt_pk_bf16_f32 v96, v32, v40
    v_cvt_pk_bf16_f32 v97, v33, v41
    v_cvt_pk_bf16_f32 v98, v34, v42
    v_cvt_pk_bf16_f32 v99, v35, v43
    buffer_store_dwordx4 v[96:99], v8, s[8:11], s28 offen offset:0 sc1
    v_cvt_pk_bf16_f32 v100, v36, v44
    v_cvt_pk_bf16_f32 v101, v37, v45
    v_cvt_pk_bf16_f32 v102, v38, v46
    v_cvt_pk_bf16_f32 v103, v39, v47
    buffer_store_dwordx4 v[100:103], v8, s[8:11], s28 offen offset:512 sc1
    v_cvt_pk_bf16_f32 v104, v48, v56
    v_cvt_pk_bf16_f32 v105, v49, v57
    v_cvt_pk_bf16_f32 v106, v50, v58
    v_cvt_pk_bf16_f32 v107, v51, v59
    buffer_store_dwordx4 v[104:107], v8, s[8:11], s28 offen offset:1024 sc1
    v_cvt_pk_bf16_f32 v108, v52, v60
    v_cvt_pk_bf16_f32 v109, v53, v61
    v_cvt_pk_bf16_f32 v110, v54, v62
    v_cvt_pk_bf16_f32 v111, v55, v63
    buffer_store_dwordx4 v[108:111], v8, s[8:11], s28 offen offset:1536 sc1
    s_add_u32 s33, s33, 1
    s_cmp_ge_u32 s33, 16
    s_cbranch_scc1 L_pk_K_fin
    s_branch L_pk_K_loop
L_pk_K_fin:
    s_waitcnt vmcnt(0)
    s_barrier
    s_cmp_lg_u32 s24, 0
    s_cbranch_scc1 L_pk_K_ppf_np
    s_mov_b64 exec, 1
    v_mov_b32 v120, 0
    v_mov_b32 v121, s33
    buffer_store_dword v121, v120, s[8:11], s34 offen sc1
    s_mov_b64 exec, -1
L_pk_K_ppf_np:
    s_branch L_pk_end
L_pk_V:
    s_mov_b32 s31, s29
    s_mov_b32 s33, 0
    s_lshl_b32 s25, s31, 15
    s_lshl_b32 s26, s24, 13
    s_add_u32 s25, s25, s26
    s_mul_i32 s26, s24, 8320
    s_add_u32 s26, s26, 0
    s_add_u32 m0, s26, 0
    s_add_u32 s27, s25, 0
    buffer_load_dwordx4 v4, s[12:15], s27 offen lds
    s_add_u32 m0, s26, 1040
    s_add_u32 s27, s25, 1024
    buffer_load_dwordx4 v4, s[12:15], s27 offen lds
    s_add_u32 m0, s26, 2080
    s_add_u32 s27, s25, 2048
    buffer_load_dwordx4 v4, s[12:15], s27 offen lds
    s_add_u32 m0, s26, 3120
    s_add_u32 s27, s25, 3072
    buffer_load_dwordx4 v4, s[12:15], s27 offen lds
    s_add_u32 m0, s26, 4160
    s_add_u32 s27, s25, 4096
    buffer_load_dwordx4 v4, s[12:15], s27 offen lds
    s_add_u32 m0, s26, 5200
    s_add_u32 s27, s25, 5120
    buffer_load_dwordx4 v4, s[12:15], s27 offen lds
    s_add_u32 m0, s26, 6240
    s_add_u32 s27, s25, 6144
    buffer_load_dwordx4 v4, s[12:15], s27 offen lds
    s_add_u32 m0, s26, 7280
    s_add_u32 s27, s25, 7168
    buffer_load_dwordx4 v4, s[12:15], s27 offen lds
L_pk_Vs_loop:
    s_cmp_eq_u32 s33, 0
    s_cbranch_scc1 L_pk_Vs_w0_0
    s_waitcnt vmcnt(4)
    s_branch L_pk_Vs_w1_0
L_pk_Vs_w0_0:
    s_waitcnt vmcnt(0)
L_pk_Vs_w1_0:
    s_barrier
    s_cmp_lt_u32 s33, 2
    s_cbranch_scc1 L_pk_Vs_pp0_np
    s_sub_u32 s36, s33, 1
    s_cmp_lg_u32 s24, 0
    s_cbranch_scc1 L_pk_Vs_pp0_np
    s_mov_b64 exec, 1
    v_mov_b32 v120, 0
    v_mov_b32 v121, s36
    buffer_store_dword v121, v120, s[8:11], s34 offen sc1
    s_mov_b64 exec, -1
L_pk_Vs_pp0_np:
    s_lshl_b32 s28, s31, 18
    s_add_u32 s28, s28, s32
    s_add_u32 s31, s31, 4
    s_cmp_ge_u32 s31, 64
    s_cbranch_scc1 L_pk_Vs_nx0
    s_lshl_b32 s25, s31, 15
    s_lshl_b32 s26, s24, 13
    s_add_u32 s25, s25, s26
    s_mul_i32 s26, s24, 8320
    s_add_u32 s26, s26, 33280
    s_add_u32 m0, s26, 0
    s_add_u32 s27, s25, 0
    buffer_load_dwordx4 v4, s[12:15], s27 offen lds
    s_add_u32 m0, s26, 1040
    s_add_u32 s27, s25, 1024
    buffer_load_dwordx4 v4, s[12:15], s27 offen lds
    s_add_u32 m0, s26, 2080
    s_add_u32 s27, s25, 2048
    buffer_load_dwordx4 v4, s[12:15], s27 offen lds
    s_add_u32 m0, s26, 3120
    s_add_u32 s27, s25, 3072
    buffer_load_dwordx4 v4, s[12:15], s27 offen lds
    s_add_u32 m0, s26, 4160
    s_add_u32 s27, s25, 4096
    buffer_load_dwordx4 v4, s[12:15], s27 offen lds
    s_add_u32 m0, s26, 5200
    s_add_u32 s27, s25, 5120
    buffer_load_dwordx4 v4, s[12:15], s27 offen lds
    s_add_u32 m0, s26, 6240
    s_add_u32 s27, s25, 6144
    buffer_load_dwordx4 v4, s[12:15], s27 offen lds
    s_add_u32 m0, s26, 7280
    s_add_u32 s27, s25, 7168
    buffer_load_dwordx4 v4, s[12:15], s27 offen lds
L_pk_Vs_nx0:
    ds_read_b128 v[64:67], v6 offset:0
    ds_read_b128 v[68:71], v6 offset:32
    ds_read_b128 v[72:75], v6 offset:64
    ds_read_b128 v[76:79], v6 offset:96
    ds_read_b128 v[80:83], v6 offset:128
    ds_read_b128 v[84:87], v6 offset:160
    ds_read_b128 v[88:91], v6 offset:192
    ds_read_b128 v[92:95], v6 offset:224
    s_waitcnt lgkmcnt(7)
    v_mfma_f32_32x32x16_bf16 v[32:47], v[64:67], a[0:3], 0
    v_mfma_f32_32x32x16_bf16 v[48:63], v[64:67], a[128:131], 0
    ds_read_b128 v[64:67], v6 offset:256
    s_waitcnt lgkmcnt(7)
    v_mfma_f32_32x32x16_bf16 v[32:47], v[68:71], a[4:7], v[32:47]
    v_mfma_f32_32x32x16_bf16 v[48:63], v[68:71], a[132:135], v[48:63]
    ds_read_b128 v[68:71], v6 offset:288
    s_waitcnt lgkmcnt(7)
    v_mfma_f32_32x32x16_bf16 v[32:47], v[72:75], a[8:11], v[32:47]
    v_mfma_f32_32x32x16_bf16 v[48:63], v[72:75], a[136:139], v[48:63]
    ds_read_b128 v[72:75], v6 offset:320
    s_waitcnt lgkmcnt(7)
    v_mfma_f32_32x32x16_bf16 v[32:47], v[76:79], a[12:15], v[32:47]
    v_mfma_f32_32x32x16_bf16 v[48:63], v[76:79], a[140:143], v[48:63]
    ds_read_b128 v[76:79], v6 offset:352
    s_waitcnt lgkmcnt(7)
    v_mfma_f32_32x32x16_bf16 v[32:47], v[80:83], a[16:19], v[32:47]
    v_mfma_f32_32x32x16_bf16 v[48:63], v[80:83], a[144:147], v[48:63]
    ds_read_b128 v[80:83], v6 offset:384
    s_waitcnt lgkmcnt(7)
    v_mfma_f32_32x32x16_bf16 v[32:47], v[84:87], a[20:23], v[32:47]
    v_mfma_f32_32x32x16_bf16 v[48:63], v[84:87], a[148:151], v[48:63]
    ds_read_b128 v[84:87], v6 offset:416
    s_waitcnt lgkmcnt(7)
    v_mfma_f32_32x32x16_bf16 v[32:47], v[88:91], a[24:27], v[32:47]
    v_mfma_f32_32x32x16_bf16 v[48:63], v[88:91], a[152:155], v[48:63]
    ds_read_b128 v[88:91], v6 offset:448
    s_waitcnt lgkmcnt(7)
    v_mfma_f32_32x32x16_bf16 v[32:47], v[92:95], a[28:31], v[32:47]
    v_mfma_f32_32x32x16_bf16 v[48:63], v[92:95], a[156:159], v[48:63]
    ds_read_b128 v[92:95], v6 offset:480
    s_waitcnt lgkmcnt(7)
    v_mfma_f32_32x32x16_bf16 v[32:47], v[64:67], a[32:35], v[32:47]
    v_mfma_f32_32x32x16_bf16 v[48:63], v[64:67], a[160:163], v[48:63]
    ds_read_b128 v[64:67], v6 offset:512
    s_waitcnt lgkmcnt(7)
    v_mfma_f32_32x32x16_bf16 v[32:47], v[68:71], a[36:39], v[32:47]
    v_mfma_f32_32x32x16_bf16 v[48:63], v[68:71], a[164:167], v[48:63]
    ds_read_b128 v[68:71], v6 offset:544
    s_waitcnt lgkmcnt(7)
    v_mfma_f32_32x32x16_bf16 v[32:47], v[72:75], a[40:43], v[32:47]
    v_mfma_f32_32x32x16_bf16 v[48:63], v[72:75], a[168:171], v[48:63]
    ds_read_b128 v[72:75], v6 offset:576
    s_waitcnt lgkmcnt(7)
    v_mfma_f32_32x32x16_bf16 v[32:47], v[76:79], a[44:47], v[32:47]
    v_mfma_f32_32x32x16_bf16 v[48:63], v[76:79], a[172:175], v[48:63]
    ds_read_b128 v[76:79], v6 offset:608
    s_waitcnt lgkmcnt(7)
    v_mfma_f32_32x32x16_bf16 v[32:47], v[80:83], a[48:51], v[32:47]
    v_mfma_f32_32x32x16_bf16 v[48:63], v[80:83], a[176:179], v[48:63]
    ds_read_b128 v[80:83], v6 offset:640
    s_waitcnt lgkmcnt(7)
    v_mfma_f32_32x32x16_bf16 v[32:47], v[84:87], a[52:55], v[32:47]
    v_mfma_f32_32x32x16_bf16 v[48:63], v[84:87], a[180:183], v[48:63]
    ds_read_b128 v[84:87], v6 offset:672
    s_waitcnt lgkmcnt(7)
    v_mfma_f32_32x32x16_bf16 v[32:47], v[88:91], a[56:59], v[32:47]
    v_mfma_f32_32x32x16_bf16 v[48:63], v[88:91], a[184:187], v[48:63]
    ds_read_b128 v[88:91], v6 offset:704
    s_waitcnt lgkmcnt(7)
    v_mfma_f32_32x32x16_bf16 v[32:47], v[92:95], a[60:63], v[32:47]
    v_mfma_f32_32x32x16_bf16 v[48:63], v[92:95], a[188:191], v[48:63]
    ds_read_b128 v[92:95], v6 offset:736
    s_waitcnt lgkmcnt(7)
    v_mfma_f32_32x32x16_bf16 v[32:47], v[64:67], a[64:67], v[32:47]
    v_mfma_f32_32x32x16_bf16 v[48:63], v[64:67], a[192:195], v[48:63]
    ds_read_b128 v[64:67], v6 offset:768
    s_waitcnt lgkmcnt(7)
    v_mfma_f32_32x32x16_bf16 v[32:47], v[68:71], a[68:71], v[32:47]
    v_mfma_f32_32x32x16_bf16 v[48:63], v[68:71], a[196:199], v[48:63]
    ds_read_b128 v[68:71], v6 offset:800
    s_waitcnt lgkmcnt(7)
    v_mfma_f32_32x32x16_bf16 v[32:47], v[72:75], a[72:75], v[32:47]
    v_mfma_f32_32x32x16_bf16 v[48:63], v[72:75], a[200:203], v[48:63]
    ds_read_b128 v[72:75], v6 offset:832
    s_waitcnt lgkmcnt(7)
    v_mfma_f32_32x32x16_bf16 v[32:47], v[76:79], a[76:79], v[32:47]
    v_mfma_f32_32x32x16_bf16 v[48:63], v[76:79], a[204:207], v[48:63]
    ds_read_b128 v[76:79], v6 offset:864
    s_waitcnt lgkmcnt(7)
    v_mfma_f32_32x32x16_bf16 v[32:47], v[80:83], a[80:83], v[32:47]
    v_mfma_f32_32x32x16_bf16 v[48:63], v[80:83], a[208:211], v[48:63]
    ds_read_b128 v[80:83], v6 offset:896
    s_waitcnt lgkmcnt(7)
    v_mfma_f32_32x32x16_bf16 v[32:47], v[84:87], a[84:87], v[32:47]
    v_mfma_f32_32x32x16_bf16 v[48:63], v[84:87], a[212:215], v[48:63]
    ds_read_b128 v[84:87], v6 offset:928
    s_waitcnt lgkmcnt(7)
    v_mfma_f32_32x32x16_bf16 v[32:47], v[88:91], a[88:91], v[32:47]
    v_mfma_f32_32x32x16_bf16 v[48:63], v[88:91], a[216:219], v[48:63]
    ds_read_b128 v[88:91], v6 offset:960
    s_waitcnt lgkmcnt(7)
    v_mfma_f32_32x32x16_bf16 v[32:47], v[92:95], a[92:95], v[32:47]
    v_mfma_f32_32x32x16_bf16 v[48:63], v[92:95], a[220:223], v[48:63]
    ds_read_b128 v[92:95], v6 offset:992
    s_waitcnt lgkmcnt(7)
    v_mfma_f32_32x32x16_bf16 v[32:47], v[64:67], a[96:99], v[32:47]
    v_mfma_f32_32x32x16_bf16 v[48:63], v[64:67], a[224:227], v[48:63]
    s_waitcnt lgkmcnt(6)
    v_mfma_f32_32x32x16_bf16 v[32:47], v[68:71], a[100:103], v[32:47]
    v_mfma_f32_32x32x16_bf16 v[48:63], v[68:71], a[228:231], v[48:63]
    s_waitcnt lgkmcnt(5)
    v_mfma_f32_32x32x16_bf16 v[32:47], v[72:75], a[104:107], v[32:47]
    v_mfma_f32_32x32x16_bf16 v[48:63], v[72:75], a[232:235], v[48:63]
    s_waitcnt lgkmcnt(4)
    v_mfma_f32_32x32x16_bf16 v[32:47], v[76:79], a[108:111], v[32:47]
    v_mfma_f32_32x32x16_bf16 v[48:63], v[76:79], a[236:239], v[48:63]
    s_waitcnt lgkmcnt(3)
    v_mfma_f32_32x32x16_bf16 v[32:47], v[80:83], a[112:115], v[32:47]
    v_mfma_f32_32x32x16_bf16 v[48:63], v[80:83], a[240:243], v[48:63]
    s_waitcnt lgkmcnt(2)
    v_mfma_f32_32x32x16_bf16 v[32:47], v[84:87], a[116:119], v[32:47]
    v_mfma_f32_32x32x16_bf16 v[48:63], v[84:87], a[244:247], v[48:63]
    s_waitcnt lgkmcnt(1)
    v_mfma_f32_32x32x16_bf16 v[32:47], v[88:91], a[120:123], v[32:47]
    v_mfma_f32_32x32x16_bf16 v[48:63], v[88:91], a[248:251], v[48:63]
    s_waitcnt lgkmcnt(0)
    v_mfma_f32_32x32x16_bf16 v[32:47], v[92:95], a[124:127], v[32:47]
    v_mfma_f32_32x32x16_bf16 v[48:63], v[92:95], a[252:255], v[48:63]
    s_nop 15
    v_cvt_pk_bf16_f32 v96, v32, v33
    v_cvt_pk_bf16_f32 v97, v40, v41
    v_cvt_pk_bf16_f32 v98, v34, v35
    v_cvt_pk_bf16_f32 v99, v42, v43
    buffer_store_dwordx4 v[96:99], v8, s[8:11], s28 offen offset:0 sc1
    v_cvt_pk_bf16_f32 v100, v36, v37
    v_cvt_pk_bf16_f32 v101, v44, v45
    v_cvt_pk_bf16_f32 v102, v38, v39
    v_cvt_pk_bf16_f32 v103, v46, v47
    buffer_store_dwordx4 v[100:103], v8, s[8:11], s28 offen offset:512 sc1
    v_cvt_pk_bf16_f32 v104, v48, v49
    v_cvt_pk_bf16_f32 v105, v56, v57
    v_cvt_pk_bf16_f32 v106, v50, v51
    v_cvt_pk_bf16_f32 v107, v58, v59
    buffer_store_dwordx4 v[104:107], v8, s[8:11], s28 offen offset:2048 sc1
    v_cvt_pk_bf16_f32 v108, v52, v53
    v_cvt_pk_bf16_f32 v109, v60, v61
    v_cvt_pk_bf16_f32 v110, v54, v55
    v_cvt_pk_bf16_f32 v111, v62, v63
    buffer_store_dwordx4 v[108:111], v8, s[8:11], s28 offen offset:2560 sc1
    s_add_u32 s33, s33, 1
    s_cmp_ge_u32 s33, 16
    s_cbranch_scc1 L_pk_Vs_fin
    s_cmp_eq_u32 s33, 0
    s_cbranch_scc1 L_pk_Vs_w0_1
    s_waitcnt vmcnt(4)
    s_branch L_pk_Vs_w1_1
L_pk_Vs_w0_1:
    s_waitcnt vmcnt(0)
L_pk_Vs_w1_1:
    s_barrier
    s_cmp_lt_u32 s33, 2
    s_cbranch_scc1 L_pk_Vs_pp1_np
    s_sub_u32 s36, s33, 1
    s_cmp_lg_u32 s24, 0
    s_cbranch_scc1 L_pk_Vs_pp1_np
    s_mov_b64 exec, 1
    v_mov_b32 v120, 0
    v_mov_b32 v121, s36
    buffer_store_dword v121, v120, s[8:11], s34 offen sc1
    s_mov_b64 exec, -1
L_pk_Vs_pp1_np:
    s_lshl_b32 s28, s31, 18
    s_add_u32 s28, s28, s32
    s_add_u32 s31, s31, 4
    s_cmp_ge_u32 s31, 64
    s_cbranch_scc1 L_pk_Vs_nx1
    s_lshl_b32 s25, s31, 15
    s_lshl_b32 s26, s24, 13
    s_add_u32 s25, s25, s26
    s_mul_i32 s26, s24, 8320
    s_add_u32 s26, s26, 0
    s_add_u32 m0, s26, 0
    s_add_u32 s27, s25, 0
    buffer_load_dwordx4 v4, s[12:15], s27 offen lds
    s_add_u32 m0, s26, 1040
    s_add_u32 s27, s25, 1024
    buffer_load_dwordx4 v4, s[12:15], s27 offen lds
    s_add_u32 m0, s26, 2080
    s_add_u32 s27, s25, 2048
    buffer_load_dwordx4 v4, s[12:15], s27 offen lds
    s_add_u32 m0, s26, 3120
    s_add_u32 s27, s25, 3072
    buffer_load_dwordx4 v4, s[12:15], s27 offen lds
    s_add_u32 m0, s26, 4160
    s_add_u32 s27, s25, 4096
    buffer_load_dwordx4 v4, s[12:15], s27 offen lds
    s_add_u32 m0, s26, 5200
    s_add_u32 s27, s25, 5120
    buffer_load_dwordx4 v4, s[12:15], s27 offen lds
    s_add_u32 m0, s26, 6240
    s_add_u32 s27, s25, 6144
    buffer_load_dwordx4 v4, s[12:15], s27 offen lds
    s_add_u32 m0, s26, 7280
    s_add_u32 s27, s25, 7168
    buffer_load_dwordx4 v4, s[12:15], s27 offen lds
L_pk_Vs_nx1:
    ds_read_b128 v[64:67], v6 offset:33280
    ds_read_b128 v[68:71], v6 offset:33312
    ds_read_b128 v[72:75], v6 offset:33344
    ds_read_b128 v[76:79], v6 offset:33376
    ds_read_b128 v[80:83], v6 offset:33408
    ds_read_b128 v[84:87], v6 offset:33440
    ds_read_b128 v[88:91], v6 offset:33472
    ds_read_b128 v[92:95], v6 offset:33504
    s_waitcnt lgkmcnt(7)
    v_mfma_f32_32x32x16_bf16 v[32:47], v[64:67], a[0:3], 0
    v_mfma_f32_32x32x16_bf16 v[48:63], v[64:67], a[128:131], 0
    ds_read_b128 v[64:67], v6 offset:33536
    s_waitcnt lgkmcnt(7)
    v_mfma_f32_32x32x16_bf16 v[32:47], v[68:71], a[4:7], v[32:47]
    v_mfma_f32_32x32x16_bf16 v[48:63], v[68:71], a[132:135], v[48:63]
    ds_read_b128 v[68:71], v6 offset:33568
    s_waitcnt lgkmcnt(7)
    v_mfma_f32_32x32x16_bf16 v[32:47], v[72:75], a[8:11], v[32:47]
    v_mfma_f32_32x32x16_bf16 v[48:63], v[72:75], a[136:139], v[48:63]
    ds_read_b128 v[72:75], v6 offset:33600
    s_waitcnt lgkmcnt(7)
    v_mfma_f32_32x32x16_bf16 v[32:47], v[76:79], a[12:15], v[32:47]
    v_mfma_f32_32x32x16_bf16 v[48:63], v[76:79], a[140:143], v[48:63]
    ds_read_b128 v[76:79], v6 offset:33632
    s_waitcnt lgkmcnt(7)
    v_mfma_f32_32x32x16_bf16 v[32:47], v[80:83], a[16:19], v[32:47]
    v_mfma_f32_32x32x16_bf16 v[48:63], v[80:83], a[144:147], v[48:63]
    ds_read_b128 v[80:83], v6 offset:33664
    s_waitcnt lgkmcnt(7)
    v_mfma_f32_32x32x16_bf16 v[32:47], v[84:87], a[20:23], v[32:47]
    v_mfma_f32_32x32x16_bf16 v[48:63], v[84:87], a[148:151], v[48:63]
    ds_read_b128 v[84:87], v6 offset:33696
    s_waitcnt lgkmcnt(7)
    v_mfma_f32_32x32x16_bf16 v[32:47], v[88:91], a[24:27], v[32:47]
    v_mfma_f32_32x32x16_bf16 v[48:63], v[88:91], a[152:155], v[48:63]
    ds_read_b128 v[88:91], v6 offset:33728
    s_waitcnt lgkmcnt(7)
    v_mfma_f32_32x32x16_bf16 v[32:47], v[92:95], a[28:31], v[32:47]
    v_mfma_f32_32x32x16_bf16 v[48:63], v[92:95], a[156:159], v[48:63]
    ds_read_b128 v[92:95], v6 offset:33760
    s_waitcnt lgkmcnt(7)
    v_mfma_f32_32x32x16_bf16 v[32:47], v[64:67], a[32:35], v[32:47]
    v_mfma_f32_32x32x16_bf16 v[48:63], v[64:67], a[160:163], v[48:63]
    ds_read_b128 v[64:67], v6 offset:33792
    s_waitcnt lgkmcnt(7)
    v_mfma_f32_32x32x16_bf16 v[32:47], v[68:71], a[36:39], v[32:47]
    v_mfma_f32_32x32x16_bf16 v[48:63], v[68:71], a[164:167], v[48:63]
    ds_read_b128 v[68:71], v6 offset:33824
    s_waitcnt lgkmcnt(7)
    v_mfma_f32_32x32x16_bf16 v[32:47], v[72:75], a[40:43], v[32:47]
    v_mfma_f32_32x32x16_bf16 v[48:63], v[72:75], a[168:171], v[48:63]
    ds_read_b128 v[72:75], v6 offset:33856
    s_waitcnt lgkmcnt(7)
    v_mfma_f32_32x32x16_bf16 v[32:47], v[76:79], a[44:47], v[32:47]
    v_mfma_f32_32x32x16_bf16 v[48:63], v[76:79], a[172:175], v[48:63]
    ds_read_b128 v[76:79], v6 offset:33888
    s_waitcnt lgkmcnt(7)
    v_mfma_f32_32x32x16_bf16 v[32:47], v[80:83], a[48:51], v[32:47]
    v_mfma_f32_32x32x16_bf16 v[48:63], v[80:83], a[176:179], v[48:63]
    ds_read_b128 v[80:83], v6 offset:33920
    s_waitcnt lgkmcnt(7)
    v_mfma_f32_32x32x16_bf16 v[32:47], v[84:87], a[52:55], v[32:47]
    v_mfma_f32_32x32x16_bf16 v[48:63], v[84:87], a[180:183], v[48:63]
    ds_read_b128 v[84:87], v6 offset:33952
    s_waitcnt lgkmcnt(7)
    v_mfma_f32_32x32x16_bf16 v[32:47], v[88:91], a[56:59], v[32:47]
    v_mfma_f32_32x32x16_bf16 v[48:63], v[88:91], a[184:187], v[48:63]
    ds_read_b128 v[88:91], v6 offset:33984
    s_waitcnt lgkmcnt(7)
    v_mfma_f32_32x32x16_bf16 v[32:47], v[92:95], a[60:63], v[32:47]
    v_mfma_f32_32x32x16_bf16 v[48:63], v[92:95], a[188:191], v[48:63]
    ds_read_b128 v[92:95], v6 offset:34016
    s_waitcnt lgkmcnt(7)
    v_mfma_f32_32x32x16_bf16 v[32:47], v[64:67], a[64:67], v[32:47]
    v_mfma_f32_32x32x16_bf16 v[48:63], v[64:67], a[192:195], v[48:63]
    ds_read_b128 v[64:67], v6 offset:34048
    s_waitcnt lgkmcnt(7)
    v_mfma_f32_32x32x16_bf16 v[32:47], v[68:71], a[68:71], v[32:47]
    v_mfma_f32_32x32x16_bf16 v[48:63], v[68:71], a[196:199], v[48:63]
    ds_read_b128 v[68:71], v6 offset:34080
    s_waitcnt lgkmcnt(7)
    v_mfma_f32_32x32x16_bf16 v[32:47], v[72:75], a[72:75], v[32:47]
    v_mfma_f32_32x32x16_bf16 v[48:63], v[72:75], a[200:203], v[48:63]
    ds_read_b128 v[72:75], v6 offset:34112
    s_waitcnt lgkmcnt(7)
    v_mfma_f32_32x32x16_bf16 v[32:47], v[76:79], a[76:79], v[32:47]
    v_mfma_f32_32x32x16_bf16 v[48:63], v[76:79], a[204:207], v[48:63]
    ds_read_b128 v[76:79], v6 offset:34144
    s_waitcnt lgkmcnt(7)
    v_mfma_f32_32x32x16_bf16 v[32:47], v[80:83], a[80:83], v[32:47]
    v_mfma_f32_32x32x16_bf16 v[48:63], v[80:83], a[208:211], v[48:63]
    ds_read_b128 v[80:83], v6 offset:34176
    s_waitcnt lgkmcnt(7)
    v_mfma_f32_32x32x16_bf16 v[32:47], v[84:87], a[84:87], v[32:47]
    v_mfma_f32_32x32x16_bf16 v[48:63], v[84:87], a[212:215], v[48:63]
    ds_read_b128 v[84:87], v6 offset:34208
    s_waitcnt lgkmcnt(7)
    v_mfma_f32_32x32x16_bf16 v[32:47], v[88:91], a[88:91], v[32:47]
    v_mfma_f32_32x32x16_bf16 v[48:63], v[88:91], a[216:219], v[48:63]
    ds_read_b128 v[88:91], v6 offset:34240
    s_waitcnt lgkmcnt(7)
    v_mfma_f32_32x32x16_bf16 v[32:47], v[92:95], a[92:95], v[32:47]
    v_mfma_f32_32x32x16_bf16 v[48:63], v[92:95], a[220:223], v[48:63]
    ds_read_b128 v[92:95], v6 offset:34272
    s_waitcnt lgkmcnt(7)
    v_mfma_f32_32x32x16_bf16 v[32:47], v[64:67], a[96:99], v[32:47]
    v_mfma_f32_32x32x16_bf16 v[48:63], v[64:67], a[224:227], v[48:63]
    s_waitcnt lgkmcnt(6)
    v_mfma_f32_32x32x16_bf16 v[32:47], v[68:71], a[100:103], v[32:47]
    v_mfma_f32_32x32x16_bf16 v[48:63], v[68:71], a[228:231], v[48:63]
    s_waitcnt lgkmcnt(5)
    v_mfma_f32_32x32x16_bf16 v[32:47], v[72:75], a[104:107], v[32:47]
    v_mfma_f32_32x32x16_bf16 v[48:63], v[72:75], a[232:235], v[48:63]
    s_waitcnt lgkmcnt(4)
    v_mfma_f32_32x32x16_bf16 v[32:47], v[76:79], a[108:111], v[32:47]
    v_mfma_f32_32x32x16_bf16 v[48:63], v[76:79], a[236:239], v[48:63]
    s_waitcnt lgkmcnt(3)
    v_mfma_f32_32x32x16_bf16 v[32:47], v[80:83], a[112:115], v[32:47]
    v_mfma_f32_32x32x16_bf16 v[48:63], v[80:83], a[240:243], v[48:63]
    s_waitcnt lgkmcnt(2)
    v_mfma_f32_32x32x16_bf16 v[32:47], v[84:87], a[116:119], v[32:47]
    v_mfma_f32_32x32x16_bf16 v[48:63], v[84:87], a[244:247], v[48:63]
    s_waitcnt lgkmcnt(1)
    v_mfma_f32_32x32x16_bf16 v[32:47], v[88:91], a[120:123], v[32:47]
    v_mfma_f32_32x32x16_bf16 v[48:63], v[88:91], a[248:251], v[48:63]
    s_waitcnt lgkmcnt(0)
    v_mfma_f32_32x32x16_bf16 v[32:47], v[92:95], a[124:127], v[32:47]
    v_mfma_f32_32x32x16_bf16 v[48:63], v[92:95], a[252:255], v[48:63]
    s_nop 15
    v_cvt_pk_bf16_f32 v96, v32, v33
    v_cvt_pk_bf16_f32 v97, v40, v41
    v_cvt_pk_bf16_f32 v98, v34, v35
    v_cvt_pk_bf16_f32 v99, v42, v43
    buffer_store_dwordx4 v[96:99], v8, s[8:11], s28 offen offset:0 sc1
    v_cvt_pk_bf16_f32 v100, v36, v37
    v_cvt_pk_bf16_f32 v101, v44, v45
    v_cvt_pk_bf16_f32 v102, v38, v39
    v_cvt_pk_bf16_f32 v103, v46, v47
    buffer_store_dwordx4 v[100:103], v8, s[8:11], s28 offen offset:512 sc1
    v_cvt_pk_bf16_f32 v104, v48, v49
    v_cvt_pk_bf16_f32 v105, v56, v57
    v_cvt_pk_bf16_f32 v106, v50, v51
    v_cvt_pk_bf16_f32 v107, v58, v59
    buffer_store_dwordx4 v[104:107], v8, s[8:11], s28 offen offset:2048 sc1
    v_cvt_pk_bf16_f32 v108, v52, v53
    v_cvt_pk_bf16_f32 v109, v60, v61
    v_cvt_pk_bf16_f32 v110, v54, v55
    v_cvt_pk_bf16_f32 v111, v62, v63
    buffer_store_dwordx4 v[108:111], v8, s[8:11], s28 offen offset:2560 sc1
    s_add_u32 s33, s33, 1
    s_cmp_ge_u32 s33, 16
    s_cbranch_scc1 L_pk_Vs_fin
    s_branch L_pk_Vs_loop
L_pk_Vs_fin:
    s_waitcnt vmcnt(0)
    s_barrier
    s_cmp_lg_u32 s24, 0
    s_cbranch_scc1 L_pk_Vs_ppf_np
    s_mov_b64 exec, 1
    v_mov_b32 v120, 0
    v_mov_b32 v121, s33
    buffer_store_dword v121, v120, s[8:11], s34 offen sc1
    s_mov_b64 exec, -1
L_pk_Vs_ppf_np:
L_pk_end:
    v_mov_b32 v40, 204
    v_mov_b32 v41, 1
    v_cmp_eq_u32 vcc, 0, v0
    s_and_saveexec_b64 s[6:7], vcc
    global_atomic_add v40, v41, s[4:5]
    s_mov_b64 exec, s[6:7]
L_phase2:
    s_barrier
    s_cmp_ge_u32 s60, 176
    s_cbranch_scc1 L_scan
    s_cmp_lt_u32 s60, 112
    s_cbranch_scc1 L_t4a
    s_sub_u32 s25, s60, 112
    s_lshl_b32 s25, s25, 2
    s_add_u32 s25, s25, s24
    s_and_b32 s30, s25, 63
    s_lshr_b32 s29, s25, 6

    v_and_b32 v1, 63, v0
    v_and_b32 v2, 15, v1
    v_lshrrev_b32 v3, 4, v1
    v_lshlrev_b32 v4, 4, v1
    s_lshr_b32 s40, s30, 1
    s_and_b32 s41, s30, 1
    s_mov_b32 s45, 0x3e0293ee
    v_lshlrev_b32 v5, 4, v3
    v_and_b32 v6, 7, v2
    v_lshlrev_b32 v6, 6, v6
    v_add_u32 v5, v5, v6
    v_and_b32 v6, 1, v3
    v_lshlrev_b32 v6, 7, v6
    v_lshlrev_b32 v7, 2, v2
    v_add_u32 v6, v6, v7
    v_lshrrev_b32 v7, 1, v3
    v_lshlrev_b32 v7, 9, v7
    v_lshlrev_b32 v8, 4, v2
    v_and_b32 v9, 1, v3
    v_lshlrev_b32 v9, 3, v9
    v_add3_u32 v7, v7, v8, v9
    s_lshl_b32 s25, s41, 8
    v_add_u32 v7, s25, v7
    s_lshl_b32 s25, s41, 4
    v_lshlrev_b32 v8, 2, v3
    v_sub_u32 v8, v2, v8
    v_add_u32 v8, s25, v8
    v_mov_b32 v9, 0xff800000
    s_mov_b32 s42, s29
L_t3_loop:
    s_and_b32 s25, s42, 3
    s_lshl_b32 s26, s25, 5
    s_add_u32 s26, s26, s40
    s_lshl_b32 s26, s26, 2
    s_add_u32 s46, s26, 589824
    s_lshl_b32 s26, s25, 4
    s_lshr_b32 s27, s40, 1
    s_add_u32 s26, s26, s27
    s_lshl_b32 s26, s26, 2
    s_add_u32 s47, s26, 590336
    s_lshr_b32 s27, s42, 2
    s_add_u32 s27, s27, 1
    v_mov_b32 v120, 0
L_t3_wk_w:
    buffer_load_dword v121, v120, s[8:11], s46 offen sc1
    s_waitcnt vmcnt(0)
    v_readfirstlane_b32 s28, v121
    s_cmp_ge_u32 s28, s27
    s_cbranch_scc1 L_t3_wk_d
    s_sleep 4
    s_add_u32 s35, s35, 1
    s_cmp_lt_u32 s35, 1000000
    s_cbranch_scc1 L_t3_wk_w
    s_endpgm
L_t3_wk_d:
    v_mov_b32 v120, 0
L_t3_wq_w:
    buffer_load_dword v121, v120, s[8:11], s47 offen sc1
    s_waitcnt vmcnt(0)
    v_readfirstlane_b32 s28, v121
    s_cmp_ge_u32 s28, s27
    s_cbranch_scc1 L_t3_wq_d
    s_sleep 4
    s_add_u32 s35, s35, 1
    s_cmp_lt_u32 s35, 1000000
    s_cbranch_scc1 L_t3_wq_w
    s_endpgm
L_t3_wq_d:
    s_lshl_b32 s25, s42, 5
    s_add_u32 s25, s25, s40
    s_lshl_b32 s43, s25, 13
    s_add_u32 s44, s25, 32
    s_lshl_b32 s44, s44, 11
    s_lshl_b32 s26, s41, 12
    s_add_u32 s26, s26, s43
    s_add_u32 s26, s26, 50331648
    buffer_load_dwordx4 v[16:19], v4, s[8:11], s26 offen offset:0 sc1
    buffer_load_dwordx4 v[20:23], v4, s[8:11], s26 offen offset:1024 sc1
    buffer_load_dwordx4 v[24:27], v4, s[8:11], s26 offen offset:2048 sc1
    buffer_load_dwordx4 v[28:31], v4, s[8:11], s26 offen offset:3072 sc1
    s_add_u32 s26, s43, 16777216
    s_add_u32 s27, s26, 4096
    buffer_load_dwordx4 v[32:35], v4, s[8:11], s26 offen offset:0 sc1
    buffer_load_dwordx4 v[36:39], v4, s[8:11], s26 offen offset:1024 sc1
    buffer_load_dwordx4 v[40:43], v4, s[8:11], s26 offen offset:2048 sc1
    buffer_load_dwordx4 v[44:47], v4, s[8:11], s26 offen offset:3072 sc1
    buffer_load_dwordx4 v[48:51], v4, s[8:11], s27 offen offset:0 sc1
    buffer_load_dwordx4 v[52:55], v4, s[8:11], s27 offen offset:1024 sc1
    buffer_load_dwordx4 v[56:59], v4, s[8:11], s27 offen offset:2048 sc1
    buffer_load_dwordx4 v[60:63], v4, s[8:11], s27 offen offset:3072 sc1
    s_add_u32 s26, s43, 33554432
    s_add_u32 s27, s26, 4096
    buffer_load_dwordx4 v[80:83], v4, s[8:11], s26 offen offset:0 sc1
    buffer_load_dwordx4 v[84:87], v4, s[8:11], s26 offen offset:1024 sc1
    buffer_load_dwordx4 v[88:91], v4, s[8:11], s26 offen offset:2048 sc1
    buffer_load_dwordx4 v[92:95], v4, s[8:11], s26 offen offset:3072 sc1
    buffer_load_dwordx4 v[96:99], v4, s[8:11], s27 offen offset:0 sc1
    buffer_load_dwordx4 v[100:103], v4, s[8:11], s27 offen offset:1024 sc1
    buffer_load_dwordx4 v[104:107], v4, s[8:11], s27 offen offset:2048 sc1
    buffer_load_dwordx4 v[108:111], v4, s[8:11], s27 offen offset:3072 sc1
    s_lshl_b32 s26, s40, 7
    s_add_u32 s46, s26, 593920
    s_add_u32 s27, s42, 1
    v_mov_b32 v190, 0
L_t3_wc_w:
    buffer_load_dword v191, v190, s[8:11], s46 offen sc1
    s_waitcnt vmcnt(0)
    v_readfirstlane_b32 s28, v191
    s_cmp_ge_u32 s28, s27
    s_cbranch_scc1 L_t3_wc_d
    s_add_u32 s28, s28, 2
    s_cmp_ge_u32 s28, s27
    s_cbranch_scc1 L_t3_wc_n
    s_sleep 40
L_t3_wc_n:
    s_sleep 2
    s_add_u32 s35, s35, 1
    s_cmp_lt_u32 s35, 1000000
    s_cbranch_scc1 L_t3_wc_w
    s_endpgm
L_t3_wc_d:
    s_add_u32 s26, s44, 83886080
    buffer_load_dwordx4 v[64:67], v5, s[8:11], s26 offen offset:0 sc1
    buffer_load_dwordx4 v[68:71], v5, s[8:11], s26 offen offset:512 sc1
    buffer_load_dwordx4 v[72:75], v5, s[8:11], s26 offen offset:1024 sc1
    buffer_load_dwordx4 v[76:79], v5, s[8:11], s26 offen offset:1536 sc1
    s_add_u32 s26, s44, 88080384
    buffer_load_dword v112, v6, s[8:11], s26 offen offset:0 sc1
    buffer_load_dword v113, v6, s[8:11], s26 offen offset:64 sc1
    buffer_load_dword v114, v6, s[8:11], s26 offen offset:256 sc1
    buffer_load_dword v115, v6, s[8:11], s26 offen offset:320 sc1
    buffer_load_dword v116, v6, s[8:11], s26 offen offset:512 sc1
    buffer_load_dword v117, v6, s[8:11], s26 offen offset:576 sc1
    buffer_load_dword v118, v6, s[8:11], s26 offen offset:768 sc1
    buffer_load_dword v119, v6, s[8:11], s26 offen offset:832 sc1
    buffer_load_dword v120, v6, s[8:11], s26 offen offset:1024 sc1
    buffer_load_dword v121, v6, s[8:11], s26 offen offset:1088 sc1
    buffer_load_dword v122, v6, s[8:11], s26 offen offset:1280 sc1
    buffer_load_dword v123, v6, s[8:11], s26 offen offset:1344 sc1
    buffer_load_dword v124, v6, s[8:11], s26 offen offset:1536 sc1
    buffer_load_dword v125, v6, s[8:11], s26 offen offset:1600 sc1
    buffer_load_dword v126, v6, s[8:11], s26 offen offset:1792 sc1
    buffer_load_dword v127, v6, s[8:11], s26 offen offset:1856 sc1
    s_waitcnt vmcnt(16)
    v_mfma_f32_16x16x32_bf16 v[128:131], v[32:35], v[16:19], 0
    v_mfma_f32_16x16x32_bf16 v[128:131], v[36:39], v[20:23], v[128:131]
    v_mfma_f32_16x16x32_bf16 v[128:131], v[40:43], v[24:27], v[128:131]
    v_mfma_f32_16x16x32_bf16 v[128:131], v[44:47], v[28:31], v[128:131]
    v_mfma_f32_16x16x32_bf16 v[132:135], v[48:51], v[16:19], 0
    v_mfma_f32_16x16x32_bf16 v[132:135], v[52:55], v[20:23], v[132:135]
    v_mfma_f32_16x16x32_bf16 v[132:135], v[56:59], v[24:27], v[132:135]
    v_mfma_f32_16x16x32_bf16 v[132:135], v[60:63], v[28:31], v[132:135]
    v_mfma_f32_16x16x32_bf16 v[136:139], v[64:67], v[16:19], 0
    v_mfma_f32_16x16x32_bf16 v[136:139], v[68:71], v[20:23], v[136:139]
    v_mfma_f32_16x16x32_bf16 v[136:139], v[72:75], v[24:27], v[136:139]
    v_mfma_f32_16x16x32_bf16 v[136:139], v[76:79], v[28:31], v[136:139]
    s_nop 7
    v_cmp_le_i32 vcc, 0, v8
    s_nop 1
    v_cndmask_b32 v128, v9, v128, vcc
    v_cmp_le_i32 vcc, 1, v8
    s_nop 1
    v_cndmask_b32 v129, v9, v129, vcc
    v_cmp_le_i32 vcc, 2, v8
    s_nop 1
    v_cndmask_b32 v130, v9, v130, vcc
    v_cmp_le_i32 vcc, 3, v8
    s_nop 1
    v_cndmask_b32 v131, v9, v131, vcc
    v_cmp_le_i32 vcc, 16, v8
    s_nop 1
    v_cndmask_b32 v132, v9, v132, vcc
    v_cmp_le_i32 vcc, 17, v8
    s_nop 1
    v_cndmask_b32 v133, v9, v133, vcc
    v_cmp_le_i32 vcc, 18, v8
    s_nop 1
    v_cndmask_b32 v134, v9, v134, vcc
    v_cmp_le_i32 vcc, 19, v8
    s_nop 1
    v_cndmask_b32 v135, v9, v135, vcc
    v_cmp_gt_u32 vcc, 2, v3
    s_nop 1
    v_cndmask_b32 v136, v9, v136, vcc
    v_cndmask_b32 v137, v9, v137, vcc
    v_cndmask_b32 v138, v9, v138, vcc
    v_cndmask_b32 v139, v9, v139, vcc
    v_max3_f32 v140, v128, v129, v130
    v_max3_f32 v141, v131, v132, v133
    v_max3_f32 v140, v140, v134, v135
    v_max3_f32 v141, v141, v136, v137
    v_max3_f32 v140, v140, v138, v139
    v_max_f32 v140, v140, v141
    v_mov_b32 v141, v140
    s_nop 1
    v_permlane16_swap_b32 v140, v141
    v_max_f32 v140, v140, v141
    v_mov_b32 v141, v140
    s_nop 1
    v_permlane32_swap_b32 v140, v141
    v_max_f32 v140, v140, v141
    v_mul_f32 v140, s45, v140
    v_fma_f32 v128, v128, s45, -v140
    v_fma_f32 v129, v129, s45, -v140
    v_fma_f32 v130, v130, s45, -v140
    v_fma_f32 v131, v131, s45, -v140
    v_fma_f32 v132, v132, s45, -v140
    v_fma_f32 v133, v133, s45, -v140
    v_fma_f32 v134, v134, s45, -v140
    v_fma_f32 v135, v135, s45, -v140
    v_fma_f32 v136, v136, s45, -v140
    v_fma_f32 v137, v137, s45, -v140
    v_fma_f32 v138, v138, s45, -v140
    v_fma_f32 v139, v139, s45, -v140
    v_exp_f32 v128, v128
    v_exp_f32 v129, v129
    v_exp_f32 v130, v130
    v_exp_f32 v131, v131
    v_exp_f32 v132, v132
    v_exp_f32 v133, v133
    v_exp_f32 v134, v134
    v_exp_f32 v135, v135
    v_exp_f32 v136, v136
    v_exp_f32 v137, v137
    v_exp_f32 v138, v138
    v_exp_f32 v139, v139
    s_nop 0
    v_cvt_pk_bf16_f32 v144, v128, v129
    v_cvt_pk_bf16_f32 v145, v132, v133
    v_cvt_pk_bf16_f32 v146, v130, v131
    v_cvt_pk_bf16_f32 v147, v134, v135
    v_cvt_pk_bf16_f32 v148, v136, v137
    v_cvt_pk_bf16_f32 v149, v138, v139
    v_mov_b32 v140, 0
    v_lshlrev_b32 v141, 16, v144
    v_add_f32 v140, v140, v141
    v_and_b32 v141, 0xffff0000, v144
    v_add_f32 v140, v140, v141
    v_lshlrev_b32 v141, 16, v145
    v_add_f32 v140, v140, v141
    v_and_b32 v141, 0xffff0000, v145
    v_add_f32 v140, v140, v141
    v_lshlrev_b32 v141, 16, v146
    v_add_f32 v140, v140, v141
    v_and_b32 v141, 0xffff0000, v146
    v_add_f32 v140, v140, v141
    v_lshlrev_b32 v141, 16, v147
    v_add_f32 v140, v140, v141
    v_and_b32 v141, 0xffff0000, v147
    v_add_f32 v140, v140, v141
    v_lshlrev_b32 v141, 16, v148
    v_add_f32 v140, v140, v141
    v_and_b32 v141, 0xffff0000, v148
    v_add_f32 v140, v140, v141
    v_lshlrev_b32 v141, 16, v149
    v_add_f32 v140, v140, v141
    v_and_b32 v141, 0xffff0000, v149
    v_add_f32 v140, v140, v141
    v_mov_b32 v141, v140
    s_nop 1
    v_permlane16_swap_b32 v140, v141
    v_add_f32 v140, v140, v141
    v_mov_b32 v141, v140
    s_nop 1
    v_permlane32_swap_b32 v140, v141
    v_add_f32 v140, v140, v141
    v_rcp_f32 v140, v140
    s_waitcnt vmcnt(0)
    v_mfma_f32_16x16x32_bf16 v[152:155], v[80:83], v[144:147], 0
    v_mfma_f32_16x16x32_bf16 v[156:159], v[84:87], v[144:147], 0
    v_mfma_f32_16x16x32_bf16 v[160:163], v[88:91], v[144:147], 0
    v_mfma_f32_16x16x32_bf16 v[164:167], v[92:95], v[144:147], 0
    v_mfma_f32_16x16x32_bf16 v[168:171], v[96:99], v[144:147], 0
    v_mfma_f32_16x16x32_bf16 v[172:175], v[100:103], v[144:147], 0
    v_mfma_f32_16x16x32_bf16 v[176:179], v[104:107], v[144:147], 0
    v_mfma_f32_16x16x32_bf16 v[180:183], v[108:111], v[144:147], 0
    v_mfma_f32_16x16x16_bf16 v[152:155], v[112:113], v[148:149], v[152:155]
    v_mfma_f32_16x16x16_bf16 v[156:159], v[114:115], v[148:149], v[156:159]
    v_mfma_f32_16x16x16_bf16 v[160:163], v[116:117], v[148:149], v[160:163]
    v_mfma_f32_16x16x16_bf16 v[164:167], v[118:119], v[148:149], v[164:167]
    v_mfma_f32_16x16x16_bf16 v[168:171], v[120:121], v[148:149], v[168:171]
    v_mfma_f32_16x16x16_bf16 v[172:175], v[122:123], v[148:149], v[172:175]
    v_mfma_f32_16x16x16_bf16 v[176:179], v[124:125], v[148:149], v[176:179]
    v_mfma_f32_16x16x16_bf16 v[180:183], v[126:127], v[148:149], v[180:183]
    s_nop 7
    s_lshl_b32 s26, s41, 12
    s_add_u32 s26, s26, s43
    s_add_u32 s26, s26, 67108864
    v_mul_f32 v152, v152, v140
    v_mul_f32 v156, v156, v140
    v_mul_f32 v153, v153, v140
    v_mul_f32 v157, v157, v140
    v_mul_f32 v154, v154, v140
    v_mul_f32 v158, v158, v140
    v_mul_f32 v155, v155, v140
    v_mul_f32 v159, v159, v140
    v_cvt_pk_bf16_f32 v152, v152, v153
    v_cvt_pk_bf16_f32 v153, v154, v155
    v_cvt_pk_bf16_f32 v154, v156, v157
    v_cvt_pk_bf16_f32 v155, v158, v159
    buffer_store_dwordx4 v[152:155], v4, s[8:11], s26 offen offset:0 sc1
    v_mul_f32 v160, v160, v140
    v_mul_f32 v164, v164, v140
    v_mul_f32 v161, v161, v140
    v_mul_f32 v165, v165, v140
    v_mul_f32 v162, v162, v140
    v_mul_f32 v166, v166, v140
    v_mul_f32 v163, v163, v140
    v_mul_f32 v167, v167, v140
    v_cvt_pk_bf16_f32 v160, v160, v161
    v_cvt_pk_bf16_f32 v161, v162, v163
    v_cvt_pk_bf16_f32 v162, v164, v165
    v_cvt_pk_bf16_f32 v163, v166, v167
    buffer_store_dwordx4 v[160:163], v4, s[8:11], s26 offen offset:1024 sc1
    v_mul_f32 v168, v168, v140
    v_mul_f32 v172, v172, v140
    v_mul_f32 v169, v169, v140
    v_mul_f32 v173, v173, v140
    v_mul_f32 v170, v170, v140
    v_mul_f32 v174, v174, v140
    v_mul_f32 v171, v171, v140
    v_mul_f32 v175, v175, v140
    v_cvt_pk_bf16_f32 v168, v168, v169
    v_cvt_pk_bf16_f32 v169, v170, v171
    v_cvt_pk_bf16_f32 v170, v172, v173
    v_cvt_pk_bf16_f32 v171, v174, v175
    buffer_store_dwordx4 v[168:171], v4, s[8:11], s26 offen offset:2048 sc1
    v_mul_f32 v176, v176, v140
    v_mul_f32 v180, v180, v140
    v_mul_f32 v177, v177, v140
    v_mul_f32 v181, v181, v140
    v_mul_f32 v178, v178, v140
    v_mul_f32 v182, v182, v140
    v_mul_f32 v179, v179, v140
    v_mul_f32 v183, v183, v140
    v_cvt_pk_bf16_f32 v176, v176, v177
    v_cvt_pk_bf16_f32 v177, v178, v179
    v_cvt_pk_bf16_f32 v178, v180, v181
    v_cvt_pk_bf16_f32 v179, v182, v183
    buffer_store_dwordx4 v[176:179], v4, s[8:11], s26 offen offset:3072 sc1
    s_waitcnt vmcnt(0)
    s_lshl_b32 s26, s42, 7
    s_add_u32 s26, s26, 598016
    s_mov_b64 exec, 1
    v_mov_b32 v120, 0
    v_mov_b32 v121, 1
    buffer_atomic_add v121, v120, s[8:11], s26 offen sc1
    s_mov_b64 exec, -1
    s_add_u32 s42, s42, 4
    s_cmp_lt_u32 s42, 64
    s_cbranch_scc1 L_t3_loop
    s_waitcnt vmcnt(0)
    s_waitcnt vmcnt(0)
    s_endpgm
L_t4a:
    s_lshr_b32 s29, s60, 5
    s_and_b32 s30, s60, 31
    s_branch L_t4
L_spare:
    s_mov_b32 s29, 3
    s_sub_u32 s30, s60, 192
L_t4:

    v_and_b32 v1, 63, v0
    v_and_b32 v2, 15, v1
    v_lshrrev_b32 v3, 4, v1
    v_lshlrev_b32 v4, 4, v1
    s_lshr_b32 s40, s30, 4
    s_and_b32 s41, s30, 15
    s_load_dwordx2 s[16:17], s[0:1], 40
    s_mov_b32 s18, 4194304
    s_mov_b32 s19, 0x20000
    s_waitcnt lgkmcnt(0)
    v_lshrrev_b32 v5, 2, v1
    v_lshlrev_b32 v5, 10, v5
    v_and_b32 v6, 3, v1
    v_lshlrev_b32 v6, 4, v6
    s_lshl_b32 s25, s41, 6
    s_lshl_b32 s26, s24, 20
    s_add_u32 s25, s25, s26
    v_add3_u32 v5, v5, v6, s25
    v_lshrrev_b32 v7, 2, v2
    v_lshlrev_b32 v8, 2, v3
    v_add_u32 v7, v7, v8
    v_lshlrev_b32 v7, 6, v7
    v_and_b32 v6, 3, v2
    v_lshlrev_b32 v6, 3, v6
    s_lshl_b32 s27, s24, 15
    v_add3_u32 v7, v7, v6, s27
    s_add_u32 m0, s27, 0
    s_mov_b32 s28, 0
    buffer_load_dwordx4 v5, s[16:19], s28 offen lds
    s_add_u32 m0, s27, 1024
    s_mov_b32 s28, 16384
    buffer_load_dwordx4 v5, s[16:19], s28 offen lds
    s_add_u32 m0, s27, 2048
    s_mov_b32 s28, 32768
    buffer_load_dwordx4 v5, s[16:19], s28 offen lds
    s_add_u32 m0, s27, 3072
    s_mov_b32 s28, 49152
    buffer_load_dwordx4 v5, s[16:19], s28 offen lds
    s_add_u32 m0, s27, 4096
    s_mov_b32 s28, 65536
    buffer_load_dwordx4 v5, s[16:19], s28 offen lds
    s_add_u32 m0, s27, 5120
    s_mov_b32 s28, 81920
    buffer_load_dwordx4 v5, s[16:19], s28 offen lds
    s_add_u32 m0, s27, 6144
    s_mov_b32 s28, 98304
    buffer_load_dwordx4 v5, s[16:19], s28 offen lds
    s_add_u32 m0, s27, 7168
    s_mov_b32 s28, 114688
    buffer_load_dwordx4 v5, s[16:19], s28 offen lds
    s_add_u32 m0, s27, 8192
    s_mov_b32 s28, 131072
    buffer_load_dwordx4 v5, s[16:19], s28 offen lds
    s_add_u32 m0, s27, 9216
    s_mov_b32 s28, 147456
    buffer_load_dwordx4 v5, s[16:19], s28 offen lds
    s_add_u32 m0, s27, 10240
    s_mov_b32 s28, 163840
    buffer_load_dwordx4 v5, s[16:19], s28 offen lds
    s_add_u32 m0, s27, 11264
    s_mov_b32 s28, 180224
    buffer_load_dwordx4 v5, s[16:19], s28 offen lds
    s_add_u32 m0, s27, 12288
    s_mov_b32 s28, 196608
    buffer_load_dwordx4 v5, s[16:19], s28 offen lds
    s_add_u32 m0, s27, 13312
    s_mov_b32 s28, 212992
    buffer_load_dwordx4 v5, s[16:19], s28 offen lds
    s_add_u32 m0, s27, 14336
    s_mov_b32 s28, 229376
    buffer_load_dwordx4 v5, s[16:19], s28 offen lds
    s_add_u32 m0, s27, 15360
    s_mov_b32 s28, 245760
    buffer_load_dwordx4 v5, s[16:19], s28 offen lds
    s_add_u32 m0, s27, 16384
    s_mov_b32 s28, 262144
    buffer_load_dwordx4 v5, s[16:19], s28 offen lds
    s_add_u32 m0, s27, 17408
    s_mov_b32 s28, 278528
    buffer_load_dwordx4 v5, s[16:19], s28 offen lds
    s_add_u32 m0, s27, 18432
    s_mov_b32 s28, 294912
    buffer_load_dwordx4 v5, s[16:19], s28 offen lds
    s_add_u32 m0, s27, 19456
    s_mov_b32 s28, 311296
    buffer_load_dwordx4 v5, s[16:19], s28 offen lds
    s_add_u32 m0, s27, 20480
    s_mov_b32 s28, 327680
    buffer_load_dwordx4 v5, s[16:19], s28 offen lds
    s_add_u32 m0, s27, 21504
    s_mov_b32 s28, 344064
    buffer_load_dwordx4 v5, s[16:19], s28 offen lds
    s_add_u32 m0, s27, 22528
    s_mov_b32 s28, 360448
    buffer_load_dwordx4 v5, s[16:19], s28 offen lds
    s_add_u32 m0, s27, 23552
    s_mov_b32 s28, 376832
    buffer_load_dwordx4 v5, s[16:19], s28 offen lds
    s_add_u32 m0, s27, 24576
    s_mov_b32 s28, 393216
    buffer_load_dwordx4 v5, s[16:19], s28 offen lds
    s_add_u32 m0, s27, 25600
    s_mov_b32 s28, 409600
    buffer_load_dwordx4 v5, s[16:19], s28 offen lds
    s_add_u32 m0, s27, 26624
    s_mov_b32 s28, 425984
    buffer_load_dwordx4 v5, s[16:19], s28 offen lds
    s_add_u32 m0, s27, 27648
    s_mov_b32 s28, 442368
    buffer_load_dwordx4 v5, s[16:19], s28 offen lds
    s_add_u32 m0, s27, 28672
    s_mov_b32 s28, 458752
    buffer_load_dwordx4 v5, s[16:19], s28 offen lds
    s_add_u32 m0, s27, 29696
    s_mov_b32 s28, 475136
    buffer_load_dwordx4 v5, s[16:19], s28 offen lds
    s_add_u32 m0, s27, 30720
    s_mov_b32 s28, 491520
    buffer_load_dwordx4 v5, s[16:19], s28 offen lds
    s_add_u32 m0, s27, 31744
    s_mov_b32 s28, 507904
    buffer_load_dwordx4 v5, s[16:19], s28 offen lds
    s_waitcnt vmcnt(16)
    ds_read_b64_tr_b16 a[0:1], v7 offset:0
    ds_read_b64_tr_b16 a[2:3], v7 offset:1024
    ds_read_b64_tr_b16 a[4:5], v7 offset:32
    ds_read_b64_tr_b16 a[6:7], v7 offset:1056
    ds_read_b64_tr_b16 a[8:9], v7 offset:2048
    ds_read_b64_tr_b16 a[10:11], v7 offset:3072
    ds_read_b64_tr_b16 a[12:13], v7 offset:2080
    ds_read_b64_tr_b16 a[14:15], v7 offset:3104
    s_waitcnt lgkmcnt(4)
    ds_read_b64_tr_b16 a[16:17], v7 offset:4096
    ds_read_b64_tr_b16 a[18:19], v7 offset:5120
    ds_read_b64_tr_b16 a[20:21], v7 offset:4128
    ds_read_b64_tr_b16 a[22:23], v7 offset:5152
    ds_read_b64_tr_b16 a[24:25], v7 offset:6144
    ds_read_b64_tr_b16 a[26:27], v7 offset:7168
    ds_read_b64_tr_b16 a[28:29], v7 offset:6176
    ds_read_b64_tr_b16 a[30:31], v7 offset:7200
    s_waitcnt lgkmcnt(4)
    ds_read_b64_tr_b16 a[32:33], v7 offset:8192
    ds_read_b64_tr_b16 a[34:35], v7 offset:9216
    ds_read_b64_tr_b16 a[36:37], v7 offset:8224
    ds_read_b64_tr_b16 a[38:39], v7 offset:9248
    ds_read_b64_tr_b16 a[40:41], v7 offset:10240
    ds_read_b64_tr_b16 a[42:43], v7 offset:11264
    ds_read_b64_tr_b16 a[44:45], v7 offset:10272
    ds_read_b64_tr_b16 a[46:47], v7 offset:11296
    s_waitcnt lgkmcnt(4)
    ds_read_b64_tr_b16 a[48:49], v7 offset:12288
    ds_read_b64_tr_b16 a[50:51], v7 offset:13312
    ds_read_b64_tr_b16 a[52:53], v7 offset:12320
    ds_read_b64_tr_b16 a[54:55], v7 offset:13344
    ds_read_b64_tr_b16 a[56:57], v7 offset:14336
    ds_read_b64_tr_b16 a[58:59], v7 offset:15360
    ds_read_b64_tr_b16 a[60:61], v7 offset:14368
    ds_read_b64_tr_b16 a[62:63], v7 offset:15392
    s_waitcnt lgkmcnt(4)
    s_waitcnt lgkmcnt(0)
    s_add_u32 m0, s27, 0
    s_mov_b32 s28, 524288
    buffer_load_dwordx4 v5, s[16:19], s28 offen lds
    s_add_u32 m0, s27, 1024
    s_mov_b32 s28, 540672
    buffer_load_dwordx4 v5, s[16:19], s28 offen lds
    s_add_u32 m0, s27, 2048
    s_mov_b32 s28, 557056
    buffer_load_dwordx4 v5, s[16:19], s28 offen lds
    s_add_u32 m0, s27, 3072
    s_mov_b32 s28, 573440
    buffer_load_dwordx4 v5, s[16:19], s28 offen lds
    s_add_u32 m0, s27, 4096
    s_mov_b32 s28, 589824
    buffer_load_dwordx4 v5, s[16:19], s28 offen lds
    s_add_u32 m0, s27, 5120
    s_mov_b32 s28, 606208
    buffer_load_dwordx4 v5, s[16:19], s28 offen lds
    s_add_u32 m0, s27, 6144
    s_mov_b32 s28, 622592
    buffer_load_dwordx4 v5, s[16:19], s28 offen lds
    s_add_u32 m0, s27, 7168
    s_mov_b32 s28, 638976
    buffer_load_dwordx4 v5, s[16:19], s28 offen lds
    s_add_u32 m0, s27, 8192
    s_mov_b32 s28, 655360
    buffer_load_dwordx4 v5, s[16:19], s28 offen lds
    s_add_u32 m0, s27, 9216
    s_mov_b32 s28, 671744
    buffer_load_dwordx4 v5, s[16:19], s28 offen lds
    s_add_u32 m0, s27, 10240
    s_mov_b32 s28, 688128
    buffer_load_dwordx4 v5, s[16:19], s28 offen lds
    s_add_u32 m0, s27, 11264
    s_mov_b32 s28, 704512
    buffer_load_dwordx4 v5, s[16:19], s28 offen lds
    s_add_u32 m0, s27, 12288
    s_mov_b32 s28, 720896
    buffer_load_dwordx4 v5, s[16:19], s28 offen lds
    s_add_u32 m0, s27, 13312
    s_mov_b32 s28, 737280
    buffer_load_dwordx4 v5, s[16:19], s28 offen lds
    s_add_u32 m0, s27, 14336
    s_mov_b32 s28, 753664
    buffer_load_dwordx4 v5, s[16:19], s28 offen lds
    s_add_u32 m0, s27, 15360
    s_mov_b32 s28, 770048
    buffer_load_dwordx4 v5, s[16:19], s28 offen lds
    s_waitcnt vmcnt(16)
    ds_read_b64_tr_b16 a[64:65], v7 offset:16384
    ds_read_b64_tr_b16 a[66:67], v7 offset:17408
    ds_read_b64_tr_b16 a[68:69], v7 offset:16416
    ds_read_b64_tr_b16 a[70:71], v7 offset:17440
    ds_read_b64_tr_b16 a[72:73], v7 offset:18432
    ds_read_b64_tr_b16 a[74:75], v7 offset:19456
    ds_read_b64_tr_b16 a[76:77], v7 offset:18464
    ds_read_b64_tr_b16 a[78:79], v7 offset:19488
    s_waitcnt lgkmcnt(4)
    ds_read_b64_tr_b16 a[80:81], v7 offset:20480
    ds_read_b64_tr_b16 a[82:83], v7 offset:21504
    ds_read_b64_tr_b16 a[84:85], v7 offset:20512
    ds_read_b64_tr_b16 a[86:87], v7 offset:21536
    ds_read_b64_tr_b16 a[88:89], v7 offset:22528
    ds_read_b64_tr_b16 a[90:91], v7 offset:23552
    ds_read_b64_tr_b16 a[92:93], v7 offset:22560
    ds_read_b64_tr_b16 a[94:95], v7 offset:23584
    s_waitcnt lgkmcnt(4)
    ds_read_b64_tr_b16 a[96:97], v7 offset:24576
    ds_read_b64_tr_b16 a[98:99], v7 offset:25600
    ds_read_b64_tr_b16 a[100:101], v7 offset:24608
    ds_read_b64_tr_b16 a[102:103], v7 offset:25632
    ds_read_b64_tr_b16 a[104:105], v7 offset:26624
    ds_read_b64_tr_b16 a[106:107], v7 offset:27648
    ds_read_b64_tr_b16 a[108:109], v7 offset:26656
    ds_read_b64_tr_b16 a[110:111], v7 offset:27680
    s_waitcnt lgkmcnt(4)
    ds_read_b64_tr_b16 a[112:113], v7 offset:28672
    ds_read_b64_tr_b16 a[114:115], v7 offset:29696
    ds_read_b64_tr_b16 a[116:117], v7 offset:28704
    ds_read_b64_tr_b16 a[118:119], v7 offset:29728
    ds_read_b64_tr_b16 a[120:121], v7 offset:30720
    ds_read_b64_tr_b16 a[122:123], v7 offset:31744
    ds_read_b64_tr_b16 a[124:125], v7 offset:30752
    ds_read_b64_tr_b16 a[126:127], v7 offset:31776
    s_waitcnt lgkmcnt(4)
    s_waitcnt lgkmcnt(0)
    s_add_u32 m0, s27, 16384
    s_mov_b32 s28, 786432
    buffer_load_dwordx4 v5, s[16:19], s28 offen lds
    s_add_u32 m0, s27, 17408
    s_mov_b32 s28, 802816
    buffer_load_dwordx4 v5, s[16:19], s28 offen lds
    s_add_u32 m0, s27, 18432
    s_mov_b32 s28, 819200
    buffer_load_dwordx4 v5, s[16:19], s28 offen lds
    s_add_u32 m0, s27, 19456
    s_mov_b32 s28, 835584
    buffer_load_dwordx4 v5, s[16:19], s28 offen lds
    s_add_u32 m0, s27, 20480
    s_mov_b32 s28, 851968
    buffer_load_dwordx4 v5, s[16:19], s28 offen lds
    s_add_u32 m0, s27, 21504
    s_mov_b32 s28, 868352
    buffer_load_dwordx4 v5, s[16:19], s28 offen lds
    s_add_u32 m0, s27, 22528
    s_mov_b32 s28, 884736
    buffer_load_dwordx4 v5, s[16:19], s28 offen lds
    s_add_u32 m0, s27, 23552
    s_mov_b32 s28, 901120
    buffer_load_dwordx4 v5, s[16:19], s28 offen lds
    s_add_u32 m0, s27, 24576
    s_mov_b32 s28, 917504
    buffer_load_dwordx4 v5, s[16:19], s28 offen lds
    s_add_u32 m0, s27, 25600
    s_mov_b32 s28, 933888
    buffer_load_dwordx4 v5, s[16:19], s28 offen lds
    s_add_u32 m0, s27, 26624
    s_mov_b32 s28, 950272
    buffer_load_dwordx4 v5, s[16:19], s28 offen lds
    s_add_u32 m0, s27, 27648
    s_mov_b32 s28, 966656
    buffer_load_dwordx4 v5, s[16:19], s28 offen lds
    s_add_u32 m0, s27, 28672
    s_mov_b32 s28, 983040
    buffer_load_dwordx4 v5, s[16:19], s28 offen lds
    s_add_u32 m0, s27, 29696
    s_mov_b32 s28, 999424
    buffer_load_dwordx4 v5, s[16:19], s28 offen lds
    s_add_u32 m0, s27, 30720
    s_mov_b32 s28, 1015808
    buffer_load_dwordx4 v5, s[16:19], s28 offen lds
    s_add_u32 m0, s27, 31744
    s_mov_b32 s28, 1032192
    buffer_load_dwordx4 v5, s[16:19], s28 offen lds
    s_waitcnt vmcnt(16)
    ds_read_b64_tr_b16 a[128:129], v7 offset:0
    ds_read_b64_tr_b16 a[130:131], v7 offset:1024
    ds_read_b64_tr_b16 a[132:133], v7 offset:32
    ds_read_b64_tr_b16 a[134:135], v7 offset:1056
    ds_read_b64_tr_b16 a[136:137], v7 offset:2048
    ds_read_b64_tr_b16 a[138:139], v7 offset:3072
    ds_read_b64_tr_b16 a[140:141], v7 offset:2080
    ds_read_b64_tr_b16 a[142:143], v7 offset:3104
    s_waitcnt lgkmcnt(4)
    ds_read_b64_tr_b16 a[144:145], v7 offset:4096
    ds_read_b64_tr_b16 a[146:147], v7 offset:5120
    ds_read_b64_tr_b16 a[148:149], v7 offset:4128
    ds_read_b64_tr_b16 a[150:151], v7 offset:5152
    ds_read_b64_tr_b16 a[152:153], v7 offset:6144
    ds_read_b64_tr_b16 a[154:155], v7 offset:7168
    ds_read_b64_tr_b16 a[156:157], v7 offset:6176
    ds_read_b64_tr_b16 a[158:159], v7 offset:7200
    s_waitcnt lgkmcnt(4)
    ds_read_b64_tr_b16 a[160:161], v7 offset:8192
    ds_read_b64_tr_b16 a[162:163], v7 offset:9216
    ds_read_b64_tr_b16 a[164:165], v7 offset:8224
    ds_read_b64_tr_b16 a[166:167], v7 offset:9248
    ds_read_b64_tr_b16 a[168:169], v7 offset:10240
    ds_read_b64_tr_b16 a[170:171], v7 offset:11264
    ds_read_b64_tr_b16 a[172:173], v7 offset:10272
    ds_read_b64_tr_b16 a[174:175], v7 offset:11296
    s_waitcnt lgkmcnt(4)
    ds_read_b64_tr_b16 a[176:177], v7 offset:12288
    ds_read_b64_tr_b16 a[178:179], v7 offset:13312
    ds_read_b64_tr_b16 a[180:181], v7 offset:12320
    ds_read_b64_tr_b16 a[182:183], v7 offset:13344
    ds_read_b64_tr_b16 a[184:185], v7 offset:14336
    ds_read_b64_tr_b16 a[186:187], v7 offset:15360
    ds_read_b64_tr_b16 a[188:189], v7 offset:14368
    ds_read_b64_tr_b16 a[190:191], v7 offset:15392
    s_waitcnt lgkmcnt(4)
    s_waitcnt lgkmcnt(0)
    s_waitcnt vmcnt(0)
    ds_read_b64_tr_b16 a[192:193], v7 offset:16384
    ds_read_b64_tr_b16 a[194:195], v7 offset:17408
    ds_read_b64_tr_b16 a[196:197], v7 offset:16416
    ds_read_b64_tr_b16 a[198:199], v7 offset:17440
    ds_read_b64_tr_b16 a[200:201], v7 offset:18432
    ds_read_b64_tr_b16 a[202:203], v7 offset:19456
    ds_read_b64_tr_b16 a[204:205], v7 offset:18464
    ds_read_b64_tr_b16 a[206:207], v7 offset:19488
    s_waitcnt lgkmcnt(4)
    ds_read_b64_tr_b16 a[208:209], v7 offset:20480
    ds_read_b64_tr_b16 a[210:211], v7 offset:21504
    ds_read_b64_tr_b16 a[212:213], v7 offset:20512
    ds_read_b64_tr_b16 a[214:215], v7 offset:21536
    ds_read_b64_tr_b16 a[216:217], v7 offset:22528
    ds_read_b64_tr_b16 a[218:219], v7 offset:23552
    ds_read_b64_tr_b16 a[220:221], v7 offset:22560
    ds_read_b64_tr_b16 a[222:223], v7 offset:23584
    s_waitcnt lgkmcnt(4)
    ds_read_b64_tr_b16 a[224:225], v7 offset:24576
    ds_read_b64_tr_b16 a[226:227], v7 offset:25600
    ds_read_b64_tr_b16 a[228:229], v7 offset:24608
    ds_read_b64_tr_b16 a[230:231], v7 offset:25632
    ds_read_b64_tr_b16 a[232:233], v7 offset:26624
    ds_read_b64_tr_b16 a[234:235], v7 offset:27648
    ds_read_b64_tr_b16 a[236:237], v7 offset:26656
    ds_read_b64_tr_b16 a[238:239], v7 offset:27680
    s_waitcnt lgkmcnt(4)
    ds_read_b64_tr_b16 a[240:241], v7 offset:28672
    ds_read_b64_tr_b16 a[242:243], v7 offset:29696
    ds_read_b64_tr_b16 a[244:245], v7 offset:28704
    ds_read_b64_tr_b16 a[246:247], v7 offset:29728
    ds_read_b64_tr_b16 a[248:249], v7 offset:30720
    ds_read_b64_tr_b16 a[250:251], v7 offset:31744
    ds_read_b64_tr_b16 a[252:253], v7 offset:30752
    ds_read_b64_tr_b16 a[254:255], v7 offset:31776
    s_waitcnt lgkmcnt(4)
    s_waitcnt lgkmcnt(0)
    s_barrier
    s_load_dwordx2 s[20:21], s[0:1], 128
    s_mov_b32 s22, 8388608
    s_mov_b32 s23, 0x20000
    s_waitcnt lgkmcnt(0)
    v_lshlrev_b32 v8, 14, v3
    v_lshlrev_b32 v9, 2, v2
    s_lshl_b32 s25, s41, 7
    s_and_b32 s26, s24, 1
    s_lshl_b32 s26, s26, 6
    s_add_u32 s25, s25, s26
    s_lshl_b32 s26, s40, 16
    s_add_u32 s25, s25, s26
    v_add3_u32 v8, v8, v9, s25
    s_lshl_b32 s25, s24, 11
    v_add_u32 v9, s25, v4
    s_and_b32 s25, s24, 1
    s_lshl_b32 s25, s25, 10
    v_add_u32 v10, s25, v4
    s_mov_b32 s31, s29
L_t4_loop:
    s_lshl_b32 s26, s31, 7
    s_add_u32 s26, s26, 598016
    v_mov_b32 v120, 0
L_t4_wo_w:
    buffer_load_dword v121, v120, s[8:11], s26 offen sc1
    s_waitcnt vmcnt(0)
    v_readfirstlane_b32 s28, v121
    s_cmp_ge_u32 s28, 64
    s_cbranch_scc1 L_t4_wo_d
    s_add_u32 s28, s28, 63
    s_cmp_ge_u32 s28, 64
    s_cbranch_scc1 L_t4_wo_n
    s_sleep 24
L_t4_wo_n:
    s_sleep 1
    s_add_u32 s35, s35, 1
    s_cmp_lt_u32 s35, 1000000
    s_cbranch_scc1 L_t4_wo_w
    s_endpgm
L_t4_wo_d:
    s_lshl_b32 s25, s31, 18
    s_lshl_b32 s26, s24, 16
    s_add_u32 s25, s25, s26
    s_lshl_b32 s26, s40, 12
    s_add_u32 s25, s25, s26
    s_add_u32 s25, s25, 67108864
    s_add_u32 s26, s25, 0
    buffer_load_dwordx4 v[32:35], v4, s[8:11], s26 offen offset:0 sc1
    buffer_load_dwordx4 v[36:39], v4, s[8:11], s26 offen offset:1024 sc1
    buffer_load_dwordx4 v[40:43], v4, s[8:11], s26 offen offset:2048 sc1
    buffer_load_dwordx4 v[44:47], v4, s[8:11], s26 offen offset:3072 sc1
    s_add_u32 s26, s25, 8192
    buffer_load_dwordx4 v[48:51], v4, s[8:11], s26 offen offset:0 sc1
    buffer_load_dwordx4 v[52:55], v4, s[8:11], s26 offen offset:1024 sc1
    buffer_load_dwordx4 v[56:59], v4, s[8:11], s26 offen offset:2048 sc1
    buffer_load_dwordx4 v[60:63], v4, s[8:11], s26 offen offset:3072 sc1
    s_add_u32 s26, s25, 16384
    buffer_load_dwordx4 v[64:67], v4, s[8:11], s26 offen offset:0 sc1
    buffer_load_dwordx4 v[68:71], v4, s[8:11], s26 offen offset:1024 sc1
    buffer_load_dwordx4 v[72:75], v4, s[8:11], s26 offen offset:2048 sc1
    buffer_load_dwordx4 v[76:79], v4, s[8:11], s26 offen offset:3072 sc1
    s_add_u32 s26, s25, 24576
    buffer_load_dwordx4 v[80:83], v4, s[8:11], s26 offen offset:0 sc1
    buffer_load_dwordx4 v[84:87], v4, s[8:11], s26 offen offset:1024 sc1
    buffer_load_dwordx4 v[88:91], v4, s[8:11], s26 offen offset:2048 sc1
    buffer_load_dwordx4 v[92:95], v4, s[8:11], s26 offen offset:3072 sc1
    s_add_u32 s26, s25, 32768
    buffer_load_dwordx4 v[96:99], v4, s[8:11], s26 offen offset:0 sc1
    buffer_load_dwordx4 v[100:103], v4, s[8:11], s26 offen offset:1024 sc1
    buffer_load_dwordx4 v[104:107], v4, s[8:11], s26 offen offset:2048 sc1
    buffer_load_dwordx4 v[108:111], v4, s[8:11], s26 offen offset:3072 sc1
    s_add_u32 s26, s25, 40960
    buffer_load_dwordx4 v[112:115], v4, s[8:11], s26 offen offset:0 sc1
    buffer_load_dwordx4 v[116:119], v4, s[8:11], s26 offen offset:1024 sc1
    buffer_load_dwordx4 v[120:123], v4, s[8:11], s26 offen offset:2048 sc1
    buffer_load_dwordx4 v[124:127], v4, s[8:11], s26 offen offset:3072 sc1
    s_add_u32 s26, s25, 49152
    buffer_load_dwordx4 v[128:131], v4, s[8:11], s26 offen offset:0 sc1
    buffer_load_dwordx4 v[132:135], v4, s[8:11], s26 offen offset:1024 sc1
    buffer_load_dwordx4 v[136:139], v4, s[8:11], s26 offen offset:2048 sc1
    buffer_load_dwordx4 v[140:143], v4, s[8:11], s26 offen offset:3072 sc1
    s_add_u32 s26, s25, 57344
    buffer_load_dwordx4 v[144:147], v4, s[8:11], s26 offen offset:0 sc1
    buffer_load_dwordx4 v[148:151], v4, s[8:11], s26 offen offset:1024 sc1
    buffer_load_dwordx4 v[152:155], v4, s[8:11], s26 offen offset:2048 sc1
    buffer_load_dwordx4 v[156:159], v4, s[8:11], s26 offen offset:3072 sc1
    s_waitcnt vmcnt(31)
    v_mfma_f32_16x16x32_bf16 v[16:19], v[32:35], a[0:3], 0
    v_mfma_f32_16x16x32_bf16 v[20:23], v[32:35], a[4:7], 0
    s_waitcnt vmcnt(30)
    v_mfma_f32_16x16x32_bf16 v[16:19], v[36:39], a[8:11], v[16:19]
    v_mfma_f32_16x16x32_bf16 v[20:23], v[36:39], a[12:15], v[20:23]
    s_waitcnt vmcnt(29)
    v_mfma_f32_16x16x32_bf16 v[16:19], v[40:43], a[16:19], v[16:19]
    v_mfma_f32_16x16x32_bf16 v[20:23], v[40:43], a[20:23], v[20:23]
    s_waitcnt vmcnt(28)
    v_mfma_f32_16x16x32_bf16 v[16:19], v[44:47], a[24:27], v[16:19]
    v_mfma_f32_16x16x32_bf16 v[20:23], v[44:47], a[28:31], v[20:23]
    s_waitcnt vmcnt(27)
    v_mfma_f32_16x16x32_bf16 v[16:19], v[48:51], a[32:35], v[16:19]
    v_mfma_f32_16x16x32_bf16 v[20:23], v[48:51], a[36:39], v[20:23]
    s_waitcnt vmcnt(26)
    v_mfma_f32_16x16x32_bf16 v[16:19], v[52:55], a[40:43], v[16:19]
    v_mfma_f32_16x16x32_bf16 v[20:23], v[52:55], a[44:47], v[20:23]
    s_waitcnt vmcnt(25)
    v_mfma_f32_16x16x32_bf16 v[16:19], v[56:59], a[48:51], v[16:19]
    v_mfma_f32_16x16x32_bf16 v[20:23], v[56:59], a[52:55], v[20:23]
    s_waitcnt vmcnt(24)
    v_mfma_f32_16x16x32_bf16 v[16:19], v[60:63], a[56:59], v[16:19]
    v_mfma_f32_16x16x32_bf16 v[20:23], v[60:63], a[60:63], v[20:23]
    s_waitcnt vmcnt(23)
    v_mfma_f32_16x16x32_bf16 v[16:19], v[64:67], a[64:67], v[16:19]
    v_mfma_f32_16x16x32_bf16 v[20:23], v[64:67], a[68:71], v[20:23]
    s_waitcnt vmcnt(22)
    v_mfma_f32_16x16x32_bf16 v[16:19], v[68:71], a[72:75], v[16:19]
    v_mfma_f32_16x16x32_bf16 v[20:23], v[68:71], a[76:79], v[20:23]
    s_waitcnt vmcnt(21)
    v_mfma_f32_16x16x32_bf16 v[16:19], v[72:75], a[80:83], v[16:19]
    v_mfma_f32_16x16x32_bf16 v[20:23], v[72:75], a[84:87], v[20:23]
    s_waitcnt vmcnt(20)
    v_mfma_f32_16x16x32_bf16 v[16:19], v[76:79], a[88:91], v[16:19]
    v_mfma_f32_16x16x32_bf16 v[20:23], v[76:79], a[92:95], v[20:23]
    s_waitcnt vmcnt(19)
    v_mfma_f32_16x16x32_bf16 v[16:19], v[80:83], a[96:99], v[16:19]
    v_mfma_f32_16x16x32_bf16 v[20:23], v[80:83], a[100:103], v[20:23]
    s_waitcnt vmcnt(18)
    v_mfma_f32_16x16x32_bf16 v[16:19], v[84:87], a[104:107], v[16:19]
    v_mfma_f32_16x16x32_bf16 v[20:23], v[84:87], a[108:111], v[20:23]
    s_waitcnt vmcnt(17)
    v_mfma_f32_16x16x32_bf16 v[16:19], v[88:91], a[112:115], v[16:19]
    v_mfma_f32_16x16x32_bf16 v[20:23], v[88:91], a[116:119], v[20:23]
    s_waitcnt vmcnt(16)
    v_mfma_f32_16x16x32_bf16 v[16:19], v[92:95], a[120:123], v[16:19]
    v_mfma_f32_16x16x32_bf16 v[20:23], v[92:95], a[124:127], v[20:23]
    s_waitcnt vmcnt(15)
    v_mfma_f32_16x16x32_bf16 v[16:19], v[96:99], a[128:131], v[16:19]
    v_mfma_f32_16x16x32_bf16 v[20:23], v[96:99], a[132:135], v[20:23]
    s_waitcnt vmcnt(14)
    v_mfma_f32_16x16x32_bf16 v[16:19], v[100:103], a[136:139], v[16:19]
    v_mfma_f32_16x16x32_bf16 v[20:23], v[100:103], a[140:143], v[20:23]
    s_waitcnt vmcnt(13)
    v_mfma_f32_16x16x32_bf16 v[16:19], v[104:107], a[144:147], v[16:19]
    v_mfma_f32_16x16x32_bf16 v[20:23], v[104:107], a[148:151], v[20:23]
    s_waitcnt vmcnt(12)
    v_mfma_f32_16x16x32_bf16 v[16:19], v[108:111], a[152:155], v[16:19]
    v_mfma_f32_16x16x32_bf16 v[20:23], v[108:111], a[156:159], v[20:23]
    s_waitcnt vmcnt(11)
    v_mfma_f32_16x16x32_bf16 v[16:19], v[112:115], a[160:163], v[16:19]
    v_mfma_f32_16x16x32_bf16 v[20:23], v[112:115], a[164:167], v[20:23]
    s_waitcnt vmcnt(10)
    v_mfma_f32_16x16x32_bf16 v[16:19], v[116:119], a[168:171], v[16:19]
    v_mfma_f32_16x16x32_bf16 v[20:23], v[116:119], a[172:175], v[20:23]
    s_waitcnt vmcnt(9)
    v_mfma_f32_16x16x32_bf16 v[16:19], v[120:123], a[176:179], v[16:19]
    v_mfma_f32_16x16x32_bf16 v[20:23], v[120:123], a[180:183], v[20:23]
    s_waitcnt vmcnt(8)
    v_mfma_f32_16x16x32_bf16 v[16:19], v[124:127], a[184:187], v[16:19]
    v_mfma_f32_16x16x32_bf16 v[20:23], v[124:127], a[188:191], v[20:23]
    s_waitcnt vmcnt(7)
    v_mfma_f32_16x16x32_bf16 v[16:19], v[128:131], a[192:195], v[16:19]
    v_mfma_f32_16x16x32_bf16 v[20:23], v[128:131], a[196:199], v[20:23]
    s_waitcnt vmcnt(6)
    v_mfma_f32_16x16x32_bf16 v[16:19], v[132:135], a[200:203], v[16:19]
    v_mfma_f32_16x16x32_bf16 v[20:23], v[132:135], a[204:207], v[20:23]
    s_waitcnt vmcnt(5)
    v_mfma_f32_16x16x32_bf16 v[16:19], v[136:139], a[208:211], v[16:19]
    v_mfma_f32_16x16x32_bf16 v[20:23], v[136:139], a[212:215], v[20:23]
    s_waitcnt vmcnt(4)
    v_mfma_f32_16x16x32_bf16 v[16:19], v[140:143], a[216:219], v[16:19]
    v_mfma_f32_16x16x32_bf16 v[20:23], v[140:143], a[220:223], v[20:23]
    s_waitcnt vmcnt(3)
    v_mfma_f32_16x16x32_bf16 v[16:19], v[144:147], a[224:227], v[16:19]
    v_mfma_f32_16x16x32_bf16 v[20:23], v[144:147], a[228:231], v[20:23]
    s_waitcnt vmcnt(2)
    v_mfma_f32_16x16x32_bf16 v[16:19], v[148:151], a[232:235], v[16:19]
    v_mfma_f32_16x16x32_bf16 v[20:23], v[148:151], a[236:239], v[20:23]
    s_waitcnt vmcnt(1)
    v_mfma_f32_16x16x32_bf16 v[16:19], v[152:155], a[240:243], v[16:19]
    v_mfma_f32_16x16x32_bf16 v[20:23], v[152:155], a[244:247], v[20:23]
    s_waitcnt vmcnt(0)
    v_mfma_f32_16x16x32_bf16 v[16:19], v[156:159], a[248:251], v[16:19]
    v_mfma_f32_16x16x32_bf16 v[20:23], v[156:159], a[252:255], v[20:23]
    s_nop 7
    ds_write_b128 v9, v[16:19] offset:0
    ds_write_b128 v9, v[20:23] offset:1024
    s_waitcnt lgkmcnt(0)
    s_barrier
    s_cmp_ge_u32 s24, 2
    s_cbranch_scc1 L_t4_skip
    ds_read_b128 v[16:19], v10 offset:0
    ds_read_b128 v[20:23], v10 offset:2048
    ds_read_b128 v[24:27], v10 offset:4096
    ds_read_b128 v[28:31], v10 offset:6144
    s_waitcnt lgkmcnt(0)
    s_lshl_b32 s25, s31, 17
    v_add_f32 v16, v16, v20
    v_add_f32 v24, v24, v28
    v_add_f32 v16, v16, v24
    s_add_u32 s26, s25, 0
    buffer_store_dword v16, v8, s[20:23], s26 offen sc1
    v_add_f32 v17, v17, v21
    v_add_f32 v25, v25, v29
    v_add_f32 v17, v17, v25
    s_add_u32 s26, s25, 4096
    buffer_store_dword v17, v8, s[20:23], s26 offen sc1
    v_add_f32 v18, v18, v22
    v_add_f32 v26, v26, v30
    v_add_f32 v18, v18, v26
    s_add_u32 s26, s25, 8192
    buffer_store_dword v18, v8, s[20:23], s26 offen sc1
    v_add_f32 v19, v19, v23
    v_add_f32 v27, v27, v31
    v_add_f32 v19, v19, v27
    s_add_u32 s26, s25, 12288
    buffer_store_dword v19, v8, s[20:23], s26 offen sc1
L_t4_skip:
    s_barrier
    s_add_u32 s31, s31, 4
    s_cmp_lt_u32 s31, 64
    s_cbranch_scc1 L_t4_loop
    s_waitcnt vmcnt(0)
    s_waitcnt vmcnt(0)
    s_endpgm
L_scan:
    s_sub_u32 s63, s60, 176
    s_mov_b32 s30, s63

    v_and_b32 v1, 63, v0
    v_and_b32 v2, 15, v1
    v_lshrrev_b32 v3, 4, v0
    s_lshl_b32 s25, s30, 4
    v_add_u32 v4, s25, v2
    v_lshlrev_b32 v12, 1, v4
    s_load_dwordx2 s[16:17], s[0:1], 64
    s_mov_b32 s18, 1024
    s_mov_b32 s19, 0x20000
    s_waitcnt lgkmcnt(0)
    buffer_load_ushort v13, v12, s[16:19], 0 offen
    s_load_dwordx2 s[16:17], s[0:1], 72
    s_mov_b32 s18, 1024
    s_mov_b32 s19, 0x20000
    s_waitcnt lgkmcnt(0)
    buffer_load_ushort v14, v12, s[16:19], 0 offen
    s_load_dwordx2 s[16:17], s[0:1], 112
    s_mov_b32 s18, 1024
    s_mov_b32 s19, 0x20000
    s_waitcnt lgkmcnt(0)
    buffer_load_ushort v15, v12, s[16:19], 0 offen
    s_waitcnt vmcnt(0)
    v_lshlrev_b32 v13, 16, v13
    v_lshlrev_b32 v14, 16, v14
    v_lshlrev_b32 v15, 16, v15
    v_mul_f32 v15, 0x3fb8aa3b, v15
    v_exp_f32 v15, v15
    s_nop 1
    v_cvt_pk_bf16_f32 v15, v15, v15
    v_lshlrev_b32 v15, 16, v15
    v_mul_f32 v16, v15, v13
    v_mul_f32 v17, v15, v14
    v_mul_f32 v16, 0x3fb8aa3b, v16
    v_exp_f32 v16, v16
    v_mul_f32 v17, 0.15915494, v17
    v_rndne_f32 v18, v17
    v_sub_f32 v17, v17, v18
    v_cos_f32 v18, v17
    v_sin_f32 v19, v17
    s_nop 1
    v_mul_f32 v8, v16, v18
    v_mul_f32 v9, v16, v19
    v_add_f32 v16, -1.0, v8
    v_mul_f32 v17, v13, v13
    v_fma_f32 v17, v14, v14, v17
    v_rcp_f32 v17, v17
    v_mul_f32 v18, v16, v13
    v_fma_f32 v18, v9, v14, v18
    v_mul_f32 v19, v9, v13
    v_fma_f32 v19, -v16, v14, v19
    v_mul_f32 v10, v18, v17
    v_mul_f32 v11, v19, v17
    v_mov_b32 v12, v8
    v_mov_b32 v13, v9
    v_mul_f32 v14, v12, v12
    v_fma_f32 v14, -v13, v13, v14
    v_mul_f32 v15, v12, v13
    v_add_f32 v13, v15, v15
    v_mov_b32 v12, v14
    v_mul_f32 v14, v12, v12
    v_fma_f32 v14, -v13, v13, v14
    v_mul_f32 v15, v12, v13
    v_add_f32 v13, v15, v15
    v_mov_b32 v12, v14
    v_mul_f32 v14, v12, v12
    v_fma_f32 v14, -v13, v13, v14
    v_mul_f32 v15, v12, v13
    v_add_f32 v13, v15, v15
    v_mov_b32 v12, v14
    v_mul_f32 v14, v12, v12
    v_fma_f32 v14, -v13, v13, v14
    v_mul_f32 v15, v12, v13
    v_add_f32 v13, v15, v15
    v_mov_b32 v12, v14
    v_mul_f32 v14, v12, v12
    v_fma_f32 v14, -v13, v13, v14
    v_mul_f32 v15, v12, v13
    v_add_f32 v13, v15, v15
    v_mov_b32 v12, v14
    v_mul_f32 v14, v12, v12
    v_fma_f32 v14, -v13, v13, v14
    v_mul_f32 v15, v12, v13
    v_add_f32 v13, v15, v15
    v_mov_b32 v12, v14
    v_mul_f32 v14, v12, v12
    v_fma_f32 v14, -v13, v13, v14
    v_mul_f32 v15, v12, v13
    v_add_f32 v13, v15, v15
    v_mov_b32 v12, v14
    s_mov_b32 s25, 591104
    v_mov_b32 v120, 0
L_sc_wu_w:
    buffer_load_dword v121, v120, s[8:11], s25 offen sc1
    s_waitcnt vmcnt(0)
    v_readfirstlane_b32 s28, v121
    s_cmp_ge_u32 s28, 256
    s_cbranch_scc1 L_sc_wu_d
    s_sleep 4
    s_add_u32 s35, s35, 1
    s_cmp_lt_u32 s35, 1000000
    s_cbranch_scc1 L_sc_wu_w
    s_endpgm
L_sc_wu_d:
    v_lshlrev_b32 v5, 19, v3
    v_lshlrev_b32 v6, 3, v4
    v_add_u32 v5, v5, v6
    v_lshlrev_b32 v6, 18, v3
    v_lshlrev_b32 v7, 2, v4
    v_add_u32 v6, v6, v7
    v_mov_b32 v16, 0
    v_mov_b32 v17, 0
    s_mov_b32 s40, 100663296
    s_mov_b32 s41, 109051904
    s_mov_b32 s42, 0
    s_add_u32 s26, s40, 0
    buffer_load_dwordx2 v[32:33], v5, s[8:11], s26 offen sc1
    s_add_u32 s26, s40, 4096
    buffer_load_dwordx2 v[34:35], v5, s[8:11], s26 offen sc1
    s_add_u32 s26, s40, 8192
    buffer_load_dwordx2 v[36:37], v5, s[8:11], s26 offen sc1
    s_add_u32 s26, s40, 12288
    buffer_load_dwordx2 v[38:39], v5, s[8:11], s26 offen sc1
    s_add_u32 s26, s40, 16384
    buffer_load_dwordx2 v[40:41], v5, s[8:11], s26 offen sc1
    s_add_u32 s26, s40, 20480
    buffer_load_dwordx2 v[42:43], v5, s[8:11], s26 offen sc1
    s_add_u32 s26, s40, 24576
    buffer_load_dwordx2 v[44:45], v5, s[8:11], s26 offen sc1
    s_add_u32 s26, s40, 28672
    buffer_load_dwordx2 v[46:47], v5, s[8:11], s26 offen sc1
    s_add_u32 s26, s40, 32768
    buffer_load_dwordx2 v[48:49], v5, s[8:11], s26 offen sc1
    s_add_u32 s26, s40, 36864
    buffer_load_dwordx2 v[50:51], v5, s[8:11], s26 offen sc1
    s_add_u32 s26, s40, 40960
    buffer_load_dwordx2 v[52:53], v5, s[8:11], s26 offen sc1
    s_add_u32 s26, s40, 45056
    buffer_load_dwordx2 v[54:55], v5, s[8:11], s26 offen sc1
    s_add_u32 s26, s40, 49152
    buffer_load_dwordx2 v[56:57], v5, s[8:11], s26 offen sc1
    s_add_u32 s26, s40, 53248
    buffer_load_dwordx2 v[58:59], v5, s[8:11], s26 offen sc1
    s_add_u32 s26, s40, 57344
    buffer_load_dwordx2 v[60:61], v5, s[8:11], s26 offen sc1
    s_add_u32 s26, s40, 61440
    buffer_load_dwordx2 v[62:63], v5, s[8:11], s26 offen sc1
L_sc_p0:
    s_add_u32 s40, s40, 65536
    s_add_u32 s26, s40, 0
    buffer_load_dwordx2 v[64:65], v5, s[8:11], s26 offen sc1
    s_add_u32 s26, s40, 4096
    buffer_load_dwordx2 v[66:67], v5, s[8:11], s26 offen sc1
    s_add_u32 s26, s40, 8192
    buffer_load_dwordx2 v[68:69], v5, s[8:11], s26 offen sc1
    s_add_u32 s26, s40, 12288
    buffer_load_dwordx2 v[70:71], v5, s[8:11], s26 offen sc1
    s_add_u32 s26, s40, 16384
    buffer_load_dwordx2 v[72:73], v5, s[8:11], s26 offen sc1
    s_add_u32 s26, s40, 20480
    buffer_load_dwordx2 v[74:75], v5, s[8:11], s26 offen sc1
    s_add_u32 s26, s40, 24576
    buffer_load_dwordx2 v[76:77], v5, s[8:11], s26 offen sc1
    s_add_u32 s26, s40, 28672
    buffer_load_dwordx2 v[78:79], v5, s[8:11], s26 offen sc1
    s_add_u32 s26, s40, 32768
    buffer_load_dwordx2 v[80:81], v5, s[8:11], s26 offen sc1
    s_add_u32 s26, s40, 36864
    buffer_load_dwordx2 v[82:83], v5, s[8:11], s26 offen sc1
    s_add_u32 s26, s40, 40960
    buffer_load_dwordx2 v[84:85], v5, s[8:11], s26 offen sc1
    s_add_u32 s26, s40, 45056
    buffer_load_dwordx2 v[86:87], v5, s[8:11], s26 offen sc1
    s_add_u32 s26, s40, 49152
    buffer_load_dwordx2 v[88:89], v5, s[8:11], s26 offen sc1
    s_add_u32 s26, s40, 53248
    buffer_load_dwordx2 v[90:91], v5, s[8:11], s26 offen sc1
    s_add_u32 s26, s40, 57344
    buffer_load_dwordx2 v[92:93], v5, s[8:11], s26 offen sc1
    s_add_u32 s26, s40, 61440
    buffer_load_dwordx2 v[94:95], v5, s[8:11], s26 offen sc1
    s_waitcnt vmcnt(16)
    v_fma_f32 v18, v8, v16, v32
    v_fma_f32 v19, v8, v17, v33
    v_fma_f32 v18, -v9, v17, v18
    v_fma_f32 v17, v9, v16, v19
    v_mov_b32 v16, v18
    v_fma_f32 v18, v8, v16, v34
    v_fma_f32 v19, v8, v17, v35
    v_fma_f32 v18, -v9, v17, v18
    v_fma_f32 v17, v9, v16, v19
    v_mov_b32 v16, v18
    v_fma_f32 v18, v8, v16, v36
    v_fma_f32 v19, v8, v17, v37
    v_fma_f32 v18, -v9, v17, v18
    v_fma_f32 v17, v9, v16, v19
    v_mov_b32 v16, v18
    v_fma_f32 v18, v8, v16, v38
    v_fma_f32 v19, v8, v17, v39
    v_fma_f32 v18, -v9, v17, v18
    v_fma_f32 v17, v9, v16, v19
    v_mov_b32 v16, v18
    v_fma_f32 v18, v8, v16, v40
    v_fma_f32 v19, v8, v17, v41
    v_fma_f32 v18, -v9, v17, v18
    v_fma_f32 v17, v9, v16, v19
    v_mov_b32 v16, v18
    v_fma_f32 v18, v8, v16, v42
    v_fma_f32 v19, v8, v17, v43
    v_fma_f32 v18, -v9, v17, v18
    v_fma_f32 v17, v9, v16, v19
    v_mov_b32 v16, v18
    v_fma_f32 v18, v8, v16, v44
    v_fma_f32 v19, v8, v17, v45
    v_fma_f32 v18, -v9, v17, v18
    v_fma_f32 v17, v9, v16, v19
    v_mov_b32 v16, v18
    v_fma_f32 v18, v8, v16, v46
    v_fma_f32 v19, v8, v17, v47
    v_fma_f32 v18, -v9, v17, v18
    v_fma_f32 v17, v9, v16, v19
    v_mov_b32 v16, v18
    v_fma_f32 v18, v8, v16, v48
    v_fma_f32 v19, v8, v17, v49
    v_fma_f32 v18, -v9, v17, v18
    v_fma_f32 v17, v9, v16, v19
    v_mov_b32 v16, v18
    v_fma_f32 v18, v8, v16, v50
    v_fma_f32 v19, v8, v17, v51
    v_fma_f32 v18, -v9, v17, v18
    v_fma_f32 v17, v9, v16, v19
    v_mov_b32 v16, v18
    v_fma_f32 v18, v8, v16, v52
    v_fma_f32 v19, v8, v17, v53
    v_fma_f32 v18, -v9, v17, v18
    v_fma_f32 v17, v9, v16, v19
    v_mov_b32 v16, v18
    v_fma_f32 v18, v8, v16, v54
    v_fma_f32 v19, v8, v17, v55
    v_fma_f32 v18, -v9, v17, v18
    v_fma_f32 v17, v9, v16, v19
    v_mov_b32 v16, v18
    v_fma_f32 v18, v8, v16, v56
    v_fma_f32 v19, v8, v17, v57
    v_fma_f32 v18, -v9, v17, v18
    v_fma_f32 v17, v9, v16, v19
    v_mov_b32 v16, v18
    v_fma_f32 v18, v8, v16, v58
    v_fma_f32 v19, v8, v17, v59
    v_fma_f32 v18, -v9, v17, v18
    v_fma_f32 v17, v9, v16, v19
    v_mov_b32 v16, v18
    v_fma_f32 v18, v8, v16, v60
    v_fma_f32 v19, v8, v17, v61
    v_fma_f32 v18, -v9, v17, v18
    v_fma_f32 v17, v9, v16, v19
    v_mov_b32 v16, v18
    v_fma_f32 v18, v8, v16, v62
    v_fma_f32 v19, v8, v17, v63
    v_fma_f32 v18, -v9, v17, v18
    v_fma_f32 v17, v9, v16, v19
    v_mov_b32 v16, v18
    s_add_u32 s41, s41, 32768
    s_add_u32 s40, s40, 65536
    s_add_u32 s42, s42, 1
    s_cmp_ge_u32 s42, 4
    s_cbranch_scc1 L_sc_p0_last
    s_add_u32 s26, s40, 0
    buffer_load_dwordx2 v[32:33], v5, s[8:11], s26 offen sc1
    s_add_u32 s26, s40, 4096
    buffer_load_dwordx2 v[34:35], v5, s[8:11], s26 offen sc1
    s_add_u32 s26, s40, 8192
    buffer_load_dwordx2 v[36:37], v5, s[8:11], s26 offen sc1
    s_add_u32 s26, s40, 12288
    buffer_load_dwordx2 v[38:39], v5, s[8:11], s26 offen sc1
    s_add_u32 s26, s40, 16384
    buffer_load_dwordx2 v[40:41], v5, s[8:11], s26 offen sc1
    s_add_u32 s26, s40, 20480
    buffer_load_dwordx2 v[42:43], v5, s[8:11], s26 offen sc1
    s_add_u32 s26, s40, 24576
    buffer_load_dwordx2 v[44:45], v5, s[8:11], s26 offen sc1
    s_add_u32 s26, s40, 28672
    buffer_load_dwordx2 v[46:47], v5, s[8:11], s26 offen sc1
    s_add_u32 s26, s40, 32768
    buffer_load_dwordx2 v[48:49], v5, s[8:11], s26 offen sc1
    s_add_u32 s26, s40, 36864
    buffer_load_dwordx2 v[50:51], v5, s[8:11], s26 offen sc1
    s_add_u32 s26, s40, 40960
    buffer_load_dwordx2 v[52:53], v5, s[8:11], s26 offen sc1
    s_add_u32 s26, s40, 45056
    buffer_load_dwordx2 v[54:55], v5, s[8:11], s26 offen sc1
    s_add_u32 s26, s40, 49152
    buffer_load_dwordx2 v[56:57], v5, s[8:11], s26 offen sc1
    s_add_u32 s26, s40, 53248
    buffer_load_dwordx2 v[58:59], v5, s[8:11], s26 offen sc1
    s_add_u32 s26, s40, 57344
    buffer_load_dwordx2 v[60:61], v5, s[8:11], s26 offen sc1
    s_add_u32 s26, s40, 61440
    buffer_load_dwordx2 v[62:63], v5, s[8:11], s26 offen sc1
    s_waitcnt vmcnt(16)
    v_fma_f32 v18, v8, v16, v64
    v_fma_f32 v19, v8, v17, v65
    v_fma_f32 v18, -v9, v17, v18
    v_fma_f32 v17, v9, v16, v19
    v_mov_b32 v16, v18
    v_fma_f32 v18, v8, v16, v66
    v_fma_f32 v19, v8, v17, v67
    v_fma_f32 v18, -v9, v17, v18
    v_fma_f32 v17, v9, v16, v19
    v_mov_b32 v16, v18
    v_fma_f32 v18, v8, v16, v68
    v_fma_f32 v19, v8, v17, v69
    v_fma_f32 v18, -v9, v17, v18
    v_fma_f32 v17, v9, v16, v19
    v_mov_b32 v16, v18
    v_fma_f32 v18, v8, v16, v70
    v_fma_f32 v19, v8, v17, v71
    v_fma_f32 v18, -v9, v17, v18
    v_fma_f32 v17, v9, v16, v19
    v_mov_b32 v16, v18
    v_fma_f32 v18, v8, v16, v72
    v_fma_f32 v19, v8, v17, v73
    v_fma_f32 v18, -v9, v17, v18
    v_fma_f32 v17, v9, v16, v19
    v_mov_b32 v16, v18
    v_fma_f32 v18, v8, v16, v74
    v_fma_f32 v19, v8, v17, v75
    v_fma_f32 v18, -v9, v17, v18
    v_fma_f32 v17, v9, v16, v19
    v_mov_b32 v16, v18
    v_fma_f32 v18, v8, v16, v76
    v_fma_f32 v19, v8, v17, v77
    v_fma_f32 v18, -v9, v17, v18
    v_fma_f32 v17, v9, v16, v19
    v_mov_b32 v16, v18
    v_fma_f32 v18, v8, v16, v78
    v_fma_f32 v19, v8, v17, v79
    v_fma_f32 v18, -v9, v17, v18
    v_fma_f32 v17, v9, v16, v19
    v_mov_b32 v16, v18
    v_fma_f32 v18, v8, v16, v80
    v_fma_f32 v19, v8, v17, v81
    v_fma_f32 v18, -v9, v17, v18
    v_fma_f32 v17, v9, v16, v19
    v_mov_b32 v16, v18
    v_fma_f32 v18, v8, v16, v82
    v_fma_f32 v19, v8, v17, v83
    v_fma_f32 v18, -v9, v17, v18
    v_fma_f32 v17, v9, v16, v19
    v_mov_b32 v16, v18
    v_fma_f32 v18, v8, v16, v84
    v_fma_f32 v19, v8, v17, v85
    v_fma_f32 v18, -v9, v17, v18
    v_fma_f32 v17, v9, v16, v19
    v_mov_b32 v16, v18
    v_fma_f32 v18, v8, v16, v86
    v_fma_f32 v19, v8, v17, v87
    v_fma_f32 v18, -v9, v17, v18
    v_fma_f32 v17, v9, v16, v19
    v_mov_b32 v16, v18
    v_fma_f32 v18, v8, v16, v88
    v_fma_f32 v19, v8, v17, v89
    v_fma_f32 v18, -v9, v17, v18
    v_fma_f32 v17, v9, v16, v19
    v_mov_b32 v16, v18
    v_fma_f32 v18, v8, v16, v90
    v_fma_f32 v19, v8, v17, v91
    v_fma_f32 v18, -v9, v17, v18
    v_fma_f32 v17, v9, v16, v19
    v_mov_b32 v16, v18
    v_fma_f32 v18, v8, v16, v92
    v_fma_f32 v19, v8, v17, v93
    v_fma_f32 v18, -v9, v17, v18
    v_fma_f32 v17, v9, v16, v19
    v_mov_b32 v16, v18
    v_fma_f32 v18, v8, v16, v94
    v_fma_f32 v19, v8, v17, v95
    v_fma_f32 v18, -v9, v17, v18
    v_fma_f32 v17, v9, v16, v19
    v_mov_b32 v16, v18
    s_add_u32 s41, s41, 32768
    s_branch L_sc_p0
L_sc_p0_last:
    s_waitcnt vmcnt(0)
    v_fma_f32 v18, v8, v16, v64
    v_fma_f32 v19, v8, v17, v65
    v_fma_f32 v18, -v9, v17, v18
    v_fma_f32 v17, v9, v16, v19
    v_mov_b32 v16, v18
    v_fma_f32 v18, v8, v16, v66
    v_fma_f32 v19, v8, v17, v67
    v_fma_f32 v18, -v9, v17, v18
    v_fma_f32 v17, v9, v16, v19
    v_mov_b32 v16, v18
    v_fma_f32 v18, v8, v16, v68
    v_fma_f32 v19, v8, v17, v69
    v_fma_f32 v18, -v9, v17, v18
    v_fma_f32 v17, v9, v16, v19
    v_mov_b32 v16, v18
    v_fma_f32 v18, v8, v16, v70
    v_fma_f32 v19, v8, v17, v71
    v_fma_f32 v18, -v9, v17, v18
    v_fma_f32 v17, v9, v16, v19
    v_mov_b32 v16, v18
    v_fma_f32 v18, v8, v16, v72
    v_fma_f32 v19, v8, v17, v73
    v_fma_f32 v18, -v9, v17, v18
    v_fma_f32 v17, v9, v16, v19
    v_mov_b32 v16, v18
    v_fma_f32 v18, v8, v16, v74
    v_fma_f32 v19, v8, v17, v75
    v_fma_f32 v18, -v9, v17, v18
    v_fma_f32 v17, v9, v16, v19
    v_mov_b32 v16, v18
    v_fma_f32 v18, v8, v16, v76
    v_fma_f32 v19, v8, v17, v77
    v_fma_f32 v18, -v9, v17, v18
    v_fma_f32 v17, v9, v16, v19
    v_mov_b32 v16, v18
    v_fma_f32 v18, v8, v16, v78
    v_fma_f32 v19, v8, v17, v79
    v_fma_f32 v18, -v9, v17, v18
    v_fma_f32 v17, v9, v16, v19
    v_mov_b32 v16, v18
    v_fma_f32 v18, v8, v16, v80
    v_fma_f32 v19, v8, v17, v81
    v_fma_f32 v18, -v9, v17, v18
    v_fma_f32 v17, v9, v16, v19
    v_mov_b32 v16, v18
    v_fma_f32 v18, v8, v16, v82
    v_fma_f32 v19, v8, v17, v83
    v_fma_f32 v18, -v9, v17, v18
    v_fma_f32 v17, v9, v16, v19
    v_mov_b32 v16, v18
    v_fma_f32 v18, v8, v16, v84
    v_fma_f32 v19, v8, v17, v85
    v_fma_f32 v18, -v9, v17, v18
    v_fma_f32 v17, v9, v16, v19
    v_mov_b32 v16, v18
    v_fma_f32 v18, v8, v16, v86
    v_fma_f32 v19, v8, v17, v87
    v_fma_f32 v18, -v9, v17, v18
    v_fma_f32 v17, v9, v16, v19
    v_mov_b32 v16, v18
    v_fma_f32 v18, v8, v16, v88
    v_fma_f32 v19, v8, v17, v89
    v_fma_f32 v18, -v9, v17, v18
    v_fma_f32 v17, v9, v16, v19
    v_mov_b32 v16, v18
    v_fma_f32 v18, v8, v16, v90
    v_fma_f32 v19, v8, v17, v91
    v_fma_f32 v18, -v9, v17, v18
    v_fma_f32 v17, v9, v16, v19
    v_mov_b32 v16, v18
    v_fma_f32 v18, v8, v16, v92
    v_fma_f32 v19, v8, v17, v93
    v_fma_f32 v18, -v9, v17, v18
    v_fma_f32 v17, v9, v16, v19
    v_mov_b32 v16, v18
    v_fma_f32 v18, v8, v16, v94
    v_fma_f32 v19, v8, v17, v95
    v_fma_f32 v18, -v9, v17, v18
    v_fma_f32 v17, v9, v16, v19
    v_mov_b32 v16, v18
    v_lshlrev_b32 v18, 3, v0
    ds_write_b64 v18, v[16:17]
    s_waitcnt lgkmcnt(0)
    s_barrier
    v_lshlrev_b32 v18, 3, v2
    v_mov_b32 v16, 0
    v_mov_b32 v17, 0
    ds_read_b64 v[20:21], v18 offset:0
    v_cmp_lt_u32 vcc, 0, v3
    s_waitcnt lgkmcnt(0)
    v_fma_f32 v22, v12, v16, v20
    v_fma_f32 v23, v12, v17, v21
    v_fma_f32 v22, -v13, v17, v22
    v_fma_f32 v23, v13, v16, v23
    v_cndmask_b32 v16, v16, v22, vcc
    v_cndmask_b32 v17, v17, v23, vcc
    ds_read_b64 v[20:21], v18 offset:128
    v_cmp_lt_u32 vcc, 1, v3
    s_waitcnt lgkmcnt(0)
    v_fma_f32 v22, v12, v16, v20
    v_fma_f32 v23, v12, v17, v21
    v_fma_f32 v22, -v13, v17, v22
    v_fma_f32 v23, v13, v16, v23
    v_cndmask_b32 v16, v16, v22, vcc
    v_cndmask_b32 v17, v17, v23, vcc
    ds_read_b64 v[20:21], v18 offset:256
    v_cmp_lt_u32 vcc, 2, v3
    s_waitcnt lgkmcnt(0)
    v_fma_f32 v22, v12, v16, v20
    v_fma_f32 v23, v12, v17, v21
    v_fma_f32 v22, -v13, v17, v22
    v_fma_f32 v23, v13, v16, v23
    v_cndmask_b32 v16, v16, v22, vcc
    v_cndmask_b32 v17, v17, v23, vcc
    ds_read_b64 v[20:21], v18 offset:384
    v_cmp_lt_u32 vcc, 3, v3
    s_waitcnt lgkmcnt(0)
    v_fma_f32 v22, v12, v16, v20
    v_fma_f32 v23, v12, v17, v21
    v_fma_f32 v22, -v13, v17, v22
    v_fma_f32 v23, v13, v16, v23
    v_cndmask_b32 v16, v16, v22, vcc
    v_cndmask_b32 v17, v17, v23, vcc
    ds_read_b64 v[20:21], v18 offset:512
    v_cmp_lt_u32 vcc, 4, v3
    s_waitcnt lgkmcnt(0)
    v_fma_f32 v22, v12, v16, v20
    v_fma_f32 v23, v12, v17, v21
    v_fma_f32 v22, -v13, v17, v22
    v_fma_f32 v23, v13, v16, v23
    v_cndmask_b32 v16, v16, v22, vcc
    v_cndmask_b32 v17, v17, v23, vcc
    ds_read_b64 v[20:21], v18 offset:640
    v_cmp_lt_u32 vcc, 5, v3
    s_waitcnt lgkmcnt(0)
    v_fma_f32 v22, v12, v16, v20
    v_fma_f32 v23, v12, v17, v21
    v_fma_f32 v22, -v13, v17, v22
    v_fma_f32 v23, v13, v16, v23
    v_cndmask_b32 v16, v16, v22, vcc
    v_cndmask_b32 v17, v17, v23, vcc
    ds_read_b64 v[20:21], v18 offset:768
    v_cmp_lt_u32 vcc, 6, v3
    s_waitcnt lgkmcnt(0)
    v_fma_f32 v22, v12, v16, v20
    v_fma_f32 v23, v12, v17, v21
    v_fma_f32 v22, -v13, v17, v22
    v_fma_f32 v23, v13, v16, v23
    v_cndmask_b32 v16, v16, v22, vcc
    v_cndmask_b32 v17, v17, v23, vcc
    ds_read_b64 v[20:21], v18 offset:896
    v_cmp_lt_u32 vcc, 7, v3
    s_waitcnt lgkmcnt(0)
    v_fma_f32 v22, v12, v16, v20
    v_fma_f32 v23, v12, v17, v21
    v_fma_f32 v22, -v13, v17, v22
    v_fma_f32 v23, v13, v16, v23
    v_cndmask_b32 v16, v16, v22, vcc
    v_cndmask_b32 v17, v17, v23, vcc
    ds_read_b64 v[20:21], v18 offset:1024
    v_cmp_lt_u32 vcc, 8, v3
    s_waitcnt lgkmcnt(0)
    v_fma_f32 v22, v12, v16, v20
    v_fma_f32 v23, v12, v17, v21
    v_fma_f32 v22, -v13, v17, v22
    v_fma_f32 v23, v13, v16, v23
    v_cndmask_b32 v16, v16, v22, vcc
    v_cndmask_b32 v17, v17, v23, vcc
    ds_read_b64 v[20:21], v18 offset:1152
    v_cmp_lt_u32 vcc, 9, v3
    s_waitcnt lgkmcnt(0)
    v_fma_f32 v22, v12, v16, v20
    v_fma_f32 v23, v12, v17, v21
    v_fma_f32 v22, -v13, v17, v22
    v_fma_f32 v23, v13, v16, v23
    v_cndmask_b32 v16, v16, v22, vcc
    v_cndmask_b32 v17, v17, v23, vcc
    ds_read_b64 v[20:21], v18 offset:1280
    v_cmp_lt_u32 vcc, 10, v3
    s_waitcnt lgkmcnt(0)
    v_fma_f32 v22, v12, v16, v20
    v_fma_f32 v23, v12, v17, v21
    v_fma_f32 v22, -v13, v17, v22
    v_fma_f32 v23, v13, v16, v23
    v_cndmask_b32 v16, v16, v22, vcc
    v_cndmask_b32 v17, v17, v23, vcc
    ds_read_b64 v[20:21], v18 offset:1408
    v_cmp_lt_u32 vcc, 11, v3
    s_waitcnt lgkmcnt(0)
    v_fma_f32 v22, v12, v16, v20
    v_fma_f32 v23, v12, v17, v21
    v_fma_f32 v22, -v13, v17, v22
    v_fma_f32 v23, v13, v16, v23
    v_cndmask_b32 v16, v16, v22, vcc
    v_cndmask_b32 v17, v17, v23, vcc
    ds_read_b64 v[20:21], v18 offset:1536
    v_cmp_lt_u32 vcc, 12, v3
    s_waitcnt lgkmcnt(0)
    v_fma_f32 v22, v12, v16, v20
    v_fma_f32 v23, v12, v17, v21
    v_fma_f32 v22, -v13, v17, v22
    v_fma_f32 v23, v13, v16, v23
    v_cndmask_b32 v16, v16, v22, vcc
    v_cndmask_b32 v17, v17, v23, vcc
    ds_read_b64 v[20:21], v18 offset:1664
    v_cmp_lt_u32 vcc, 13, v3
    s_waitcnt lgkmcnt(0)
    v_fma_f32 v22, v12, v16, v20
    v_fma_f32 v23, v12, v17, v21
    v_fma_f32 v22, -v13, v17, v22
    v_fma_f32 v23, v13, v16, v23
    v_cndmask_b32 v16, v16, v22, vcc
    v_cndmask_b32 v17, v17, v23, vcc
    ds_read_b64 v[20:21], v18 offset:1792
    v_cmp_lt_u32 vcc, 14, v3
    s_waitcnt lgkmcnt(0)
    v_fma_f32 v22, v12, v16, v20
    v_fma_f32 v23, v12, v17, v21
    v_fma_f32 v22, -v13, v17, v22
    v_fma_f32 v23, v13, v16, v23
    v_cndmask_b32 v16, v16, v22, vcc
    v_cndmask_b32 v17, v17, v23, vcc
    s_mov_b32 s40, 100663296
    s_mov_b32 s41, 109051904
    s_mov_b32 s42, 0
    s_add_u32 s26, s40, 0
    buffer_load_dwordx2 v[32:33], v5, s[8:11], s26 offen sc1
    s_add_u32 s26, s40, 4096
    buffer_load_dwordx2 v[34:35], v5, s[8:11], s26 offen sc1
    s_add_u32 s26, s40, 8192
    buffer_load_dwordx2 v[36:37], v5, s[8:11], s26 offen sc1
    s_add_u32 s26, s40, 12288
    buffer_load_dwordx2 v[38:39], v5, s[8:11], s26 offen sc1
    s_add_u32 s26, s40, 16384
    buffer_load_dwordx2 v[40:41], v5, s[8:11], s26 offen sc1
    s_add_u32 s26, s40, 20480
    buffer_load_dwordx2 v[42:43], v5, s[8:11], s26 offen sc1
    s_add_u32 s26, s40, 24576
    buffer_load_dwordx2 v[44:45], v5, s[8:11], s26 offen sc1
    s_add_u32 s26, s40, 28672
    buffer_load_dwordx2 v[46:47], v5, s[8:11], s26 offen sc1
    s_add_u32 s26, s40, 32768
    buffer_load_dwordx2 v[48:49], v5, s[8:11], s26 offen sc1
    s_add_u32 s26, s40, 36864
    buffer_load_dwordx2 v[50:51], v5, s[8:11], s26 offen sc1
    s_add_u32 s26, s40, 40960
    buffer_load_dwordx2 v[52:53], v5, s[8:11], s26 offen sc1
    s_add_u32 s26, s40, 45056
    buffer_load_dwordx2 v[54:55], v5, s[8:11], s26 offen sc1
    s_add_u32 s26, s40, 49152
    buffer_load_dwordx2 v[56:57], v5, s[8:11], s26 offen sc1
    s_add_u32 s26, s40, 53248
    buffer_load_dwordx2 v[58:59], v5, s[8:11], s26 offen sc1
    s_add_u32 s26, s40, 57344
    buffer_load_dwordx2 v[60:61], v5, s[8:11], s26 offen sc1
    s_add_u32 s26, s40, 61440
    buffer_load_dwordx2 v[62:63], v5, s[8:11], s26 offen sc1
L_sc_p1:
    s_add_u32 s40, s40, 65536
    s_add_u32 s26, s40, 0
    buffer_load_dwordx2 v[64:65], v5, s[8:11], s26 offen sc1
    s_add_u32 s26, s40, 4096
    buffer_load_dwordx2 v[66:67], v5, s[8:11], s26 offen sc1
    s_add_u32 s26, s40, 8192
    buffer_load_dwordx2 v[68:69], v5, s[8:11], s26 offen sc1
    s_add_u32 s26, s40, 12288
    buffer_load_dwordx2 v[70:71], v5, s[8:11], s26 offen sc1
    s_add_u32 s26, s40, 16384
    buffer_load_dwordx2 v[72:73], v5, s[8:11], s26 offen sc1
    s_add_u32 s26, s40, 20480
    buffer_load_dwordx2 v[74:75], v5, s[8:11], s26 offen sc1
    s_add_u32 s26, s40, 24576
    buffer_load_dwordx2 v[76:77], v5, s[8:11], s26 offen sc1
    s_add_u32 s26, s40, 28672
    buffer_load_dwordx2 v[78:79], v5, s[8:11], s26 offen sc1
    s_add_u32 s26, s40, 32768
    buffer_load_dwordx2 v[80:81], v5, s[8:11], s26 offen sc1
    s_add_u32 s26, s40, 36864
    buffer_load_dwordx2 v[82:83], v5, s[8:11], s26 offen sc1
    s_add_u32 s26, s40, 40960
    buffer_load_dwordx2 v[84:85], v5, s[8:11], s26 offen sc1
    s_add_u32 s26, s40, 45056
    buffer_load_dwordx2 v[86:87], v5, s[8:11], s26 offen sc1
    s_add_u32 s26, s40, 49152
    buffer_load_dwordx2 v[88:89], v5, s[8:11], s26 offen sc1
    s_add_u32 s26, s40, 53248
    buffer_load_dwordx2 v[90:91], v5, s[8:11], s26 offen sc1
    s_add_u32 s26, s40, 57344
    buffer_load_dwordx2 v[92:93], v5, s[8:11], s26 offen sc1
    s_add_u32 s26, s40, 61440
    buffer_load_dwordx2 v[94:95], v5, s[8:11], s26 offen sc1
    s_waitcnt vmcnt(16)
    v_fma_f32 v18, v8, v16, v32
    v_fma_f32 v19, v8, v17, v33
    v_fma_f32 v18, -v9, v17, v18
    v_fma_f32 v17, v9, v16, v19
    v_mov_b32 v16, v18
    v_mul_f32 v20, v10, v16
    v_mul_f32 v21, v10, v17
    v_fma_f32 v20, -v11, v17, v20
    v_fma_f32 v21, v11, v16, v21
    v_cvt_pk_bf16_f32 v22, v20, v21
    s_add_u32 s26, s41, 0
    buffer_store_dword v22, v6, s[8:11], s26 offen sc1
    v_fma_f32 v18, v8, v16, v34
    v_fma_f32 v19, v8, v17, v35
    v_fma_f32 v18, -v9, v17, v18
    v_fma_f32 v17, v9, v16, v19
    v_mov_b32 v16, v18
    v_mul_f32 v20, v10, v16
    v_mul_f32 v21, v10, v17
    v_fma_f32 v20, -v11, v17, v20
    v_fma_f32 v21, v11, v16, v21
    v_cvt_pk_bf16_f32 v23, v20, v21
    s_add_u32 s26, s41, 2048
    buffer_store_dword v23, v6, s[8:11], s26 offen sc1
    v_fma_f32 v18, v8, v16, v36
    v_fma_f32 v19, v8, v17, v37
    v_fma_f32 v18, -v9, v17, v18
    v_fma_f32 v17, v9, v16, v19
    v_mov_b32 v16, v18
    v_mul_f32 v20, v10, v16
    v_mul_f32 v21, v10, v17
    v_fma_f32 v20, -v11, v17, v20
    v_fma_f32 v21, v11, v16, v21
    v_cvt_pk_bf16_f32 v24, v20, v21
    s_add_u32 s26, s41, 4096
    buffer_store_dword v24, v6, s[8:11], s26 offen sc1
    v_fma_f32 v18, v8, v16, v38
    v_fma_f32 v19, v8, v17, v39
    v_fma_f32 v18, -v9, v17, v18
    v_fma_f32 v17, v9, v16, v19
    v_mov_b32 v16, v18
    v_mul_f32 v20, v10, v16
    v_mul_f32 v21, v10, v17
    v_fma_f32 v20, -v11, v17, v20
    v_fma_f32 v21, v11, v16, v21
    v_cvt_pk_bf16_f32 v25, v20, v21
    s_add_u32 s26, s41, 6144
    buffer_store_dword v25, v6, s[8:11], s26 offen sc1
    v_fma_f32 v18, v8, v16, v40
    v_fma_f32 v19, v8, v17, v41
    v_fma_f32 v18, -v9, v17, v18
    v_fma_f32 v17, v9, v16, v19
    v_mov_b32 v16, v18
    v_mul_f32 v20, v10, v16
    v_mul_f32 v21, v10, v17
    v_fma_f32 v20, -v11, v17, v20
    v_fma_f32 v21, v11, v16, v21
    v_cvt_pk_bf16_f32 v22, v20, v21
    s_add_u32 s26, s41, 8192
    buffer_store_dword v22, v6, s[8:11], s26 offen sc1
    v_fma_f32 v18, v8, v16, v42
    v_fma_f32 v19, v8, v17, v43
    v_fma_f32 v18, -v9, v17, v18
    v_fma_f32 v17, v9, v16, v19
    v_mov_b32 v16, v18
    v_mul_f32 v20, v10, v16
    v_mul_f32 v21, v10, v17
    v_fma_f32 v20, -v11, v17, v20
    v_fma_f32 v21, v11, v16, v21
    v_cvt_pk_bf16_f32 v23, v20, v21
    s_add_u32 s26, s41, 10240
    buffer_store_dword v23, v6, s[8:11], s26 offen sc1
    v_fma_f32 v18, v8, v16, v44
    v_fma_f32 v19, v8, v17, v45
    v_fma_f32 v18, -v9, v17, v18
    v_fma_f32 v17, v9, v16, v19
    v_mov_b32 v16, v18
    v_mul_f32 v20, v10, v16
    v_mul_f32 v21, v10, v17
    v_fma_f32 v20, -v11, v17, v20
    v_fma_f32 v21, v11, v16, v21
    v_cvt_pk_bf16_f32 v24, v20, v21
    s_add_u32 s26, s41, 12288
    buffer_store_dword v24, v6, s[8:11], s26 offen sc1
    v_fma_f32 v18, v8, v16, v46
    v_fma_f32 v19, v8, v17, v47
    v_fma_f32 v18, -v9, v17, v18
    v_fma_f32 v17, v9, v16, v19
    v_mov_b32 v16, v18
    v_mul_f32 v20, v10, v16
    v_mul_f32 v21, v10, v17
    v_fma_f32 v20, -v11, v17, v20
    v_fma_f32 v21, v11, v16, v21
    v_cvt_pk_bf16_f32 v25, v20, v21
    s_add_u32 s26, s41, 14336
    buffer_store_dword v25, v6, s[8:11], s26 offen sc1
    v_fma_f32 v18, v8, v16, v48
    v_fma_f32 v19, v8, v17, v49
    v_fma_f32 v18, -v9, v17, v18
    v_fma_f32 v17, v9, v16, v19
    v_mov_b32 v16, v18
    v_mul_f32 v20, v10, v16
    v_mul_f32 v21, v10, v17
    v_fma_f32 v20, -v11, v17, v20
    v_fma_f32 v21, v11, v16, v21
    v_cvt_pk_bf16_f32 v22, v20, v21
    s_add_u32 s26, s41, 16384
    buffer_store_dword v22, v6, s[8:11], s26 offen sc1
    v_fma_f32 v18, v8, v16, v50
    v_fma_f32 v19, v8, v17, v51
    v_fma_f32 v18, -v9, v17, v18
    v_fma_f32 v17, v9, v16, v19
    v_mov_b32 v16, v18
    v_mul_f32 v20, v10, v16
    v_mul_f32 v21, v10, v17
    v_fma_f32 v20, -v11, v17, v20
    v_fma_f32 v21, v11, v16, v21
    v_cvt_pk_bf16_f32 v23, v20, v21
    s_add_u32 s26, s41, 18432
    buffer_store_dword v23, v6, s[8:11], s26 offen sc1
    v_fma_f32 v18, v8, v16, v52
    v_fma_f32 v19, v8, v17, v53
    v_fma_f32 v18, -v9, v17, v18
    v_fma_f32 v17, v9, v16, v19
    v_mov_b32 v16, v18
    v_mul_f32 v20, v10, v16
    v_mul_f32 v21, v10, v17
    v_fma_f32 v20, -v11, v17, v20
    v_fma_f32 v21, v11, v16, v21
    v_cvt_pk_bf16_f32 v24, v20, v21
    s_add_u32 s26, s41, 20480
    buffer_store_dword v24, v6, s[8:11], s26 offen sc1
    v_fma_f32 v18, v8, v16, v54
    v_fma_f32 v19, v8, v17, v55
    v_fma_f32 v18, -v9, v17, v18
    v_fma_f32 v17, v9, v16, v19
    v_mov_b32 v16, v18
    v_mul_f32 v20, v10, v16
    v_mul_f32 v21, v10, v17
    v_fma_f32 v20, -v11, v17, v20
    v_fma_f32 v21, v11, v16, v21
    v_cvt_pk_bf16_f32 v25, v20, v21
    s_add_u32 s26, s41, 22528
    buffer_store_dword v25, v6, s[8:11], s26 offen sc1
    v_fma_f32 v18, v8, v16, v56
    v_fma_f32 v19, v8, v17, v57
    v_fma_f32 v18, -v9, v17, v18
    v_fma_f32 v17, v9, v16, v19
    v_mov_b32 v16, v18
    v_mul_f32 v20, v10, v16
    v_mul_f32 v21, v10, v17
    v_fma_f32 v20, -v11, v17, v20
    v_fma_f32 v21, v11, v16, v21
    v_cvt_pk_bf16_f32 v22, v20, v21
    s_add_u32 s26, s41, 24576
    buffer_store_dword v22, v6, s[8:11], s26 offen sc1
    v_fma_f32 v18, v8, v16, v58
    v_fma_f32 v19, v8, v17, v59
    v_fma_f32 v18, -v9, v17, v18
    v_fma_f32 v17, v9, v16, v19
    v_mov_b32 v16, v18
    v_mul_f32 v20, v10, v16
    v_mul_f32 v21, v10, v17
    v_fma_f32 v20, -v11, v17, v20
    v_fma_f32 v21, v11, v16, v21
    v_cvt_pk_bf16_f32 v23, v20, v21
    s_add_u32 s26, s41, 26624
    buffer_store_dword v23, v6, s[8:11], s26 offen sc1
    v_fma_f32 v18, v8, v16, v60
    v_fma_f32 v19, v8, v17, v61
    v_fma_f32 v18, -v9, v17, v18
    v_fma_f32 v17, v9, v16, v19
    v_mov_b32 v16, v18
    v_mul_f32 v20, v10, v16
    v_mul_f32 v21, v10, v17
    v_fma_f32 v20, -v11, v17, v20
    v_fma_f32 v21, v11, v16, v21
    v_cvt_pk_bf16_f32 v24, v20, v21
    s_add_u32 s26, s41, 28672
    buffer_store_dword v24, v6, s[8:11], s26 offen sc1
    v_fma_f32 v18, v8, v16, v62
    v_fma_f32 v19, v8, v17, v63
    v_fma_f32 v18, -v9, v17, v18
    v_fma_f32 v17, v9, v16, v19
    v_mov_b32 v16, v18
    v_mul_f32 v20, v10, v16
    v_mul_f32 v21, v10, v17
    v_fma_f32 v20, -v11, v17, v20
    v_fma_f32 v21, v11, v16, v21
    v_cvt_pk_bf16_f32 v25, v20, v21
    s_add_u32 s26, s41, 30720
    buffer_store_dword v25, v6, s[8:11], s26 offen sc1
    s_add_u32 s41, s41, 32768
    s_add_u32 s40, s40, 65536
    s_add_u32 s42, s42, 1
    s_cmp_ge_u32 s42, 4
    s_cbranch_scc1 L_sc_p1_last
    s_add_u32 s26, s40, 0
    buffer_load_dwordx2 v[32:33], v5, s[8:11], s26 offen sc1
    s_add_u32 s26, s40, 4096
    buffer_load_dwordx2 v[34:35], v5, s[8:11], s26 offen sc1
    s_add_u32 s26, s40, 8192
    buffer_load_dwordx2 v[36:37], v5, s[8:11], s26 offen sc1
    s_add_u32 s26, s40, 12288
    buffer_load_dwordx2 v[38:39], v5, s[8:11], s26 offen sc1
    s_add_u32 s26, s40, 16384
    buffer_load_dwordx2 v[40:41], v5, s[8:11], s26 offen sc1
    s_add_u32 s26, s40, 20480
    buffer_load_dwordx2 v[42:43], v5, s[8:11], s26 offen sc1
    s_add_u32 s26, s40, 24576
    buffer_load_dwordx2 v[44:45], v5, s[8:11], s26 offen sc1
    s_add_u32 s26, s40, 28672
    buffer_load_dwordx2 v[46:47], v5, s[8:11], s26 offen sc1
    s_add_u32 s26, s40, 32768
    buffer_load_dwordx2 v[48:49], v5, s[8:11], s26 offen sc1
    s_add_u32 s26, s40, 36864
    buffer_load_dwordx2 v[50:51], v5, s[8:11], s26 offen sc1
    s_add_u32 s26, s40, 40960
    buffer_load_dwordx2 v[52:53], v5, s[8:11], s26 offen sc1
    s_add_u32 s26, s40, 45056
    buffer_load_dwordx2 v[54:55], v5, s[8:11], s26 offen sc1
    s_add_u32 s26, s40, 49152
    buffer_load_dwordx2 v[56:57], v5, s[8:11], s26 offen sc1
    s_add_u32 s26, s40, 53248
    buffer_load_dwordx2 v[58:59], v5, s[8:11], s26 offen sc1
    s_add_u32 s26, s40, 57344
    buffer_load_dwordx2 v[60:61], v5, s[8:11], s26 offen sc1
    s_add_u32 s26, s40, 61440
    buffer_load_dwordx2 v[62:63], v5, s[8:11], s26 offen sc1
    s_waitcnt vmcnt(16)
    v_fma_f32 v18, v8, v16, v64
    v_fma_f32 v19, v8, v17, v65
    v_fma_f32 v18, -v9, v17, v18
    v_fma_f32 v17, v9, v16, v19
    v_mov_b32 v16, v18
    v_mul_f32 v20, v10, v16
    v_mul_f32 v21, v10, v17
    v_fma_f32 v20, -v11, v17, v20
    v_fma_f32 v21, v11, v16, v21
    v_cvt_pk_bf16_f32 v22, v20, v21
    s_add_u32 s26, s41, 0
    buffer_store_dword v22, v6, s[8:11], s26 offen sc1
    v_fma_f32 v18, v8, v16, v66
    v_fma_f32 v19, v8, v17, v67
    v_fma_f32 v18, -v9, v17, v18
    v_fma_f32 v17, v9, v16, v19
    v_mov_b32 v16, v18
    v_mul_f32 v20, v10, v16
    v_mul_f32 v21, v10, v17
    v_fma_f32 v20, -v11, v17, v20
    v_fma_f32 v21, v11, v16, v21
    v_cvt_pk_bf16_f32 v23, v20, v21
    s_add_u32 s26, s41, 2048
    buffer_store_dword v23, v6, s[8:11], s26 offen sc1
    v_fma_f32 v18, v8, v16, v68
    v_fma_f32 v19, v8, v17, v69
    v_fma_f32 v18, -v9, v17, v18
    v_fma_f32 v17, v9, v16, v19
    v_mov_b32 v16, v18
    v_mul_f32 v20, v10, v16
    v_mul_f32 v21, v10, v17
    v_fma_f32 v20, -v11, v17, v20
    v_fma_f32 v21, v11, v16, v21
    v_cvt_pk_bf16_f32 v24, v20, v21
    s_add_u32 s26, s41, 4096
    buffer_store_dword v24, v6, s[8:11], s26 offen sc1
    v_fma_f32 v18, v8, v16, v70
    v_fma_f32 v19, v8, v17, v71
    v_fma_f32 v18, -v9, v17, v18
    v_fma_f32 v17, v9, v16, v19
    v_mov_b32 v16, v18
    v_mul_f32 v20, v10, v16
    v_mul_f32 v21, v10, v17
    v_fma_f32 v20, -v11, v17, v20
    v_fma_f32 v21, v11, v16, v21
    v_cvt_pk_bf16_f32 v25, v20, v21
    s_add_u32 s26, s41, 6144
    buffer_store_dword v25, v6, s[8:11], s26 offen sc1
    v_fma_f32 v18, v8, v16, v72
    v_fma_f32 v19, v8, v17, v73
    v_fma_f32 v18, -v9, v17, v18
    v_fma_f32 v17, v9, v16, v19
    v_mov_b32 v16, v18
    v_mul_f32 v20, v10, v16
    v_mul_f32 v21, v10, v17
    v_fma_f32 v20, -v11, v17, v20
    v_fma_f32 v21, v11, v16, v21
    v_cvt_pk_bf16_f32 v22, v20, v21
    s_add_u32 s26, s41, 8192
    buffer_store_dword v22, v6, s[8:11], s26 offen sc1
    v_fma_f32 v18, v8, v16, v74
    v_fma_f32 v19, v8, v17, v75
    v_fma_f32 v18, -v9, v17, v18
    v_fma_f32 v17, v9, v16, v19
    v_mov_b32 v16, v18
    v_mul_f32 v20, v10, v16
    v_mul_f32 v21, v10, v17
    v_fma_f32 v20, -v11, v17, v20
    v_fma_f32 v21, v11, v16, v21
    v_cvt_pk_bf16_f32 v23, v20, v21
    s_add_u32 s26, s41, 10240
    buffer_store_dword v23, v6, s[8:11], s26 offen sc1
    v_fma_f32 v18, v8, v16, v76
    v_fma_f32 v19, v8, v17, v77
    v_fma_f32 v18, -v9, v17, v18
    v_fma_f32 v17, v9, v16, v19
    v_mov_b32 v16, v18
    v_mul_f32 v20, v10, v16
    v_mul_f32 v21, v10, v17
    v_fma_f32 v20, -v11, v17, v20
    v_fma_f32 v21, v11, v16, v21
    v_cvt_pk_bf16_f32 v24, v20, v21
    s_add_u32 s26, s41, 12288
    buffer_store_dword v24, v6, s[8:11], s26 offen sc1
    v_fma_f32 v18, v8, v16, v78
    v_fma_f32 v19, v8, v17, v79
    v_fma_f32 v18, -v9, v17, v18
    v_fma_f32 v17, v9, v16, v19
    v_mov_b32 v16, v18
    v_mul_f32 v20, v10, v16
    v_mul_f32 v21, v10, v17
    v_fma_f32 v20, -v11, v17, v20
    v_fma_f32 v21, v11, v16, v21
    v_cvt_pk_bf16_f32 v25, v20, v21
    s_add_u32 s26, s41, 14336
    buffer_store_dword v25, v6, s[8:11], s26 offen sc1
    v_fma_f32 v18, v8, v16, v80
    v_fma_f32 v19, v8, v17, v81
    v_fma_f32 v18, -v9, v17, v18
    v_fma_f32 v17, v9, v16, v19
    v_mov_b32 v16, v18
    v_mul_f32 v20, v10, v16
    v_mul_f32 v21, v10, v17
    v_fma_f32 v20, -v11, v17, v20
    v_fma_f32 v21, v11, v16, v21
    v_cvt_pk_bf16_f32 v22, v20, v21
    s_add_u32 s26, s41, 16384
    buffer_store_dword v22, v6, s[8:11], s26 offen sc1
    v_fma_f32 v18, v8, v16, v82
    v_fma_f32 v19, v8, v17, v83
    v_fma_f32 v18, -v9, v17, v18
    v_fma_f32 v17, v9, v16, v19
    v_mov_b32 v16, v18
    v_mul_f32 v20, v10, v16
    v_mul_f32 v21, v10, v17
    v_fma_f32 v20, -v11, v17, v20
    v_fma_f32 v21, v11, v16, v21
    v_cvt_pk_bf16_f32 v23, v20, v21
    s_add_u32 s26, s41, 18432
    buffer_store_dword v23, v6, s[8:11], s26 offen sc1
    v_fma_f32 v18, v8, v16, v84
    v_fma_f32 v19, v8, v17, v85
    v_fma_f32 v18, -v9, v17, v18
    v_fma_f32 v17, v9, v16, v19
    v_mov_b32 v16, v18
    v_mul_f32 v20, v10, v16
    v_mul_f32 v21, v10, v17
    v_fma_f32 v20, -v11, v17, v20
    v_fma_f32 v21, v11, v16, v21
    v_cvt_pk_bf16_f32 v24, v20, v21
    s_add_u32 s26, s41, 20480
    buffer_store_dword v24, v6, s[8:11], s26 offen sc1
    v_fma_f32 v18, v8, v16, v86
    v_fma_f32 v19, v8, v17, v87
    v_fma_f32 v18, -v9, v17, v18
    v_fma_f32 v17, v9, v16, v19
    v_mov_b32 v16, v18
    v_mul_f32 v20, v10, v16
    v_mul_f32 v21, v10, v17
    v_fma_f32 v20, -v11, v17, v20
    v_fma_f32 v21, v11, v16, v21
    v_cvt_pk_bf16_f32 v25, v20, v21
    s_add_u32 s26, s41, 22528
    buffer_store_dword v25, v6, s[8:11], s26 offen sc1
    v_fma_f32 v18, v8, v16, v88
    v_fma_f32 v19, v8, v17, v89
    v_fma_f32 v18, -v9, v17, v18
    v_fma_f32 v17, v9, v16, v19
    v_mov_b32 v16, v18
    v_mul_f32 v20, v10, v16
    v_mul_f32 v21, v10, v17
    v_fma_f32 v20, -v11, v17, v20
    v_fma_f32 v21, v11, v16, v21
    v_cvt_pk_bf16_f32 v22, v20, v21
    s_add_u32 s26, s41, 24576
    buffer_store_dword v22, v6, s[8:11], s26 offen sc1
    v_fma_f32 v18, v8, v16, v90
    v_fma_f32 v19, v8, v17, v91
    v_fma_f32 v18, -v9, v17, v18
    v_fma_f32 v17, v9, v16, v19
    v_mov_b32 v16, v18
    v_mul_f32 v20, v10, v16
    v_mul_f32 v21, v10, v17
    v_fma_f32 v20, -v11, v17, v20
    v_fma_f32 v21, v11, v16, v21
    v_cvt_pk_bf16_f32 v23, v20, v21
    s_add_u32 s26, s41, 26624
    buffer_store_dword v23, v6, s[8:11], s26 offen sc1
    v_fma_f32 v18, v8, v16, v92
    v_fma_f32 v19, v8, v17, v93
    v_fma_f32 v18, -v9, v17, v18
    v_fma_f32 v17, v9, v16, v19
    v_mov_b32 v16, v18
    v_mul_f32 v20, v10, v16
    v_mul_f32 v21, v10, v17
    v_fma_f32 v20, -v11, v17, v20
    v_fma_f32 v21, v11, v16, v21
    v_cvt_pk_bf16_f32 v24, v20, v21
    s_add_u32 s26, s41, 28672
    buffer_store_dword v24, v6, s[8:11], s26 offen sc1
    v_fma_f32 v18, v8, v16, v94
    v_fma_f32 v19, v8, v17, v95
    v_fma_f32 v18, -v9, v17, v18
    v_fma_f32 v17, v9, v16, v19
    v_mov_b32 v16, v18
    v_mul_f32 v20, v10, v16
    v_mul_f32 v21, v10, v17
    v_fma_f32 v20, -v11, v17, v20
    v_fma_f32 v21, v11, v16, v21
    v_cvt_pk_bf16_f32 v25, v20, v21
    s_add_u32 s26, s41, 30720
    buffer_store_dword v25, v6, s[8:11], s26 offen sc1
    s_add_u32 s41, s41, 32768
    s_branch L_sc_p1
L_sc_p1_last:
    s_waitcnt vmcnt(0)
    v_fma_f32 v18, v8, v16, v64
    v_fma_f32 v19, v8, v17, v65
    v_fma_f32 v18, -v9, v17, v18
    v_fma_f32 v17, v9, v16, v19
    v_mov_b32 v16, v18
    v_mul_f32 v20, v10, v16
    v_mul_f32 v21, v10, v17
    v_fma_f32 v20, -v11, v17, v20
    v_fma_f32 v21, v11, v16, v21
    v_cvt_pk_bf16_f32 v22, v20, v21
    s_add_u32 s26, s41, 0
    buffer_store_dword v22, v6, s[8:11], s26 offen sc1
    v_fma_f32 v18, v8, v16, v66
    v_fma_f32 v19, v8, v17, v67
    v_fma_f32 v18, -v9, v17, v18
    v_fma_f32 v17, v9, v16, v19
    v_mov_b32 v16, v18
    v_mul_f32 v20, v10, v16
    v_mul_f32 v21, v10, v17
    v_fma_f32 v20, -v11, v17, v20
    v_fma_f32 v21, v11, v16, v21
    v_cvt_pk_bf16_f32 v23, v20, v21
    s_add_u32 s26, s41, 2048
    buffer_store_dword v23, v6, s[8:11], s26 offen sc1
    v_fma_f32 v18, v8, v16, v68
    v_fma_f32 v19, v8, v17, v69
    v_fma_f32 v18, -v9, v17, v18
    v_fma_f32 v17, v9, v16, v19
    v_mov_b32 v16, v18
    v_mul_f32 v20, v10, v16
    v_mul_f32 v21, v10, v17
    v_fma_f32 v20, -v11, v17, v20
    v_fma_f32 v21, v11, v16, v21
    v_cvt_pk_bf16_f32 v24, v20, v21
    s_add_u32 s26, s41, 4096
    buffer_store_dword v24, v6, s[8:11], s26 offen sc1
    v_fma_f32 v18, v8, v16, v70
    v_fma_f32 v19, v8, v17, v71
    v_fma_f32 v18, -v9, v17, v18
    v_fma_f32 v17, v9, v16, v19
    v_mov_b32 v16, v18
    v_mul_f32 v20, v10, v16
    v_mul_f32 v21, v10, v17
    v_fma_f32 v20, -v11, v17, v20
    v_fma_f32 v21, v11, v16, v21
    v_cvt_pk_bf16_f32 v25, v20, v21
    s_add_u32 s26, s41, 6144
    buffer_store_dword v25, v6, s[8:11], s26 offen sc1
    v_fma_f32 v18, v8, v16, v72
    v_fma_f32 v19, v8, v17, v73
    v_fma_f32 v18, -v9, v17, v18
    v_fma_f32 v17, v9, v16, v19
    v_mov_b32 v16, v18
    v_mul_f32 v20, v10, v16
    v_mul_f32 v21, v10, v17
    v_fma_f32 v20, -v11, v17, v20
    v_fma_f32 v21, v11, v16, v21
    v_cvt_pk_bf16_f32 v22, v20, v21
    s_add_u32 s26, s41, 8192
    buffer_store_dword v22, v6, s[8:11], s26 offen sc1
    v_fma_f32 v18, v8, v16, v74
    v_fma_f32 v19, v8, v17, v75
    v_fma_f32 v18, -v9, v17, v18
    v_fma_f32 v17, v9, v16, v19
    v_mov_b32 v16, v18
    v_mul_f32 v20, v10, v16
    v_mul_f32 v21, v10, v17
    v_fma_f32 v20, -v11, v17, v20
    v_fma_f32 v21, v11, v16, v21
    v_cvt_pk_bf16_f32 v23, v20, v21
    s_add_u32 s26, s41, 10240
    buffer_store_dword v23, v6, s[8:11], s26 offen sc1
    v_fma_f32 v18, v8, v16, v76
    v_fma_f32 v19, v8, v17, v77
    v_fma_f32 v18, -v9, v17, v18
    v_fma_f32 v17, v9, v16, v19
    v_mov_b32 v16, v18
    v_mul_f32 v20, v10, v16
    v_mul_f32 v21, v10, v17
    v_fma_f32 v20, -v11, v17, v20
    v_fma_f32 v21, v11, v16, v21
    v_cvt_pk_bf16_f32 v24, v20, v21
    s_add_u32 s26, s41, 12288
    buffer_store_dword v24, v6, s[8:11], s26 offen sc1
    v_fma_f32 v18, v8, v16, v78
    v_fma_f32 v19, v8, v17, v79
    v_fma_f32 v18, -v9, v17, v18
    v_fma_f32 v17, v9, v16, v19
    v_mov_b32 v16, v18
    v_mul_f32 v20, v10, v16
    v_mul_f32 v21, v10, v17
    v_fma_f32 v20, -v11, v17, v20
    v_fma_f32 v21, v11, v16, v21
    v_cvt_pk_bf16_f32 v25, v20, v21
    s_add_u32 s26, s41, 14336
    buffer_store_dword v25, v6, s[8:11], s26 offen sc1
    v_fma_f32 v18, v8, v16, v80
    v_fma_f32 v19, v8, v17, v81
    v_fma_f32 v18, -v9, v17, v18
    v_fma_f32 v17, v9, v16, v19
    v_mov_b32 v16, v18
    v_mul_f32 v20, v10, v16
    v_mul_f32 v21, v10, v17
    v_fma_f32 v20, -v11, v17, v20
    v_fma_f32 v21, v11, v16, v21
    v_cvt_pk_bf16_f32 v22, v20, v21
    s_add_u32 s26, s41, 16384
    buffer_store_dword v22, v6, s[8:11], s26 offen sc1
    v_fma_f32 v18, v8, v16, v82
    v_fma_f32 v19, v8, v17, v83
    v_fma_f32 v18, -v9, v17, v18
    v_fma_f32 v17, v9, v16, v19
    v_mov_b32 v16, v18
    v_mul_f32 v20, v10, v16
    v_mul_f32 v21, v10, v17
    v_fma_f32 v20, -v11, v17, v20
    v_fma_f32 v21, v11, v16, v21
    v_cvt_pk_bf16_f32 v23, v20, v21
    s_add_u32 s26, s41, 18432
    buffer_store_dword v23, v6, s[8:11], s26 offen sc1
    v_fma_f32 v18, v8, v16, v84
    v_fma_f32 v19, v8, v17, v85
    v_fma_f32 v18, -v9, v17, v18
    v_fma_f32 v17, v9, v16, v19
    v_mov_b32 v16, v18
    v_mul_f32 v20, v10, v16
    v_mul_f32 v21, v10, v17
    v_fma_f32 v20, -v11, v17, v20
    v_fma_f32 v21, v11, v16, v21
    v_cvt_pk_bf16_f32 v24, v20, v21
    s_add_u32 s26, s41, 20480
    buffer_store_dword v24, v6, s[8:11], s26 offen sc1
    v_fma_f32 v18, v8, v16, v86
    v_fma_f32 v19, v8, v17, v87
    v_fma_f32 v18, -v9, v17, v18
    v_fma_f32 v17, v9, v16, v19
    v_mov_b32 v16, v18
    v_mul_f32 v20, v10, v16
    v_mul_f32 v21, v10, v17
    v_fma_f32 v20, -v11, v17, v20
    v_fma_f32 v21, v11, v16, v21
    v_cvt_pk_bf16_f32 v25, v20, v21
    s_add_u32 s26, s41, 22528
    buffer_store_dword v25, v6, s[8:11], s26 offen sc1
    v_fma_f32 v18, v8, v16, v88
    v_fma_f32 v19, v8, v17, v89
    v_fma_f32 v18, -v9, v17, v18
    v_fma_f32 v17, v9, v16, v19
    v_mov_b32 v16, v18
    v_mul_f32 v20, v10, v16
    v_mul_f32 v21, v10, v17
    v_fma_f32 v20, -v11, v17, v20
    v_fma_f32 v21, v11, v16, v21
    v_cvt_pk_bf16_f32 v22, v20, v21
    s_add_u32 s26, s41, 24576
    buffer_store_dword v22, v6, s[8:11], s26 offen sc1
    v_fma_f32 v18, v8, v16, v90
    v_fma_f32 v19, v8, v17, v91
    v_fma_f32 v18, -v9, v17, v18
    v_fma_f32 v17, v9, v16, v19
    v_mov_b32 v16, v18
    v_mul_f32 v20, v10, v16
    v_mul_f32 v21, v10, v17
    v_fma_f32 v20, -v11, v17, v20
    v_fma_f32 v21, v11, v16, v21
    v_cvt_pk_bf16_f32 v23, v20, v21
    s_add_u32 s26, s41, 26624
    buffer_store_dword v23, v6, s[8:11], s26 offen sc1
    v_fma_f32 v18, v8, v16, v92
    v_fma_f32 v19, v8, v17, v93
    v_fma_f32 v18, -v9, v17, v18
    v_fma_f32 v17, v9, v16, v19
    v_mov_b32 v16, v18
    v_mul_f32 v20, v10, v16
    v_mul_f32 v21, v10, v17
    v_fma_f32 v20, -v11, v17, v20
    v_fma_f32 v21, v11, v16, v21
    v_cvt_pk_bf16_f32 v24, v20, v21
    s_add_u32 s26, s41, 28672
    buffer_store_dword v24, v6, s[8:11], s26 offen sc1
    v_fma_f32 v18, v8, v16, v94
    v_fma_f32 v19, v8, v17, v95
    v_fma_f32 v18, -v9, v17, v18
    v_fma_f32 v17, v9, v16, v19
    v_mov_b32 v16, v18
    v_mul_f32 v20, v10, v16
    v_mul_f32 v21, v10, v17
    v_fma_f32 v20, -v11, v17, v20
    v_fma_f32 v21, v11, v16, v21
    v_cvt_pk_bf16_f32 v25, v20, v21
    s_add_u32 s26, s41, 30720
    buffer_store_dword v25, v6, s[8:11], s26 offen sc1
    s_waitcnt vmcnt(0)
    s_barrier
    s_mov_b32 s34, 591232
    s_cmp_lg_u32 s24, 0
    s_cbranch_scc1 L_sc_pp_np
    s_mov_b64 exec, 1
    v_mov_b32 v120, 0
    v_mov_b32 v121, 1
    buffer_atomic_add v121, v120, s[8:11], s34 offen sc1
    s_mov_b64 exec, -1
L_sc_pp_np:
    s_barrier
    s_lshr_b32 s29, s63, 2
    s_and_b32 s30, s63, 3

    v_and_b32 v1, 63, v0
    v_and_b32 v2, 31, v1
    v_lshrrev_b32 v3, 5, v1
    v_lshlrev_b32 v4, 4, v1
    s_lshl_b32 s25, s30, 2
    s_add_u32 s25, s25, s24
    s_lshl_b32 s25, s25, 5
    v_add_u32 v9, s25, v2
    v_lshlrev_b32 v5, 10, v9
    v_lshlrev_b32 v6, 4, v3
    v_add_u32 v5, v5, v6
    s_load_dwordx2 s[16:17], s[0:1], 96
    s_load_dwordx2 s[20:21], s[0:1], 104
    s_mov_b32 s18, 0x80000
    s_mov_b32 s19, 0x20000
    s_mov_b32 s22, 0x80000
    s_mov_b32 s23, 0x20000
    s_mov_b32 s26, 0x05040100
    s_mov_b32 s27, 0x07060302
    s_waitcnt lgkmcnt(0)
    buffer_load_dwordx4 v[32:35], v5, s[16:19], 0 offen offset:0
    buffer_load_dwordx4 v[36:39], v5, s[20:23], 0 offen offset:0
    buffer_load_dwordx4 v[40:43], v5, s[16:19], 0 offen offset:32
    buffer_load_dwordx4 v[44:47], v5, s[20:23], 0 offen offset:32
    buffer_load_dwordx4 v[48:51], v5, s[16:19], 0 offen offset:64
    buffer_load_dwordx4 v[52:55], v5, s[20:23], 0 offen offset:64
    buffer_load_dwordx4 v[56:59], v5, s[16:19], 0 offen offset:96
    buffer_load_dwordx4 v[60:63], v5, s[20:23], 0 offen offset:96
    buffer_load_dwordx4 v[64:67], v5, s[16:19], 0 offen offset:128
    buffer_load_dwordx4 v[68:71], v5, s[20:23], 0 offen offset:128
    buffer_load_dwordx4 v[72:75], v5, s[16:19], 0 offen offset:160
    buffer_load_dwordx4 v[76:79], v5, s[20:23], 0 offen offset:160
    buffer_load_dwordx4 v[80:83], v5, s[16:19], 0 offen offset:192
    buffer_load_dwordx4 v[84:87], v5, s[20:23], 0 offen offset:192
    buffer_load_dwordx4 v[88:91], v5, s[16:19], 0 offen offset:224
    buffer_load_dwordx4 v[92:95], v5, s[20:23], 0 offen offset:224
    s_waitcnt vmcnt(0)
    v_perm_b32 v10, v36, v32, s26
    v_perm_b32 v11, v36, v32, s27
    v_xor_b32 v10, 0x80000000, v10
    v_xor_b32 v11, 0x80000000, v11
    v_accvgpr_write_b32 a0, v10
    v_accvgpr_write_b32 a1, v11
    v_perm_b32 v10, v37, v33, s26
    v_perm_b32 v11, v37, v33, s27
    v_xor_b32 v10, 0x80000000, v10
    v_xor_b32 v11, 0x80000000, v11
    v_accvgpr_write_b32 a2, v10
    v_accvgpr_write_b32 a3, v11
    v_perm_b32 v10, v38, v34, s26
    v_perm_b32 v11, v38, v34, s27
    v_xor_b32 v10, 0x80000000, v10
    v_xor_b32 v11, 0x80000000, v11
    v_accvgpr_write_b32 a4, v10
    v_accvgpr_write_b32 a5, v11
    v_perm_b32 v10, v39, v35, s26
    v_perm_b32 v11, v39, v35, s27
    v_xor_b32 v10, 0x80000000, v10
    v_xor_b32 v11, 0x80000000, v11
    v_accvgpr_write_b32 a6, v10
    v_accvgpr_write_b32 a7, v11
    v_perm_b32 v10, v44, v40, s26
    v_perm_b32 v11, v44, v40, s27
    v_xor_b32 v10, 0x80000000, v10
    v_xor_b32 v11, 0x80000000, v11
    v_accvgpr_write_b32 a8, v10
    v_accvgpr_write_b32 a9, v11
    v_perm_b32 v10, v45, v41, s26
    v_perm_b32 v11, v45, v41, s27
    v_xor_b32 v10, 0x80000000, v10
    v_xor_b32 v11, 0x80000000, v11
    v_accvgpr_write_b32 a10, v10
    v_accvgpr_write_b32 a11, v11
    v_perm_b32 v10, v46, v42, s26
    v_perm_b32 v11, v46, v42, s27
    v_xor_b32 v10, 0x80000000, v10
    v_xor_b32 v11, 0x80000000, v11
    v_accvgpr_write_b32 a12, v10
    v_accvgpr_write_b32 a13, v11
    v_perm_b32 v10, v47, v43, s26
    v_perm_b32 v11, v47, v43, s27
    v_xor_b32 v10, 0x80000000, v10
    v_xor_b32 v11, 0x80000000, v11
    v_accvgpr_write_b32 a14, v10
    v_accvgpr_write_b32 a15, v11
    v_perm_b32 v10, v52, v48, s26
    v_perm_b32 v11, v52, v48, s27
    v_xor_b32 v10, 0x80000000, v10
    v_xor_b32 v11, 0x80000000, v11
    v_accvgpr_write_b32 a16, v10
    v_accvgpr_write_b32 a17, v11
    v_perm_b32 v10, v53, v49, s26
    v_perm_b32 v11, v53, v49, s27
    v_xor_b32 v10, 0x80000000, v10
    v_xor_b32 v11, 0x80000000, v11
    v_accvgpr_write_b32 a18, v10
    v_accvgpr_write_b32 a19, v11
    v_perm_b32 v10, v54, v50, s26
    v_perm_b32 v11, v54, v50, s27
    v_xor_b32 v10, 0x80000000, v10
    v_xor_b32 v11, 0x80000000, v11
    v_accvgpr_write_b32 a20, v10
    v_accvgpr_write_b32 a21, v11
    v_perm_b32 v10, v55, v51, s26
    v_perm_b32 v11, v55, v51, s27
    v_xor_b32 v10, 0x80000000, v10
    v_xor_b32 v11, 0x80000000, v11
    v_accvgpr_write_b32 a22, v10
    v_accvgpr_write_b32 a23, v11
    v_perm_b32 v10, v60, v56, s26
    v_perm_b32 v11, v60, v56, s27
    v_xor_b32 v10, 0x80000000, v10
    v_xor_b32 v11, 0x80000000, v11
    v_accvgpr_write_b32 a24, v10
    v_accvgpr_write_b32 a25, v11
    v_perm_b32 v10, v61, v57, s26
    v_perm_b32 v11, v61, v57, s27
    v_xor_b32 v10, 0x80000000, v10
    v_xor_b32 v11, 0x80000000, v11
    v_accvgpr_write_b32 a26, v10
    v_accvgpr_write_b32 a27, v11
    v_perm_b32 v10, v62, v58, s26
    v_perm_b32 v11, v62, v58, s27
    v_xor_b32 v10, 0x80000000, v10
    v_xor_b32 v11, 0x80000000, v11
    v_accvgpr_write_b32 a28, v10
    v_accvgpr_write_b32 a29, v11
    v_perm_b32 v10, v63, v59, s26
    v_perm_b32 v11, v63, v59, s27
    v_xor_b32 v10, 0x80000000, v10
    v_xor_b32 v11, 0x80000000, v11
    v_accvgpr_write_b32 a30, v10
    v_accvgpr_write_b32 a31, v11
    v_perm_b32 v10, v68, v64, s26
    v_perm_b32 v11, v68, v64, s27
    v_xor_b32 v10, 0x80000000, v10
    v_xor_b32 v11, 0x80000000, v11
    v_accvgpr_write_b32 a32, v10
    v_accvgpr_write_b32 a33, v11
    v_perm_b32 v10, v69, v65, s26
    v_perm_b32 v11, v69, v65, s27
    v_xor_b32 v10, 0x80000000, v10
    v_xor_b32 v11, 0x80000000, v11
    v_accvgpr_write_b32 a34, v10
    v_accvgpr_write_b32 a35, v11
    v_perm_b32 v10, v70, v66, s26
    v_perm_b32 v11, v70, v66, s27
    v_xor_b32 v10, 0x80000000, v10
    v_xor_b32 v11, 0x80000000, v11
    v_accvgpr_write_b32 a36, v10
    v_accvgpr_write_b32 a37, v11
    v_perm_b32 v10, v71, v67, s26
    v_perm_b32 v11, v71, v67, s27
    v_xor_b32 v10, 0x80000000, v10
    v_xor_b32 v11, 0x80000000, v11
    v_accvgpr_write_b32 a38, v10
    v_accvgpr_write_b32 a39, v11
    v_perm_b32 v10, v76, v72, s26
    v_perm_b32 v11, v76, v72, s27
    v_xor_b32 v10, 0x80000000, v10
    v_xor_b32 v11, 0x80000000, v11
    v_accvgpr_write_b32 a40, v10
    v_accvgpr_write_b32 a41, v11
    v_perm_b32 v10, v77, v73, s26
    v_perm_b32 v11, v77, v73, s27
    v_xor_b32 v10, 0x80000000, v10
    v_xor_b32 v11, 0x80000000, v11
    v_accvgpr_write_b32 a42, v10
    v_accvgpr_write_b32 a43, v11
    v_perm_b32 v10, v78, v74, s26
    v_perm_b32 v11, v78, v74, s27
    v_xor_b32 v10, 0x80000000, v10
    v_xor_b32 v11, 0x80000000, v11
    v_accvgpr_write_b32 a44, v10
    v_accvgpr_write_b32 a45, v11
    v_perm_b32 v10, v79, v75, s26
    v_perm_b32 v11, v79, v75, s27
    v_xor_b32 v10, 0x80000000, v10
    v_xor_b32 v11, 0x80000000, v11
    v_accvgpr_write_b32 a46, v10
    v_accvgpr_write_b32 a47, v11
    v_perm_b32 v10, v84, v80, s26
    v_perm_b32 v11, v84, v80, s27
    v_xor_b32 v10, 0x80000000, v10
    v_xor_b32 v11, 0x80000000, v11
    v_accvgpr_write_b32 a48, v10
    v_accvgpr_write_b32 a49, v11
    v_perm_b32 v10, v85, v81, s26
    v_perm_b32 v11, v85, v81, s27
    v_xor_b32 v10, 0x80000000, v10
    v_xor_b32 v11, 0x80000000, v11
    v_accvgpr_write_b32 a50, v10
    v_accvgpr_write_b32 a51, v11
    v_perm_b32 v10, v86, v82, s26
    v_perm_b32 v11, v86, v82, s27
    v_xor_b32 v10, 0x80000000, v10
    v_xor_b32 v11, 0x80000000, v11
    v_accvgpr_write_b32 a52, v10
    v_accvgpr_write_b32 a53, v11
    v_perm_b32 v10, v87, v83, s26
    v_perm_b32 v11, v87, v83, s27
    v_xor_b32 v10, 0x80000000, v10
    v_xor_b32 v11, 0x80000000, v11
    v_accvgpr_write_b32 a54, v10
    v_accvgpr_write_b32 a55, v11
    v_perm_b32 v10, v92, v88, s26
    v_perm_b32 v11, v92, v88, s27
    v_xor_b32 v10, 0x80000000, v10
    v_xor_b32 v11, 0x80000000, v11
    v_accvgpr_write_b32 a56, v10
    v_accvgpr_write_b32 a57, v11
    v_perm_b32 v10, v93, v89, s26
    v_perm_b32 v11, v93, v89, s27
    v_xor_b32 v10, 0x80000000, v10
    v_xor_b32 v11, 0x80000000, v11
    v_accvgpr_write_b32 a58, v10
    v_accvgpr_write_b32 a59, v11
    v_perm_b32 v10, v94, v90, s26
    v_perm_b32 v11, v94, v90, s27
    v_xor_b32 v10, 0x80000000, v10
    v_xor_b32 v11, 0x80000000, v11
    v_accvgpr_write_b32 a60, v10
    v_accvgpr_write_b32 a61, v11
    v_perm_b32 v10, v95, v91, s26
    v_perm_b32 v11, v95, v91, s27
    v_xor_b32 v10, 0x80000000, v10
    v_xor_b32 v11, 0x80000000, v11
    v_accvgpr_write_b32 a62, v10
    v_accvgpr_write_b32 a63, v11
    buffer_load_dwordx4 v[32:35], v5, s[16:19], 0 offen offset:256
    buffer_load_dwordx4 v[36:39], v5, s[20:23], 0 offen offset:256
    buffer_load_dwordx4 v[40:43], v5, s[16:19], 0 offen offset:288
    buffer_load_dwordx4 v[44:47], v5, s[20:23], 0 offen offset:288
    buffer_load_dwordx4 v[48:51], v5, s[16:19], 0 offen offset:320
    buffer_load_dwordx4 v[52:55], v5, s[20:23], 0 offen offset:320
    buffer_load_dwordx4 v[56:59], v5, s[16:19], 0 offen offset:352
    buffer_load_dwordx4 v[60:63], v5, s[20:23], 0 offen offset:352
    buffer_load_dwordx4 v[64:67], v5, s[16:19], 0 offen offset:384
    buffer_load_dwordx4 v[68:71], v5, s[20:23], 0 offen offset:384
    buffer_load_dwordx4 v[72:75], v5, s[16:19], 0 offen offset:416
    buffer_load_dwordx4 v[76:79], v5, s[20:23], 0 offen offset:416
    buffer_load_dwordx4 v[80:83], v5, s[16:19], 0 offen offset:448
    buffer_load_dwordx4 v[84:87], v5, s[20:23], 0 offen offset:448
    buffer_load_dwordx4 v[88:91], v5, s[16:19], 0 offen offset:480
    buffer_load_dwordx4 v[92:95], v5, s[20:23], 0 offen offset:480
    s_waitcnt vmcnt(0)
    v_perm_b32 v10, v36, v32, s26
    v_perm_b32 v11, v36, v32, s27
    v_xor_b32 v10, 0x80000000, v10
    v_xor_b32 v11, 0x80000000, v11
    v_accvgpr_write_b32 a64, v10
    v_accvgpr_write_b32 a65, v11
    v_perm_b32 v10, v37, v33, s26
    v_perm_b32 v11, v37, v33, s27
    v_xor_b32 v10, 0x80000000, v10
    v_xor_b32 v11, 0x80000000, v11
    v_accvgpr_write_b32 a66, v10
    v_accvgpr_write_b32 a67, v11
    v_perm_b32 v10, v38, v34, s26
    v_perm_b32 v11, v38, v34, s27
    v_xor_b32 v10, 0x80000000, v10
    v_xor_b32 v11, 0x80000000, v11
    v_accvgpr_write_b32 a68, v10
    v_accvgpr_write_b32 a69, v11
    v_perm_b32 v10, v39, v35, s26
    v_perm_b32 v11, v39, v35, s27
    v_xor_b32 v10, 0x80000000, v10
    v_xor_b32 v11, 0x80000000, v11
    v_accvgpr_write_b32 a70, v10
    v_accvgpr_write_b32 a71, v11
    v_perm_b32 v10, v44, v40, s26
    v_perm_b32 v11, v44, v40, s27
    v_xor_b32 v10, 0x80000000, v10
    v_xor_b32 v11, 0x80000000, v11
    v_accvgpr_write_b32 a72, v10
    v_accvgpr_write_b32 a73, v11
    v_perm_b32 v10, v45, v41, s26
    v_perm_b32 v11, v45, v41, s27
    v_xor_b32 v10, 0x80000000, v10
    v_xor_b32 v11, 0x80000000, v11
    v_accvgpr_write_b32 a74, v10
    v_accvgpr_write_b32 a75, v11
    v_perm_b32 v10, v46, v42, s26
    v_perm_b32 v11, v46, v42, s27
    v_xor_b32 v10, 0x80000000, v10
    v_xor_b32 v11, 0x80000000, v11
    v_accvgpr_write_b32 a76, v10
    v_accvgpr_write_b32 a77, v11
    v_perm_b32 v10, v47, v43, s26
    v_perm_b32 v11, v47, v43, s27
    v_xor_b32 v10, 0x80000000, v10
    v_xor_b32 v11, 0x80000000, v11
    v_accvgpr_write_b32 a78, v10
    v_accvgpr_write_b32 a79, v11
    v_perm_b32 v10, v52, v48, s26
    v_perm_b32 v11, v52, v48, s27
    v_xor_b32 v10, 0x80000000, v10
    v_xor_b32 v11, 0x80000000, v11
    v_accvgpr_write_b32 a80, v10
    v_accvgpr_write_b32 a81, v11
    v_perm_b32 v10, v53, v49, s26
    v_perm_b32 v11, v53, v49, s27
    v_xor_b32 v10, 0x80000000, v10
    v_xor_b32 v11, 0x80000000, v11
    v_accvgpr_write_b32 a82, v10
    v_accvgpr_write_b32 a83, v11
    v_perm_b32 v10, v54, v50, s26
    v_perm_b32 v11, v54, v50, s27
    v_xor_b32 v10, 0x80000000, v10
    v_xor_b32 v11, 0x80000000, v11
    v_accvgpr_write_b32 a84, v10
    v_accvgpr_write_b32 a85, v11
    v_perm_b32 v10, v55, v51, s26
    v_perm_b32 v11, v55, v51, s27
    v_xor_b32 v10, 0x80000000, v10
    v_xor_b32 v11, 0x80000000, v11
    v_accvgpr_write_b32 a86, v10
    v_accvgpr_write_b32 a87, v11
    v_perm_b32 v10, v60, v56, s26
    v_perm_b32 v11, v60, v56, s27
    v_xor_b32 v10, 0x80000000, v10
    v_xor_b32 v11, 0x80000000, v11
    v_accvgpr_write_b32 a88, v10
    v_accvgpr_write_b32 a89, v11
    v_perm_b32 v10, v61, v57, s26
    v_perm_b32 v11, v61, v57, s27
    v_xor_b32 v10, 0x80000000, v10
    v_xor_b32 v11, 0x80000000, v11
    v_accvgpr_write_b32 a90, v10
    v_accvgpr_write_b32 a91, v11
    v_perm_b32 v10, v62, v58, s26
    v_perm_b32 v11, v62, v58, s27
    v_xor_b32 v10, 0x80000000, v10
    v_xor_b32 v11, 0x80000000, v11
    v_accvgpr_write_b32 a92, v10
    v_accvgpr_write_b32 a93, v11
    v_perm_b32 v10, v63, v59, s26
    v_perm_b32 v11, v63, v59, s27
    v_xor_b32 v10, 0x80000000, v10
    v_xor_b32 v11, 0x80000000, v11
    v_accvgpr_write_b32 a94, v10
    v_accvgpr_write_b32 a95, v11
    v_perm_b32 v10, v68, v64, s26
    v_perm_b32 v11, v68, v64, s27
    v_xor_b32 v10, 0x80000000, v10
    v_xor_b32 v11, 0x80000000, v11
    v_accvgpr_write_b32 a96, v10
    v_accvgpr_write_b32 a97, v11
    v_perm_b32 v10, v69, v65, s26
    v_perm_b32 v11, v69, v65, s27
    v_xor_b32 v10, 0x80000000, v10
    v_xor_b32 v11, 0x80000000, v11
    v_accvgpr_write_b32 a98, v10
    v_accvgpr_write_b32 a99, v11
    v_perm_b32 v10, v70, v66, s26
    v_perm_b32 v11, v70, v66, s27
    v_xor_b32 v10, 0x80000000, v10
    v_xor_b32 v11, 0x80000000, v11
    v_accvgpr_write_b32 a100, v10
    v_accvgpr_write_b32 a101, v11
    v_perm_b32 v10, v71, v67, s26
    v_perm_b32 v11, v71, v67, s27
    v_xor_b32 v10, 0x80000000, v10
    v_xor_b32 v11, 0x80000000, v11
    v_accvgpr_write_b32 a102, v10
    v_accvgpr_write_b32 a103, v11
    v_perm_b32 v10, v76, v72, s26
    v_perm_b32 v11, v76, v72, s27
    v_xor_b32 v10, 0x80000000, v10
    v_xor_b32 v11, 0x80000000, v11
    v_accvgpr_write_b32 a104, v10
    v_accvgpr_write_b32 a105, v11
    v_perm_b32 v10, v77, v73, s26
    v_perm_b32 v11, v77, v73, s27
    v_xor_b32 v10, 0x80000000, v10
    v_xor_b32 v11, 0x80000000, v11
    v_accvgpr_write_b32 a106, v10
    v_accvgpr_write_b32 a107, v11
    v_perm_b32 v10, v78, v74, s26
    v_perm_b32 v11, v78, v74, s27
    v_xor_b32 v10, 0x80000000, v10
    v_xor_b32 v11, 0x80000000, v11
    v_accvgpr_write_b32 a108, v10
    v_accvgpr_write_b32 a109, v11
    v_perm_b32 v10, v79, v75, s26
    v_perm_b32 v11, v79, v75, s27
    v_xor_b32 v10, 0x80000000, v10
    v_xor_b32 v11, 0x80000000, v11
    v_accvgpr_write_b32 a110, v10
    v_accvgpr_write_b32 a111, v11
    v_perm_b32 v10, v84, v80, s26
    v_perm_b32 v11, v84, v80, s27
    v_xor_b32 v10, 0x80000000, v10
    v_xor_b32 v11, 0x80000000, v11
    v_accvgpr_write_b32 a112, v10
    v_accvgpr_write_b32 a113, v11
    v_perm_b32 v10, v85, v81, s26
    v_perm_b32 v11, v85, v81, s27
    v_xor_b32 v10, 0x80000000, v10
    v_xor_b32 v11, 0x80000000, v11
    v_accvgpr_write_b32 a114, v10
    v_accvgpr_write_b32 a115, v11
    v_perm_b32 v10, v86, v82, s26
    v_perm_b32 v11, v86, v82, s27
    v_xor_b32 v10, 0x80000000, v10
    v_xor_b32 v11, 0x80000000, v11
    v_accvgpr_write_b32 a116, v10
    v_accvgpr_write_b32 a117, v11
    v_perm_b32 v10, v87, v83, s26
    v_perm_b32 v11, v87, v83, s27
    v_xor_b32 v10, 0x80000000, v10
    v_xor_b32 v11, 0x80000000, v11
    v_accvgpr_write_b32 a118, v10
    v_accvgpr_write_b32 a119, v11
    v_perm_b32 v10, v92, v88, s26
    v_perm_b32 v11, v92, v88, s27
    v_xor_b32 v10, 0x80000000, v10
    v_xor_b32 v11, 0x80000000, v11
    v_accvgpr_write_b32 a120, v10
    v_accvgpr_write_b32 a121, v11
    v_perm_b32 v10, v93, v89, s26
    v_perm_b32 v11, v93, v89, s27
    v_xor_b32 v10, 0x80000000, v10
    v_xor_b32 v11, 0x80000000, v11
    v_accvgpr_write_b32 a122, v10
    v_accvgpr_write_b32 a123, v11
    v_perm_b32 v10, v94, v90, s26
    v_perm_b32 v11, v94, v90, s27
    v_xor_b32 v10, 0x80000000, v10
    v_xor_b32 v11, 0x80000000, v11
    v_accvgpr_write_b32 a124, v10
    v_accvgpr_write_b32 a125, v11
    v_perm_b32 v10, v95, v91, s26
    v_perm_b32 v11, v95, v91, s27
    v_xor_b32 v10, 0x80000000, v10
    v_xor_b32 v11, 0x80000000, v11
    v_accvgpr_write_b32 a126, v10
    v_accvgpr_write_b32 a127, v11
    buffer_load_dwordx4 v[32:35], v5, s[16:19], 0 offen offset:512
    buffer_load_dwordx4 v[36:39], v5, s[20:23], 0 offen offset:512
    buffer_load_dwordx4 v[40:43], v5, s[16:19], 0 offen offset:544
    buffer_load_dwordx4 v[44:47], v5, s[20:23], 0 offen offset:544
    buffer_load_dwordx4 v[48:51], v5, s[16:19], 0 offen offset:576
    buffer_load_dwordx4 v[52:55], v5, s[20:23], 0 offen offset:576
    buffer_load_dwordx4 v[56:59], v5, s[16:19], 0 offen offset:608
    buffer_load_dwordx4 v[60:63], v5, s[20:23], 0 offen offset:608
    buffer_load_dwordx4 v[64:67], v5, s[16:19], 0 offen offset:640
    buffer_load_dwordx4 v[68:71], v5, s[20:23], 0 offen offset:640
    buffer_load_dwordx4 v[72:75], v5, s[16:19], 0 offen offset:672
    buffer_load_dwordx4 v[76:79], v5, s[20:23], 0 offen offset:672
    buffer_load_dwordx4 v[80:83], v5, s[16:19], 0 offen offset:704
    buffer_load_dwordx4 v[84:87], v5, s[20:23], 0 offen offset:704
    buffer_load_dwordx4 v[88:91], v5, s[16:19], 0 offen offset:736
    buffer_load_dwordx4 v[92:95], v5, s[20:23], 0 offen offset:736
    s_waitcnt vmcnt(0)
    v_perm_b32 v10, v36, v32, s26
    v_perm_b32 v11, v36, v32, s27
    v_xor_b32 v10, 0x80000000, v10
    v_xor_b32 v11, 0x80000000, v11
    v_accvgpr_write_b32 a128, v10
    v_accvgpr_write_b32 a129, v11
    v_perm_b32 v10, v37, v33, s26
    v_perm_b32 v11, v37, v33, s27
    v_xor_b32 v10, 0x80000000, v10
    v_xor_b32 v11, 0x80000000, v11
    v_accvgpr_write_b32 a130, v10
    v_accvgpr_write_b32 a131, v11
    v_perm_b32 v10, v38, v34, s26
    v_perm_b32 v11, v38, v34, s27
    v_xor_b32 v10, 0x80000000, v10
    v_xor_b32 v11, 0x80000000, v11
    v_accvgpr_write_b32 a132, v10
    v_accvgpr_write_b32 a133, v11
    v_perm_b32 v10, v39, v35, s26
    v_perm_b32 v11, v39, v35, s27
    v_xor_b32 v10, 0x80000000, v10
    v_xor_b32 v11, 0x80000000, v11
    v_accvgpr_write_b32 a134, v10
    v_accvgpr_write_b32 a135, v11
    v_perm_b32 v10, v44, v40, s26
    v_perm_b32 v11, v44, v40, s27
    v_xor_b32 v10, 0x80000000, v10
    v_xor_b32 v11, 0x80000000, v11
    v_accvgpr_write_b32 a136, v10
    v_accvgpr_write_b32 a137, v11
    v_perm_b32 v10, v45, v41, s26
    v_perm_b32 v11, v45, v41, s27
    v_xor_b32 v10, 0x80000000, v10
    v_xor_b32 v11, 0x80000000, v11
    v_accvgpr_write_b32 a138, v10
    v_accvgpr_write_b32 a139, v11
    v_perm_b32 v10, v46, v42, s26
    v_perm_b32 v11, v46, v42, s27
    v_xor_b32 v10, 0x80000000, v10
    v_xor_b32 v11, 0x80000000, v11
    v_accvgpr_write_b32 a140, v10
    v_accvgpr_write_b32 a141, v11
    v_perm_b32 v10, v47, v43, s26
    v_perm_b32 v11, v47, v43, s27
    v_xor_b32 v10, 0x80000000, v10
    v_xor_b32 v11, 0x80000000, v11
    v_accvgpr_write_b32 a142, v10
    v_accvgpr_write_b32 a143, v11
    v_perm_b32 v10, v52, v48, s26
    v_perm_b32 v11, v52, v48, s27
    v_xor_b32 v10, 0x80000000, v10
    v_xor_b32 v11, 0x80000000, v11
    v_accvgpr_write_b32 a144, v10
    v_accvgpr_write_b32 a145, v11
    v_perm_b32 v10, v53, v49, s26
    v_perm_b32 v11, v53, v49, s27
    v_xor_b32 v10, 0x80000000, v10
    v_xor_b32 v11, 0x80000000, v11
    v_accvgpr_write_b32 a146, v10
    v_accvgpr_write_b32 a147, v11
    v_perm_b32 v10, v54, v50, s26
    v_perm_b32 v11, v54, v50, s27
    v_xor_b32 v10, 0x80000000, v10
    v_xor_b32 v11, 0x80000000, v11
    v_accvgpr_write_b32 a148, v10
    v_accvgpr_write_b32 a149, v11
    v_perm_b32 v10, v55, v51, s26
    v_perm_b32 v11, v55, v51, s27
    v_xor_b32 v10, 0x80000000, v10
    v_xor_b32 v11, 0x80000000, v11
    v_accvgpr_write_b32 a150, v10
    v_accvgpr_write_b32 a151, v11
    v_perm_b32 v10, v60, v56, s26
    v_perm_b32 v11, v60, v56, s27
    v_xor_b32 v10, 0x80000000, v10
    v_xor_b32 v11, 0x80000000, v11
    v_accvgpr_write_b32 a152, v10
    v_accvgpr_write_b32 a153, v11
    v_perm_b32 v10, v61, v57, s26
    v_perm_b32 v11, v61, v57, s27
    v_xor_b32 v10, 0x80000000, v10
    v_xor_b32 v11, 0x80000000, v11
    v_accvgpr_write_b32 a154, v10
    v_accvgpr_write_b32 a155, v11
    v_perm_b32 v10, v62, v58, s26
    v_perm_b32 v11, v62, v58, s27
    v_xor_b32 v10, 0x80000000, v10
    v_xor_b32 v11, 0x80000000, v11
    v_accvgpr_write_b32 a156, v10
    v_accvgpr_write_b32 a157, v11
    v_perm_b32 v10, v63, v59, s26
    v_perm_b32 v11, v63, v59, s27
    v_xor_b32 v10, 0x80000000, v10
    v_xor_b32 v11, 0x80000000, v11
    v_accvgpr_write_b32 a158, v10
    v_accvgpr_write_b32 a159, v11
    v_perm_b32 v10, v68, v64, s26
    v_perm_b32 v11, v68, v64, s27
    v_xor_b32 v10, 0x80000000, v10
    v_xor_b32 v11, 0x80000000, v11
    v_accvgpr_write_b32 a160, v10
    v_accvgpr_write_b32 a161, v11
    v_perm_b32 v10, v69, v65, s26
    v_perm_b32 v11, v69, v65, s27
    v_xor_b32 v10, 0x80000000, v10
    v_xor_b32 v11, 0x80000000, v11
    v_accvgpr_write_b32 a162, v10
    v_accvgpr_write_b32 a163, v11
    v_perm_b32 v10, v70, v66, s26
    v_perm_b32 v11, v70, v66, s27
    v_xor_b32 v10, 0x80000000, v10
    v_xor_b32 v11, 0x80000000, v11
    v_accvgpr_write_b32 a164, v10
    v_accvgpr_write_b32 a165, v11
    v_perm_b32 v10, v71, v67, s26
    v_perm_b32 v11, v71, v67, s27
    v_xor_b32 v10, 0x80000000, v10
    v_xor_b32 v11, 0x80000000, v11
    v_accvgpr_write_b32 a166, v10
    v_accvgpr_write_b32 a167, v11
    v_perm_b32 v10, v76, v72, s26
    v_perm_b32 v11, v76, v72, s27
    v_xor_b32 v10, 0x80000000, v10
    v_xor_b32 v11, 0x80000000, v11
    v_accvgpr_write_b32 a168, v10
    v_accvgpr_write_b32 a169, v11
    v_perm_b32 v10, v77, v73, s26
    v_perm_b32 v11, v77, v73, s27
    v_xor_b32 v10, 0x80000000, v10
    v_xor_b32 v11, 0x80000000, v11
    v_accvgpr_write_b32 a170, v10
    v_accvgpr_write_b32 a171, v11
    v_perm_b32 v10, v78, v74, s26
    v_perm_b32 v11, v78, v74, s27
    v_xor_b32 v10, 0x80000000, v10
    v_xor_b32 v11, 0x80000000, v11
    v_accvgpr_write_b32 a172, v10
    v_accvgpr_write_b32 a173, v11
    v_perm_b32 v10, v79, v75, s26
    v_perm_b32 v11, v79, v75, s27
    v_xor_b32 v10, 0x80000000, v10
    v_xor_b32 v11, 0x80000000, v11
    v_accvgpr_write_b32 a174, v10
    v_accvgpr_write_b32 a175, v11
    v_perm_b32 v10, v84, v80, s26
    v_perm_b32 v11, v84, v80, s27
    v_xor_b32 v10, 0x80000000, v10
    v_xor_b32 v11, 0x80000000, v11
    v_accvgpr_write_b32 a176, v10
    v_accvgpr_write_b32 a177, v11
    v_perm_b32 v10, v85, v81, s26
    v_perm_b32 v11, v85, v81, s27
    v_xor_b32 v10, 0x80000000, v10
    v_xor_b32 v11, 0x80000000, v11
    v_accvgpr_write_b32 a178, v10
    v_accvgpr_write_b32 a179, v11
    v_perm_b32 v10, v86, v82, s26
    v_perm_b32 v11, v86, v82, s27
    v_xor_b32 v10, 0x80000000, v10
    v_xor_b32 v11, 0x80000000, v11
    v_accvgpr_write_b32 a180, v10
    v_accvgpr_write_b32 a181, v11
    v_perm_b32 v10, v87, v83, s26
    v_perm_b32 v11, v87, v83, s27
    v_xor_b32 v10, 0x80000000, v10
    v_xor_b32 v11, 0x80000000, v11
    v_accvgpr_write_b32 a182, v10
    v_accvgpr_write_b32 a183, v11
    v_perm_b32 v10, v92, v88, s26
    v_perm_b32 v11, v92, v88, s27
    v_xor_b32 v10, 0x80000000, v10
    v_xor_b32 v11, 0x80000000, v11
    v_accvgpr_write_b32 a184, v10
    v_accvgpr_write_b32 a185, v11
    v_perm_b32 v10, v93, v89, s26
    v_perm_b32 v11, v93, v89, s27
    v_xor_b32 v10, 0x80000000, v10
    v_xor_b32 v11, 0x80000000, v11
    v_accvgpr_write_b32 a186, v10
    v_accvgpr_write_b32 a187, v11
    v_perm_b32 v10, v94, v90, s26
    v_perm_b32 v11, v94, v90, s27
    v_xor_b32 v10, 0x80000000, v10
    v_xor_b32 v11, 0x80000000, v11
    v_accvgpr_write_b32 a188, v10
    v_accvgpr_write_b32 a189, v11
    v_perm_b32 v10, v95, v91, s26
    v_perm_b32 v11, v95, v91, s27
    v_xor_b32 v10, 0x80000000, v10
    v_xor_b32 v11, 0x80000000, v11
    v_accvgpr_write_b32 a190, v10
    v_accvgpr_write_b32 a191, v11
    buffer_load_dwordx4 v[32:35], v5, s[16:19], 0 offen offset:768
    buffer_load_dwordx4 v[36:39], v5, s[20:23], 0 offen offset:768
    buffer_load_dwordx4 v[40:43], v5, s[16:19], 0 offen offset:800
    buffer_load_dwordx4 v[44:47], v5, s[20:23], 0 offen offset:800
    buffer_load_dwordx4 v[48:51], v5, s[16:19], 0 offen offset:832
    buffer_load_dwordx4 v[52:55], v5, s[20:23], 0 offen offset:832
    buffer_load_dwordx4 v[56:59], v5, s[16:19], 0 offen offset:864
    buffer_load_dwordx4 v[60:63], v5, s[20:23], 0 offen offset:864
    buffer_load_dwordx4 v[64:67], v5, s[16:19], 0 offen offset:896
    buffer_load_dwordx4 v[68:71], v5, s[20:23], 0 offen offset:896
    buffer_load_dwordx4 v[72:75], v5, s[16:19], 0 offen offset:928
    buffer_load_dwordx4 v[76:79], v5, s[20:23], 0 offen offset:928
    buffer_load_dwordx4 v[80:83], v5, s[16:19], 0 offen offset:960
    buffer_load_dwordx4 v[84:87], v5, s[20:23], 0 offen offset:960
    buffer_load_dwordx4 v[88:91], v5, s[16:19], 0 offen offset:992
    buffer_load_dwordx4 v[92:95], v5, s[20:23], 0 offen offset:992
    s_waitcnt vmcnt(0)
    v_perm_b32 v10, v36, v32, s26
    v_perm_b32 v11, v36, v32, s27
    v_xor_b32 v10, 0x80000000, v10
    v_xor_b32 v11, 0x80000000, v11
    v_accvgpr_write_b32 a192, v10
    v_accvgpr_write_b32 a193, v11
    v_perm_b32 v10, v37, v33, s26
    v_perm_b32 v11, v37, v33, s27
    v_xor_b32 v10, 0x80000000, v10
    v_xor_b32 v11, 0x80000000, v11
    v_accvgpr_write_b32 a194, v10
    v_accvgpr_write_b32 a195, v11
    v_perm_b32 v10, v38, v34, s26
    v_perm_b32 v11, v38, v34, s27
    v_xor_b32 v10, 0x80000000, v10
    v_xor_b32 v11, 0x80000000, v11
    v_accvgpr_write_b32 a196, v10
    v_accvgpr_write_b32 a197, v11
    v_perm_b32 v10, v39, v35, s26
    v_perm_b32 v11, v39, v35, s27
    v_xor_b32 v10, 0x80000000, v10
    v_xor_b32 v11, 0x80000000, v11
    v_accvgpr_write_b32 a198, v10
    v_accvgpr_write_b32 a199, v11
    v_perm_b32 v10, v44, v40, s26
    v_perm_b32 v11, v44, v40, s27
    v_xor_b32 v10, 0x80000000, v10
    v_xor_b32 v11, 0x80000000, v11
    v_accvgpr_write_b32 a200, v10
    v_accvgpr_write_b32 a201, v11
    v_perm_b32 v10, v45, v41, s26
    v_perm_b32 v11, v45, v41, s27
    v_xor_b32 v10, 0x80000000, v10
    v_xor_b32 v11, 0x80000000, v11
    v_accvgpr_write_b32 a202, v10
    v_accvgpr_write_b32 a203, v11
    v_perm_b32 v10, v46, v42, s26
    v_perm_b32 v11, v46, v42, s27
    v_xor_b32 v10, 0x80000000, v10
    v_xor_b32 v11, 0x80000000, v11
    v_accvgpr_write_b32 a204, v10
    v_accvgpr_write_b32 a205, v11
    v_perm_b32 v10, v47, v43, s26
    v_perm_b32 v11, v47, v43, s27
    v_xor_b32 v10, 0x80000000, v10
    v_xor_b32 v11, 0x80000000, v11
    v_accvgpr_write_b32 a206, v10
    v_accvgpr_write_b32 a207, v11
    v_perm_b32 v10, v52, v48, s26
    v_perm_b32 v11, v52, v48, s27
    v_xor_b32 v10, 0x80000000, v10
    v_xor_b32 v11, 0x80000000, v11
    v_accvgpr_write_b32 a208, v10
    v_accvgpr_write_b32 a209, v11
    v_perm_b32 v10, v53, v49, s26
    v_perm_b32 v11, v53, v49, s27
    v_xor_b32 v10, 0x80000000, v10
    v_xor_b32 v11, 0x80000000, v11
    v_accvgpr_write_b32 a210, v10
    v_accvgpr_write_b32 a211, v11
    v_perm_b32 v10, v54, v50, s26
    v_perm_b32 v11, v54, v50, s27
    v_xor_b32 v10, 0x80000000, v10
    v_xor_b32 v11, 0x80000000, v11
    v_accvgpr_write_b32 a212, v10
    v_accvgpr_write_b32 a213, v11
    v_perm_b32 v10, v55, v51, s26
    v_perm_b32 v11, v55, v51, s27
    v_xor_b32 v10, 0x80000000, v10
    v_xor_b32 v11, 0x80000000, v11
    v_accvgpr_write_b32 a214, v10
    v_accvgpr_write_b32 a215, v11
    v_perm_b32 v10, v60, v56, s26
    v_perm_b32 v11, v60, v56, s27
    v_xor_b32 v10, 0x80000000, v10
    v_xor_b32 v11, 0x80000000, v11
    v_accvgpr_write_b32 a216, v10
    v_accvgpr_write_b32 a217, v11
    v_perm_b32 v10, v61, v57, s26
    v_perm_b32 v11, v61, v57, s27
    v_xor_b32 v10, 0x80000000, v10
    v_xor_b32 v11, 0x80000000, v11
    v_accvgpr_write_b32 a218, v10
    v_accvgpr_write_b32 a219, v11
    v_perm_b32 v10, v62, v58, s26
    v_perm_b32 v11, v62, v58, s27
    v_xor_b32 v10, 0x80000000, v10
    v_xor_b32 v11, 0x80000000, v11
    v_accvgpr_write_b32 a220, v10
    v_accvgpr_write_b32 a221, v11
    v_perm_b32 v10, v63, v59, s26
    v_perm_b32 v11, v63, v59, s27
    v_xor_b32 v10, 0x80000000, v10
    v_xor_b32 v11, 0x80000000, v11
    v_accvgpr_write_b32 a222, v10
    v_accvgpr_write_b32 a223, v11
    v_perm_b32 v10, v68, v64, s26
    v_perm_b32 v11, v68, v64, s27
    v_xor_b32 v10, 0x80000000, v10
    v_xor_b32 v11, 0x80000000, v11
    v_accvgpr_write_b32 a224, v10
    v_accvgpr_write_b32 a225, v11
    v_perm_b32 v10, v69, v65, s26
    v_perm_b32 v11, v69, v65, s27
    v_xor_b32 v10, 0x80000000, v10
    v_xor_b32 v11, 0x80000000, v11
    v_accvgpr_write_b32 a226, v10
    v_accvgpr_write_b32 a227, v11
    v_perm_b32 v10, v70, v66, s26
    v_perm_b32 v11, v70, v66, s27
    v_xor_b32 v10, 0x80000000, v10
    v_xor_b32 v11, 0x80000000, v11
    v_accvgpr_write_b32 a228, v10
    v_accvgpr_write_b32 a229, v11
    v_perm_b32 v10, v71, v67, s26
    v_perm_b32 v11, v71, v67, s27
    v_xor_b32 v10, 0x80000000, v10
    v_xor_b32 v11, 0x80000000, v11
    v_accvgpr_write_b32 a230, v10
    v_accvgpr_write_b32 a231, v11
    v_perm_b32 v10, v76, v72, s26
    v_perm_b32 v11, v76, v72, s27
    v_xor_b32 v10, 0x80000000, v10
    v_xor_b32 v11, 0x80000000, v11
    v_accvgpr_write_b32 a232, v10
    v_accvgpr_write_b32 a233, v11
    v_perm_b32 v10, v77, v73, s26
    v_perm_b32 v11, v77, v73, s27
    v_xor_b32 v10, 0x80000000, v10
    v_xor_b32 v11, 0x80000000, v11
    v_accvgpr_write_b32 a234, v10
    v_accvgpr_write_b32 a235, v11
    v_perm_b32 v10, v78, v74, s26
    v_perm_b32 v11, v78, v74, s27
    v_xor_b32 v10, 0x80000000, v10
    v_xor_b32 v11, 0x80000000, v11
    v_accvgpr_write_b32 a236, v10
    v_accvgpr_write_b32 a237, v11
    v_perm_b32 v10, v79, v75, s26
    v_perm_b32 v11, v79, v75, s27
    v_xor_b32 v10, 0x80000000, v10
    v_xor_b32 v11, 0x80000000, v11
    v_accvgpr_write_b32 a238, v10
    v_accvgpr_write_b32 a239, v11
    v_perm_b32 v10, v84, v80, s26
    v_perm_b32 v11, v84, v80, s27
    v_xor_b32 v10, 0x80000000, v10
    v_xor_b32 v11, 0x80000000, v11
    v_accvgpr_write_b32 a240, v10
    v_accvgpr_write_b32 a241, v11
    v_perm_b32 v10, v85, v81, s26
    v_perm_b32 v11, v85, v81, s27
    v_xor_b32 v10, 0x80000000, v10
    v_xor_b32 v11, 0x80000000, v11
    v_accvgpr_write_b32 a242, v10
    v_accvgpr_write_b32 a243, v11
    v_perm_b32 v10, v86, v82, s26
    v_perm_b32 v11, v86, v82, s27
    v_xor_b32 v10, 0x80000000, v10
    v_xor_b32 v11, 0x80000000, v11
    v_accvgpr_write_b32 a244, v10
    v_accvgpr_write_b32 a245, v11
    v_perm_b32 v10, v87, v83, s26
    v_perm_b32 v11, v87, v83, s27
    v_xor_b32 v10, 0x80000000, v10
    v_xor_b32 v11, 0x80000000, v11
    v_accvgpr_write_b32 a246, v10
    v_accvgpr_write_b32 a247, v11
    v_perm_b32 v10, v92, v88, s26
    v_perm_b32 v11, v92, v88, s27
    v_xor_b32 v10, 0x80000000, v10
    v_xor_b32 v11, 0x80000000, v11
    v_accvgpr_write_b32 a248, v10
    v_accvgpr_write_b32 a249, v11
    v_perm_b32 v10, v93, v89, s26
    v_perm_b32 v11, v93, v89, s27
    v_xor_b32 v10, 0x80000000, v10
    v_xor_b32 v11, 0x80000000, v11
    v_accvgpr_write_b32 a250, v10
    v_accvgpr_write_b32 a251, v11
    v_perm_b32 v10, v94, v90, s26
    v_perm_b32 v11, v94, v90, s27
    v_xor_b32 v10, 0x80000000, v10
    v_xor_b32 v11, 0x80000000, v11
    v_accvgpr_write_b32 a252, v10
    v_accvgpr_write_b32 a253, v11
    v_perm_b32 v10, v95, v91, s26
    v_perm_b32 v11, v95, v91, s27
    v_xor_b32 v10, 0x80000000, v10
    v_xor_b32 v11, 0x80000000, v11
    v_accvgpr_write_b32 a254, v10
    v_accvgpr_write_b32 a255, v11
    s_load_dwordx2 s[16:17], s[0:1], 120
    s_mov_b32 s18, 1024
    s_mov_b32 s19, 0x20000
    s_waitcnt lgkmcnt(0)
    v_lshlrev_b32 v10, 1, v9
    buffer_load_ushort v12, v10, s[16:19], 0 offen
    s_waitcnt vmcnt(0)
    v_lshlrev_b32 v12, 16, v12
    s_load_dwordx2 s[12:13], s[0:1], 56
    s_mov_b32 s14, 2097152
    s_mov_b32 s15, 0x20000
    s_waitcnt lgkmcnt(0)
    s_load_dwordx2 s[20:21], s[0:1], 128
    s_mov_b32 s22, 8388608
    s_mov_b32 s23, 0x20000
    s_waitcnt lgkmcnt(0)
    v_mul_u32_u24 v6, 2064, v2
    v_lshlrev_b32 v7, 5, v3
    v_add_u32 v6, v6, v7
    v_lshlrev_b32 v7, 12, v3
    v_lshlrev_b32 v8, 1, v9
    v_add_u32 v7, v7, v8
    v_lshlrev_b32 v8, 14, v3
    v_lshlrev_b32 v10, 2, v9
    v_add3_u32 v8, v8, v10, 0
    v_add_u32 v8, 2048, v8
    s_mov_b32 s25, 591232
    v_mov_b32 v120, 0
L_yy_ws_w:
    buffer_load_dword v121, v120, s[8:11], s25 offen sc1
    s_waitcnt vmcnt(0)
    v_readfirstlane_b32 s28, v121
    s_cmp_ge_u32 s28, 32
    s_cbranch_scc1 L_yy_ws_d
    s_sleep 4
    s_add_u32 s35, s35, 1
    s_cmp_lt_u32 s35, 1000000
    s_cbranch_scc1 L_yy_ws_w
    s_endpgm
L_yy_ws_d:
    s_mov_b32 s31, s29
    s_mov_b32 s33, 0
    s_lshl_b32 s25, s31, 16
    s_lshl_b32 s26, s24, 14
    s_add_u32 s25, s25, s26
    s_add_u32 s25, s25, 109051904
    s_mul_i32 s26, s24, 16512
    s_add_u32 s26, s26, 0
    s_add_u32 m0, s26, 0
    s_add_u32 s27, s25, 0
    buffer_load_dwordx4 v4, s[8:11], s27 offen sc1 lds
    s_add_u32 m0, s26, 1024
    s_add_u32 s27, s25, 1024
    buffer_load_dwordx4 v4, s[8:11], s27 offen sc1 lds
    s_add_u32 m0, s26, 2064
    s_add_u32 s27, s25, 2048
    buffer_load_dwordx4 v4, s[8:11], s27 offen sc1 lds
    s_add_u32 m0, s26, 3088
    s_add_u32 s27, s25, 3072
    buffer_load_dwordx4 v4, s[8:11], s27 offen sc1 lds
    s_add_u32 m0, s26, 4128
    s_add_u32 s27, s25, 4096
    buffer_load_dwordx4 v4, s[8:11], s27 offen sc1 lds
    s_add_u32 m0, s26, 5152
    s_add_u32 s27, s25, 5120
    buffer_load_dwordx4 v4, s[8:11], s27 offen sc1 lds
    s_add_u32 m0, s26, 6192
    s_add_u32 s27, s25, 6144
    buffer_load_dwordx4 v4, s[8:11], s27 offen sc1 lds
    s_add_u32 m0, s26, 7216
    s_add_u32 s27, s25, 7168
    buffer_load_dwordx4 v4, s[8:11], s27 offen sc1 lds
    s_add_u32 m0, s26, 8256
    s_add_u32 s27, s25, 8192
    buffer_load_dwordx4 v4, s[8:11], s27 offen sc1 lds
    s_add_u32 m0, s26, 9280
    s_add_u32 s27, s25, 9216
    buffer_load_dwordx4 v4, s[8:11], s27 offen sc1 lds
    s_add_u32 m0, s26, 10320
    s_add_u32 s27, s25, 10240
    buffer_load_dwordx4 v4, s[8:11], s27 offen sc1 lds
    s_add_u32 m0, s26, 11344
    s_add_u32 s27, s25, 11264
    buffer_load_dwordx4 v4, s[8:11], s27 offen sc1 lds
    s_add_u32 m0, s26, 12384
    s_add_u32 s27, s25, 12288
    buffer_load_dwordx4 v4, s[8:11], s27 offen sc1 lds
    s_add_u32 m0, s26, 13408
    s_add_u32 s27, s25, 13312
    buffer_load_dwordx4 v4, s[8:11], s27 offen sc1 lds
    s_add_u32 m0, s26, 14448
    s_add_u32 s27, s25, 14336
    buffer_load_dwordx4 v4, s[8:11], s27 offen sc1 lds
    s_add_u32 m0, s26, 15472
    s_add_u32 s27, s25, 15360
    buffer_load_dwordx4 v4, s[8:11], s27 offen sc1 lds
L_yy_loop:
    s_waitcnt vmcnt(0)
    s_barrier
    s_mov_b32 s28, s31
    s_add_u32 s31, s31, 8
    s_cmp_ge_u32 s31, 64
    s_cbranch_scc1 L_yy_nx0
    s_lshl_b32 s25, s31, 16
    s_lshl_b32 s26, s24, 14
    s_add_u32 s25, s25, s26
    s_add_u32 s25, s25, 109051904
    s_mul_i32 s26, s24, 16512
    s_add_u32 s26, s26, 66048
    s_add_u32 m0, s26, 0
    s_add_u32 s27, s25, 0
    buffer_load_dwordx4 v4, s[8:11], s27 offen sc1 lds
    s_add_u32 m0, s26, 1024
    s_add_u32 s27, s25, 1024
    buffer_load_dwordx4 v4, s[8:11], s27 offen sc1 lds
    s_add_u32 m0, s26, 2064
    s_add_u32 s27, s25, 2048
    buffer_load_dwordx4 v4, s[8:11], s27 offen sc1 lds
    s_add_u32 m0, s26, 3088
    s_add_u32 s27, s25, 3072
    buffer_load_dwordx4 v4, s[8:11], s27 offen sc1 lds
    s_add_u32 m0, s26, 4128
    s_add_u32 s27, s25, 4096
    buffer_load_dwordx4 v4, s[8:11], s27 offen sc1 lds
    s_add_u32 m0, s26, 5152
    s_add_u32 s27, s25, 5120
    buffer_load_dwordx4 v4, s[8:11], s27 offen sc1 lds
    s_add_u32 m0, s26, 6192
    s_add_u32 s27, s25, 6144
    buffer_load_dwordx4 v4, s[8:11], s27 offen sc1 lds
    s_add_u32 m0, s26, 7216
    s_add_u32 s27, s25, 7168
    buffer_load_dwordx4 v4, s[8:11], s27 offen sc1 lds
    s_add_u32 m0, s26, 8256
    s_add_u32 s27, s25, 8192
    buffer_load_dwordx4 v4, s[8:11], s27 offen sc1 lds
    s_add_u32 m0, s26, 9280
    s_add_u32 s27, s25, 9216
    buffer_load_dwordx4 v4, s[8:11], s27 offen sc1 lds
    s_add_u32 m0, s26, 10320
    s_add_u32 s27, s25, 10240
    buffer_load_dwordx4 v4, s[8:11], s27 offen sc1 lds
    s_add_u32 m0, s26, 11344
    s_add_u32 s27, s25, 11264
    buffer_load_dwordx4 v4, s[8:11], s27 offen sc1 lds
    s_add_u32 m0, s26, 12384
    s_add_u32 s27, s25, 12288
    buffer_load_dwordx4 v4, s[8:11], s27 offen sc1 lds
    s_add_u32 m0, s26, 13408
    s_add_u32 s27, s25, 13312
    buffer_load_dwordx4 v4, s[8:11], s27 offen sc1 lds
    s_add_u32 m0, s26, 14448
    s_add_u32 s27, s25, 14336
    buffer_load_dwordx4 v4, s[8:11], s27 offen sc1 lds
    s_add_u32 m0, s26, 15472
    s_add_u32 s27, s25, 15360
    buffer_load_dwordx4 v4, s[8:11], s27 offen sc1 lds
L_yy_nx0:
    s_lshl_b32 s25, s28, 15
    s_add_u32 s26, s25, 0
    buffer_load_ushort v96, v7, s[12:15], s26 offen
    s_add_u32 s26, s25, 1024
    buffer_load_ushort v97, v7, s[12:15], s26 offen
    s_add_u32 s26, s25, 2048
    buffer_load_ushort v98, v7, s[12:15], s26 offen
    s_add_u32 s26, s25, 3072
    buffer_load_ushort v99, v7, s[12:15], s26 offen
    s_add_u32 s26, s25, 8192
    buffer_load_ushort v100, v7, s[12:15], s26 offen
    s_add_u32 s26, s25, 9216
    buffer_load_ushort v101, v7, s[12:15], s26 offen
    s_add_u32 s26, s25, 10240
    buffer_load_ushort v102, v7, s[12:15], s26 offen
    s_add_u32 s26, s25, 11264
    buffer_load_ushort v103, v7, s[12:15], s26 offen
    s_add_u32 s26, s25, 16384
    buffer_load_ushort v104, v7, s[12:15], s26 offen
    s_add_u32 s26, s25, 17408
    buffer_load_ushort v105, v7, s[12:15], s26 offen
    s_add_u32 s26, s25, 18432
    buffer_load_ushort v106, v7, s[12:15], s26 offen
    s_add_u32 s26, s25, 19456
    buffer_load_ushort v107, v7, s[12:15], s26 offen
    s_add_u32 s26, s25, 24576
    buffer_load_ushort v108, v7, s[12:15], s26 offen
    s_add_u32 s26, s25, 25600
    buffer_load_ushort v109, v7, s[12:15], s26 offen
    s_add_u32 s26, s25, 26624
    buffer_load_ushort v110, v7, s[12:15], s26 offen
    s_add_u32 s26, s25, 27648
    buffer_load_ushort v111, v7, s[12:15], s26 offen
    v_add_u32 v13, 66048, v6
    ds_read_b128 v[64:67], v6 offset:0
    ds_read_b128 v[68:71], v6 offset:16
    ds_read_b128 v[72:75], v6 offset:64
    ds_read_b128 v[76:79], v6 offset:80
    ds_read_b128 v[80:83], v6 offset:128
    ds_read_b128 v[84:87], v6 offset:144
    ds_read_b128 v[88:91], v6 offset:192
    ds_read_b128 v[92:95], v6 offset:208
    s_waitcnt lgkmcnt(7)
    v_mfma_f32_32x32x16_bf16 v[32:47], v[64:67], a[0:3], 0
    ds_read_b128 v[64:67], v6 offset:256
    s_waitcnt lgkmcnt(7)
    v_mfma_f32_32x32x16_bf16 v[32:47], v[68:71], a[4:7], v[32:47]
    ds_read_b128 v[68:71], v6 offset:272
    s_waitcnt lgkmcnt(7)
    v_mfma_f32_32x32x16_bf16 v[32:47], v[72:75], a[8:11], v[32:47]
    ds_read_b128 v[72:75], v6 offset:320
    s_waitcnt lgkmcnt(7)
    v_mfma_f32_32x32x16_bf16 v[32:47], v[76:79], a[12:15], v[32:47]
    ds_read_b128 v[76:79], v6 offset:336
    s_waitcnt lgkmcnt(7)
    v_mfma_f32_32x32x16_bf16 v[32:47], v[80:83], a[16:19], v[32:47]
    ds_read_b128 v[80:83], v6 offset:384
    s_waitcnt lgkmcnt(7)
    v_mfma_f32_32x32x16_bf16 v[32:47], v[84:87], a[20:23], v[32:47]
    ds_read_b128 v[84:87], v6 offset:400
    s_waitcnt lgkmcnt(7)
    v_mfma_f32_32x32x16_bf16 v[32:47], v[88:91], a[24:27], v[32:47]
    ds_read_b128 v[88:91], v6 offset:448
    s_waitcnt lgkmcnt(7)
    v_mfma_f32_32x32x16_bf16 v[32:47], v[92:95], a[28:31], v[32:47]
    ds_read_b128 v[92:95], v6 offset:464
    s_waitcnt lgkmcnt(7)
    v_mfma_f32_32x32x16_bf16 v[32:47], v[64:67], a[32:35], v[32:47]
    ds_read_b128 v[64:67], v6 offset:512
    s_waitcnt lgkmcnt(7)
    v_mfma_f32_32x32x16_bf16 v[32:47], v[68:71], a[36:39], v[32:47]
    ds_read_b128 v[68:71], v6 offset:528
    s_waitcnt lgkmcnt(7)
    v_mfma_f32_32x32x16_bf16 v[32:47], v[72:75], a[40:43], v[32:47]
    ds_read_b128 v[72:75], v6 offset:576
    s_waitcnt lgkmcnt(7)
    v_mfma_f32_32x32x16_bf16 v[32:47], v[76:79], a[44:47], v[32:47]
    ds_read_b128 v[76:79], v6 offset:592
    s_waitcnt lgkmcnt(7)
    v_mfma_f32_32x32x16_bf16 v[32:47], v[80:83], a[48:51], v[32:47]
    ds_read_b128 v[80:83], v6 offset:640
    s_waitcnt lgkmcnt(7)
    v_mfma_f32_32x32x16_bf16 v[32:47], v[84:87], a[52:55], v[32:47]
    ds_read_b128 v[84:87], v6 offset:656
    s_waitcnt lgkmcnt(7)
    v_mfma_f32_32x32x16_bf16 v[32:47], v[88:91], a[56:59], v[32:47]
    ds_read_b128 v[88:91], v6 offset:704
    s_waitcnt lgkmcnt(7)
    v_mfma_f32_32x32x16_bf16 v[32:47], v[92:95], a[60:63], v[32:47]
    ds_read_b128 v[92:95], v6 offset:720
    s_waitcnt lgkmcnt(7)
    v_mfma_f32_32x32x16_bf16 v[32:47], v[64:67], a[64:67], v[32:47]
    ds_read_b128 v[64:67], v6 offset:768
    s_waitcnt lgkmcnt(7)
    v_mfma_f32_32x32x16_bf16 v[32:47], v[68:71], a[68:71], v[32:47]
    ds_read_b128 v[68:71], v6 offset:784
    s_waitcnt lgkmcnt(7)
    v_mfma_f32_32x32x16_bf16 v[32:47], v[72:75], a[72:75], v[32:47]
    ds_read_b128 v[72:75], v6 offset:832
    s_waitcnt lgkmcnt(7)
    v_mfma_f32_32x32x16_bf16 v[32:47], v[76:79], a[76:79], v[32:47]
    ds_read_b128 v[76:79], v6 offset:848
    s_waitcnt lgkmcnt(7)
    v_mfma_f32_32x32x16_bf16 v[32:47], v[80:83], a[80:83], v[32:47]
    ds_read_b128 v[80:83], v6 offset:896
    s_waitcnt lgkmcnt(7)
    v_mfma_f32_32x32x16_bf16 v[32:47], v[84:87], a[84:87], v[32:47]
    ds_read_b128 v[84:87], v6 offset:912
    s_waitcnt lgkmcnt(7)
    v_mfma_f32_32x32x16_bf16 v[32:47], v[88:91], a[88:91], v[32:47]
    ds_read_b128 v[88:91], v6 offset:960
    s_waitcnt lgkmcnt(7)
    v_mfma_f32_32x32x16_bf16 v[32:47], v[92:95], a[92:95], v[32:47]
    ds_read_b128 v[92:95], v6 offset:976
    s_waitcnt lgkmcnt(7)
    v_mfma_f32_32x32x16_bf16 v[32:47], v[64:67], a[96:99], v[32:47]
    ds_read_b128 v[64:67], v6 offset:1024
    s_waitcnt lgkmcnt(7)
    v_mfma_f32_32x32x16_bf16 v[32:47], v[68:71], a[100:103], v[32:47]
    ds_read_b128 v[68:71], v6 offset:1040
    s_waitcnt lgkmcnt(7)
    v_mfma_f32_32x32x16_bf16 v[32:47], v[72:75], a[104:107], v[32:47]
    ds_read_b128 v[72:75], v6 offset:1088
    s_waitcnt lgkmcnt(7)
    v_mfma_f32_32x32x16_bf16 v[32:47], v[76:79], a[108:111], v[32:47]
    ds_read_b128 v[76:79], v6 offset:1104
    s_waitcnt lgkmcnt(7)
    v_mfma_f32_32x32x16_bf16 v[32:47], v[80:83], a[112:115], v[32:47]
    ds_read_b128 v[80:83], v6 offset:1152
    s_waitcnt lgkmcnt(7)
    v_mfma_f32_32x32x16_bf16 v[32:47], v[84:87], a[116:119], v[32:47]
    ds_read_b128 v[84:87], v6 offset:1168
    s_waitcnt lgkmcnt(7)
    v_mfma_f32_32x32x16_bf16 v[32:47], v[88:91], a[120:123], v[32:47]
    ds_read_b128 v[88:91], v6 offset:1216
    s_waitcnt lgkmcnt(7)
    v_mfma_f32_32x32x16_bf16 v[32:47], v[92:95], a[124:127], v[32:47]
    ds_read_b128 v[92:95], v6 offset:1232
    s_waitcnt lgkmcnt(7)
    v_mfma_f32_32x32x16_bf16 v[32:47], v[64:67], a[128:131], v[32:47]
    ds_read_b128 v[64:67], v6 offset:1280
    s_waitcnt lgkmcnt(7)
    v_mfma_f32_32x32x16_bf16 v[32:47], v[68:71], a[132:135], v[32:47]
    ds_read_b128 v[68:71], v6 offset:1296
    s_waitcnt lgkmcnt(7)
    v_mfma_f32_32x32x16_bf16 v[32:47], v[72:75], a[136:139], v[32:47]
    ds_read_b128 v[72:75], v6 offset:1344
    s_waitcnt lgkmcnt(7)
    v_mfma_f32_32x32x16_bf16 v[32:47], v[76:79], a[140:143], v[32:47]
    ds_read_b128 v[76:79], v6 offset:1360
    s_waitcnt lgkmcnt(7)
    v_mfma_f32_32x32x16_bf16 v[32:47], v[80:83], a[144:147], v[32:47]
    ds_read_b128 v[80:83], v6 offset:1408
    s_waitcnt lgkmcnt(7)
    v_mfma_f32_32x32x16_bf16 v[32:47], v[84:87], a[148:151], v[32:47]
    ds_read_b128 v[84:87], v6 offset:1424
    s_waitcnt lgkmcnt(7)
    v_mfma_f32_32x32x16_bf16 v[32:47], v[88:91], a[152:155], v[32:47]
    ds_read_b128 v[88:91], v6 offset:1472
    s_waitcnt lgkmcnt(7)
    v_mfma_f32_32x32x16_bf16 v[32:47], v[92:95], a[156:159], v[32:47]
    ds_read_b128 v[92:95], v6 offset:1488
    s_waitcnt lgkmcnt(7)
    v_mfma_f32_32x32x16_bf16 v[32:47], v[64:67], a[160:163], v[32:47]
    ds_read_b128 v[64:67], v6 offset:1536
    s_waitcnt lgkmcnt(7)
    v_mfma_f32_32x32x16_bf16 v[32:47], v[68:71], a[164:167], v[32:47]
    ds_read_b128 v[68:71], v6 offset:1552
    s_waitcnt lgkmcnt(7)
    v_mfma_f32_32x32x16_bf16 v[32:47], v[72:75], a[168:171], v[32:47]
    ds_read_b128 v[72:75], v6 offset:1600
    s_waitcnt lgkmcnt(7)
    v_mfma_f32_32x32x16_bf16 v[32:47], v[76:79], a[172:175], v[32:47]
    ds_read_b128 v[76:79], v6 offset:1616
    s_waitcnt lgkmcnt(7)
    v_mfma_f32_32x32x16_bf16 v[32:47], v[80:83], a[176:179], v[32:47]
    ds_read_b128 v[80:83], v6 offset:1664
    s_waitcnt lgkmcnt(7)
    v_mfma_f32_32x32x16_bf16 v[32:47], v[84:87], a[180:183], v[32:47]
    ds_read_b128 v[84:87], v6 offset:1680
    s_waitcnt lgkmcnt(7)
    v_mfma_f32_32x32x16_bf16 v[32:47], v[88:91], a[184:187], v[32:47]
    ds_read_b128 v[88:91], v6 offset:1728
    s_waitcnt lgkmcnt(7)
    v_mfma_f32_32x32x16_bf16 v[32:47], v[92:95], a[188:191], v[32:47]
    ds_read_b128 v[92:95], v6 offset:1744
    s_waitcnt lgkmcnt(7)
    v_mfma_f32_32x32x16_bf16 v[32:47], v[64:67], a[192:195], v[32:47]
    ds_read_b128 v[64:67], v6 offset:1792
    s_waitcnt lgkmcnt(7)
    v_mfma_f32_32x32x16_bf16 v[32:47], v[68:71], a[196:199], v[32:47]
    ds_read_b128 v[68:71], v6 offset:1808
    s_waitcnt lgkmcnt(7)
    v_mfma_f32_32x32x16_bf16 v[32:47], v[72:75], a[200:203], v[32:47]
    ds_read_b128 v[72:75], v6 offset:1856
    s_waitcnt lgkmcnt(7)
    v_mfma_f32_32x32x16_bf16 v[32:47], v[76:79], a[204:207], v[32:47]
    ds_read_b128 v[76:79], v6 offset:1872
    s_waitcnt lgkmcnt(7)
    v_mfma_f32_32x32x16_bf16 v[32:47], v[80:83], a[208:211], v[32:47]
    ds_read_b128 v[80:83], v6 offset:1920
    s_waitcnt lgkmcnt(7)
    v_mfma_f32_32x32x16_bf16 v[32:47], v[84:87], a[212:215], v[32:47]
    ds_read_b128 v[84:87], v6 offset:1936
    s_waitcnt lgkmcnt(7)
    v_mfma_f32_32x32x16_bf16 v[32:47], v[88:91], a[216:219], v[32:47]
    ds_read_b128 v[88:91], v6 offset:1984
    s_waitcnt lgkmcnt(7)
    v_mfma_f32_32x32x16_bf16 v[32:47], v[92:95], a[220:223], v[32:47]
    ds_read_b128 v[92:95], v6 offset:2000
    s_waitcnt lgkmcnt(7)
    v_mfma_f32_32x32x16_bf16 v[32:47], v[64:67], a[224:227], v[32:47]
    s_waitcnt lgkmcnt(6)
    v_mfma_f32_32x32x16_bf16 v[32:47], v[68:71], a[228:231], v[32:47]
    s_waitcnt lgkmcnt(5)
    v_mfma_f32_32x32x16_bf16 v[32:47], v[72:75], a[232:235], v[32:47]
    s_waitcnt lgkmcnt(4)
    v_mfma_f32_32x32x16_bf16 v[32:47], v[76:79], a[236:239], v[32:47]
    s_waitcnt lgkmcnt(3)
    v_mfma_f32_32x32x16_bf16 v[32:47], v[80:83], a[240:243], v[32:47]
    s_waitcnt lgkmcnt(2)
    v_mfma_f32_32x32x16_bf16 v[32:47], v[84:87], a[244:247], v[32:47]
    s_waitcnt lgkmcnt(1)
    v_mfma_f32_32x32x16_bf16 v[32:47], v[88:91], a[248:251], v[32:47]
    s_waitcnt lgkmcnt(0)
    v_mfma_f32_32x32x16_bf16 v[32:47], v[92:95], a[252:255], v[32:47]
    s_waitcnt vmcnt(0)
    s_nop 7
    s_lshl_b32 s25, s28, 17
    v_lshlrev_b32 v96, 16, v96
    v_mul_f32 v96, v96, v12
    v_cvt_pk_bf16_f32 v96, v96, v96
    v_lshlrev_b32 v96, 16, v96
    v_fma_f32 v96, 2.0, v32, v96
    s_add_u32 s26, s25, 0
    buffer_store_dword v96, v8, s[20:23], s26 offen sc1
    v_lshlrev_b32 v97, 16, v97
    v_mul_f32 v97, v97, v12
    v_cvt_pk_bf16_f32 v97, v97, v97
    v_lshlrev_b32 v97, 16, v97
    v_fma_f32 v97, 2.0, v33, v97
    s_add_u32 s26, s25, 4096
    buffer_store_dword v97, v8, s[20:23], s26 offen sc1
    v_lshlrev_b32 v98, 16, v98
    v_mul_f32 v98, v98, v12
    v_cvt_pk_bf16_f32 v98, v98, v98
    v_lshlrev_b32 v98, 16, v98
    v_fma_f32 v98, 2.0, v34, v98
    s_add_u32 s26, s25, 8192
    buffer_store_dword v98, v8, s[20:23], s26 offen sc1
    v_lshlrev_b32 v99, 16, v99
    v_mul_f32 v99, v99, v12
    v_cvt_pk_bf16_f32 v99, v99, v99
    v_lshlrev_b32 v99, 16, v99
    v_fma_f32 v99, 2.0, v35, v99
    s_add_u32 s26, s25, 12288
    buffer_store_dword v99, v8, s[20:23], s26 offen sc1
    v_lshlrev_b32 v100, 16, v100
    v_mul_f32 v100, v100, v12
    v_cvt_pk_bf16_f32 v100, v100, v100
    v_lshlrev_b32 v100, 16, v100
    v_fma_f32 v100, 2.0, v36, v100
    s_add_u32 s26, s25, 32768
    buffer_store_dword v100, v8, s[20:23], s26 offen sc1
    v_lshlrev_b32 v101, 16, v101
    v_mul_f32 v101, v101, v12
    v_cvt_pk_bf16_f32 v101, v101, v101
    v_lshlrev_b32 v101, 16, v101
    v_fma_f32 v101, 2.0, v37, v101
    s_add_u32 s26, s25, 36864
    buffer_store_dword v101, v8, s[20:23], s26 offen sc1
    v_lshlrev_b32 v102, 16, v102
    v_mul_f32 v102, v102, v12
    v_cvt_pk_bf16_f32 v102, v102, v102
    v_lshlrev_b32 v102, 16, v102
    v_fma_f32 v102, 2.0, v38, v102
    s_add_u32 s26, s25, 40960
    buffer_store_dword v102, v8, s[20:23], s26 offen sc1
    v_lshlrev_b32 v103, 16, v103
    v_mul_f32 v103, v103, v12
    v_cvt_pk_bf16_f32 v103, v103, v103
    v_lshlrev_b32 v103, 16, v103
    v_fma_f32 v103, 2.0, v39, v103
    s_add_u32 s26, s25, 45056
    buffer_store_dword v103, v8, s[20:23], s26 offen sc1
    v_lshlrev_b32 v104, 16, v104
    v_mul_f32 v104, v104, v12
    v_cvt_pk_bf16_f32 v104, v104, v104
    v_lshlrev_b32 v104, 16, v104
    v_fma_f32 v104, 2.0, v40, v104
    s_add_u32 s26, s25, 65536
    buffer_store_dword v104, v8, s[20:23], s26 offen sc1
    v_lshlrev_b32 v105, 16, v105
    v_mul_f32 v105, v105, v12
    v_cvt_pk_bf16_f32 v105, v105, v105
    v_lshlrev_b32 v105, 16, v105
    v_fma_f32 v105, 2.0, v41, v105
    s_add_u32 s26, s25, 69632
    buffer_store_dword v105, v8, s[20:23], s26 offen sc1
    v_lshlrev_b32 v106, 16, v106
    v_mul_f32 v106, v106, v12
    v_cvt_pk_bf16_f32 v106, v106, v106
    v_lshlrev_b32 v106, 16, v106
    v_fma_f32 v106, 2.0, v42, v106
    s_add_u32 s26, s25, 73728
    buffer_store_dword v106, v8, s[20:23], s26 offen sc1
    v_lshlrev_b32 v107, 16, v107
    v_mul_f32 v107, v107, v12
    v_cvt_pk_bf16_f32 v107, v107, v107
    v_lshlrev_b32 v107, 16, v107
    v_fma_f32 v107, 2.0, v43, v107
    s_add_u32 s26, s25, 77824
    buffer_store_dword v107, v8, s[20:23], s26 offen sc1
    v_lshlrev_b32 v108, 16, v108
    v_mul_f32 v108, v108, v12
    v_cvt_pk_bf16_f32 v108, v108, v108
    v_lshlrev_b32 v108, 16, v108
    v_fma_f32 v108, 2.0, v44, v108
    s_add_u32 s26, s25, 98304
    buffer_store_dword v108, v8, s[20:23], s26 offen sc1
    v_lshlrev_b32 v109, 16, v109
    v_mul_f32 v109, v109, v12
    v_cvt_pk_bf16_f32 v109, v109, v109
    v_lshlrev_b32 v109, 16, v109
    v_fma_f32 v109, 2.0, v45, v109
    s_add_u32 s26, s25, 102400
    buffer_store_dword v109, v8, s[20:23], s26 offen sc1
    v_lshlrev_b32 v110, 16, v110
    v_mul_f32 v110, v110, v12
    v_cvt_pk_bf16_f32 v110, v110, v110
    v_lshlrev_b32 v110, 16, v110
    v_fma_f32 v110, 2.0, v46, v110
    s_add_u32 s26, s25, 106496
    buffer_store_dword v110, v8, s[20:23], s26 offen sc1
    v_lshlrev_b32 v111, 16, v111
    v_mul_f32 v111, v111, v12
    v_cvt_pk_bf16_f32 v111, v111, v111
    v_lshlrev_b32 v111, 16, v111
    v_fma_f32 v111, 2.0, v47, v111
    s_add_u32 s26, s25, 110592
    buffer_store_dword v111, v8, s[20:23], s26 offen sc1
    s_add_u32 s33, s33, 1
    s_cmp_ge_u32 s33, 8
    s_cbranch_scc1 L_yy_fin
    s_waitcnt vmcnt(0)
    s_barrier
    s_mov_b32 s28, s31
    s_add_u32 s31, s31, 8
    s_cmp_ge_u32 s31, 64
    s_cbranch_scc1 L_yy_nx1
    s_lshl_b32 s25, s31, 16
    s_lshl_b32 s26, s24, 14
    s_add_u32 s25, s25, s26
    s_add_u32 s25, s25, 109051904
    s_mul_i32 s26, s24, 16512
    s_add_u32 s26, s26, 0
    s_add_u32 m0, s26, 0
    s_add_u32 s27, s25, 0
    buffer_load_dwordx4 v4, s[8:11], s27 offen sc1 lds
    s_add_u32 m0, s26, 1024
    s_add_u32 s27, s25, 1024
    buffer_load_dwordx4 v4, s[8:11], s27 offen sc1 lds
    s_add_u32 m0, s26, 2064
    s_add_u32 s27, s25, 2048
    buffer_load_dwordx4 v4, s[8:11], s27 offen sc1 lds
    s_add_u32 m0, s26, 3088
    s_add_u32 s27, s25, 3072
    buffer_load_dwordx4 v4, s[8:11], s27 offen sc1 lds
    s_add_u32 m0, s26, 4128
    s_add_u32 s27, s25, 4096
    buffer_load_dwordx4 v4, s[8:11], s27 offen sc1 lds
    s_add_u32 m0, s26, 5152
    s_add_u32 s27, s25, 5120
    buffer_load_dwordx4 v4, s[8:11], s27 offen sc1 lds
    s_add_u32 m0, s26, 6192
    s_add_u32 s27, s25, 6144
    buffer_load_dwordx4 v4, s[8:11], s27 offen sc1 lds
    s_add_u32 m0, s26, 7216
    s_add_u32 s27, s25, 7168
    buffer_load_dwordx4 v4, s[8:11], s27 offen sc1 lds
    s_add_u32 m0, s26, 8256
    s_add_u32 s27, s25, 8192
    buffer_load_dwordx4 v4, s[8:11], s27 offen sc1 lds
    s_add_u32 m0, s26, 9280
    s_add_u32 s27, s25, 9216
    buffer_load_dwordx4 v4, s[8:11], s27 offen sc1 lds
    s_add_u32 m0, s26, 10320
    s_add_u32 s27, s25, 10240
    buffer_load_dwordx4 v4, s[8:11], s27 offen sc1 lds
    s_add_u32 m0, s26, 11344
    s_add_u32 s27, s25, 11264
    buffer_load_dwordx4 v4, s[8:11], s27 offen sc1 lds
    s_add_u32 m0, s26, 12384
    s_add_u32 s27, s25, 12288
    buffer_load_dwordx4 v4, s[8:11], s27 offen sc1 lds
    s_add_u32 m0, s26, 13408
    s_add_u32 s27, s25, 13312
    buffer_load_dwordx4 v4, s[8:11], s27 offen sc1 lds
    s_add_u32 m0, s26, 14448
    s_add_u32 s27, s25, 14336
    buffer_load_dwordx4 v4, s[8:11], s27 offen sc1 lds
    s_add_u32 m0, s26, 15472
    s_add_u32 s27, s25, 15360
    buffer_load_dwordx4 v4, s[8:11], s27 offen sc1 lds
L_yy_nx1:
    s_lshl_b32 s25, s28, 15
    s_add_u32 s26, s25, 0
    buffer_load_ushort v96, v7, s[12:15], s26 offen
    s_add_u32 s26, s25, 1024
    buffer_load_ushort v97, v7, s[12:15], s26 offen
    s_add_u32 s26, s25, 2048
    buffer_load_ushort v98, v7, s[12:15], s26 offen
    s_add_u32 s26, s25, 3072
    buffer_load_ushort v99, v7, s[12:15], s26 offen
    s_add_u32 s26, s25, 8192
    buffer_load_ushort v100, v7, s[12:15], s26 offen
    s_add_u32 s26, s25, 9216
    buffer_load_ushort v101, v7, s[12:15], s26 offen
    s_add_u32 s26, s25, 10240
    buffer_load_ushort v102, v7, s[12:15], s26 offen
    s_add_u32 s26, s25, 11264
    buffer_load_ushort v103, v7, s[12:15], s26 offen
    s_add_u32 s26, s25, 16384
    buffer_load_ushort v104, v7, s[12:15], s26 offen
    s_add_u32 s26, s25, 17408
    buffer_load_ushort v105, v7, s[12:15], s26 offen
    s_add_u32 s26, s25, 18432
    buffer_load_ushort v106, v7, s[12:15], s26 offen
    s_add_u32 s26, s25, 19456
    buffer_load_ushort v107, v7, s[12:15], s26 offen
    s_add_u32 s26, s25, 24576
    buffer_load_ushort v108, v7, s[12:15], s26 offen
    s_add_u32 s26, s25, 25600
    buffer_load_ushort v109, v7, s[12:15], s26 offen
    s_add_u32 s26, s25, 26624
    buffer_load_ushort v110, v7, s[12:15], s26 offen
    s_add_u32 s26, s25, 27648
    buffer_load_ushort v111, v7, s[12:15], s26 offen
    ds_read_b128 v[64:67], v13 offset:0
    ds_read_b128 v[68:71], v13 offset:16
    ds_read_b128 v[72:75], v13 offset:64
    ds_read_b128 v[76:79], v13 offset:80
    ds_read_b128 v[80:83], v13 offset:128
    ds_read_b128 v[84:87], v13 offset:144
    ds_read_b128 v[88:91], v13 offset:192
    ds_read_b128 v[92:95], v13 offset:208
    s_waitcnt lgkmcnt(7)
    v_mfma_f32_32x32x16_bf16 v[32:47], v[64:67], a[0:3], 0
    ds_read_b128 v[64:67], v13 offset:256
    s_waitcnt lgkmcnt(7)
    v_mfma_f32_32x32x16_bf16 v[32:47], v[68:71], a[4:7], v[32:47]
    ds_read_b128 v[68:71], v13 offset:272
    s_waitcnt lgkmcnt(7)
    v_mfma_f32_32x32x16_bf16 v[32:47], v[72:75], a[8:11], v[32:47]
    ds_read_b128 v[72:75], v13 offset:320
    s_waitcnt lgkmcnt(7)
    v_mfma_f32_32x32x16_bf16 v[32:47], v[76:79], a[12:15], v[32:47]
    ds_read_b128 v[76:79], v13 offset:336
    s_waitcnt lgkmcnt(7)
    v_mfma_f32_32x32x16_bf16 v[32:47], v[80:83], a[16:19], v[32:47]
    ds_read_b128 v[80:83], v13 offset:384
    s_waitcnt lgkmcnt(7)
    v_mfma_f32_32x32x16_bf16 v[32:47], v[84:87], a[20:23], v[32:47]
    ds_read_b128 v[84:87], v13 offset:400
    s_waitcnt lgkmcnt(7)
    v_mfma_f32_32x32x16_bf16 v[32:47], v[88:91], a[24:27], v[32:47]
    ds_read_b128 v[88:91], v13 offset:448
    s_waitcnt lgkmcnt(7)
    v_mfma_f32_32x32x16_bf16 v[32:47], v[92:95], a[28:31], v[32:47]
    ds_read_b128 v[92:95], v13 offset:464
    s_waitcnt lgkmcnt(7)
    v_mfma_f32_32x32x16_bf16 v[32:47], v[64:67], a[32:35], v[32:47]
    ds_read_b128 v[64:67], v13 offset:512
    s_waitcnt lgkmcnt(7)
    v_mfma_f32_32x32x16_bf16 v[32:47], v[68:71], a[36:39], v[32:47]
    ds_read_b128 v[68:71], v13 offset:528
    s_waitcnt lgkmcnt(7)
    v_mfma_f32_32x32x16_bf16 v[32:47], v[72:75], a[40:43], v[32:47]
    ds_read_b128 v[72:75], v13 offset:576
    s_waitcnt lgkmcnt(7)
    v_mfma_f32_32x32x16_bf16 v[32:47], v[76:79], a[44:47], v[32:47]
    ds_read_b128 v[76:79], v13 offset:592
    s_waitcnt lgkmcnt(7)
    v_mfma_f32_32x32x16_bf16 v[32:47], v[80:83], a[48:51], v[32:47]
    ds_read_b128 v[80:83], v13 offset:640
    s_waitcnt lgkmcnt(7)
    v_mfma_f32_32x32x16_bf16 v[32:47], v[84:87], a[52:55], v[32:47]
    ds_read_b128 v[84:87], v13 offset:656
    s_waitcnt lgkmcnt(7)
    v_mfma_f32_32x32x16_bf16 v[32:47], v[88:91], a[56:59], v[32:47]
    ds_read_b128 v[88:91], v13 offset:704
    s_waitcnt lgkmcnt(7)
    v_mfma_f32_32x32x16_bf16 v[32:47], v[92:95], a[60:63], v[32:47]
    ds_read_b128 v[92:95], v13 offset:720
    s_waitcnt lgkmcnt(7)
    v_mfma_f32_32x32x16_bf16 v[32:47], v[64:67], a[64:67], v[32:47]
    ds_read_b128 v[64:67], v13 offset:768
    s_waitcnt lgkmcnt(7)
    v_mfma_f32_32x32x16_bf16 v[32:47], v[68:71], a[68:71], v[32:47]
    ds_read_b128 v[68:71], v13 offset:784
    s_waitcnt lgkmcnt(7)
    v_mfma_f32_32x32x16_bf16 v[32:47], v[72:75], a[72:75], v[32:47]
    ds_read_b128 v[72:75], v13 offset:832
    s_waitcnt lgkmcnt(7)
    v_mfma_f32_32x32x16_bf16 v[32:47], v[76:79], a[76:79], v[32:47]
    ds_read_b128 v[76:79], v13 offset:848
    s_waitcnt lgkmcnt(7)
    v_mfma_f32_32x32x16_bf16 v[32:47], v[80:83], a[80:83], v[32:47]
    ds_read_b128 v[80:83], v13 offset:896
    s_waitcnt lgkmcnt(7)
    v_mfma_f32_32x32x16_bf16 v[32:47], v[84:87], a[84:87], v[32:47]
    ds_read_b128 v[84:87], v13 offset:912
    s_waitcnt lgkmcnt(7)
    v_mfma_f32_32x32x16_bf16 v[32:47], v[88:91], a[88:91], v[32:47]
    ds_read_b128 v[88:91], v13 offset:960
    s_waitcnt lgkmcnt(7)
    v_mfma_f32_32x32x16_bf16 v[32:47], v[92:95], a[92:95], v[32:47]
    ds_read_b128 v[92:95], v13 offset:976
    s_waitcnt lgkmcnt(7)
    v_mfma_f32_32x32x16_bf16 v[32:47], v[64:67], a[96:99], v[32:47]
    ds_read_b128 v[64:67], v13 offset:1024
    s_waitcnt lgkmcnt(7)
    v_mfma_f32_32x32x16_bf16 v[32:47], v[68:71], a[100:103], v[32:47]
    ds_read_b128 v[68:71], v13 offset:1040
    s_waitcnt lgkmcnt(7)
    v_mfma_f32_32x32x16_bf16 v[32:47], v[72:75], a[104:107], v[32:47]
    ds_read_b128 v[72:75], v13 offset:1088
    s_waitcnt lgkmcnt(7)
    v_mfma_f32_32x32x16_bf16 v[32:47], v[76:79], a[108:111], v[32:47]
    ds_read_b128 v[76:79], v13 offset:1104
    s_waitcnt lgkmcnt(7)
    v_mfma_f32_32x32x16_bf16 v[32:47], v[80:83], a[112:115], v[32:47]
    ds_read_b128 v[80:83], v13 offset:1152
    s_waitcnt lgkmcnt(7)
    v_mfma_f32_32x32x16_bf16 v[32:47], v[84:87], a[116:119], v[32:47]
    ds_read_b128 v[84:87], v13 offset:1168
    s_waitcnt lgkmcnt(7)
    v_mfma_f32_32x32x16_bf16 v[32:47], v[88:91], a[120:123], v[32:47]
    ds_read_b128 v[88:91], v13 offset:1216
    s_waitcnt lgkmcnt(7)
    v_mfma_f32_32x32x16_bf16 v[32:47], v[92:95], a[124:127], v[32:47]
    ds_read_b128 v[92:95], v13 offset:1232
    s_waitcnt lgkmcnt(7)
    v_mfma_f32_32x32x16_bf16 v[32:47], v[64:67], a[128:131], v[32:47]
    ds_read_b128 v[64:67], v13 offset:1280
    s_waitcnt lgkmcnt(7)
    v_mfma_f32_32x32x16_bf16 v[32:47], v[68:71], a[132:135], v[32:47]
    ds_read_b128 v[68:71], v13 offset:1296
    s_waitcnt lgkmcnt(7)
    v_mfma_f32_32x32x16_bf16 v[32:47], v[72:75], a[136:139], v[32:47]
    ds_read_b128 v[72:75], v13 offset:1344
    s_waitcnt lgkmcnt(7)
    v_mfma_f32_32x32x16_bf16 v[32:47], v[76:79], a[140:143], v[32:47]
    ds_read_b128 v[76:79], v13 offset:1360
    s_waitcnt lgkmcnt(7)
    v_mfma_f32_32x32x16_bf16 v[32:47], v[80:83], a[144:147], v[32:47]
    ds_read_b128 v[80:83], v13 offset:1408
    s_waitcnt lgkmcnt(7)
    v_mfma_f32_32x32x16_bf16 v[32:47], v[84:87], a[148:151], v[32:47]
    ds_read_b128 v[84:87], v13 offset:1424
    s_waitcnt lgkmcnt(7)
    v_mfma_f32_32x32x16_bf16 v[32:47], v[88:91], a[152:155], v[32:47]
    ds_read_b128 v[88:91], v13 offset:1472
    s_waitcnt lgkmcnt(7)
    v_mfma_f32_32x32x16_bf16 v[32:47], v[92:95], a[156:159], v[32:47]
    ds_read_b128 v[92:95], v13 offset:1488
    s_waitcnt lgkmcnt(7)
    v_mfma_f32_32x32x16_bf16 v[32:47], v[64:67], a[160:163], v[32:47]
    ds_read_b128 v[64:67], v13 offset:1536
    s_waitcnt lgkmcnt(7)
    v_mfma_f32_32x32x16_bf16 v[32:47], v[68:71], a[164:167], v[32:47]
    ds_read_b128 v[68:71], v13 offset:1552
    s_waitcnt lgkmcnt(7)
    v_mfma_f32_32x32x16_bf16 v[32:47], v[72:75], a[168:171], v[32:47]
    ds_read_b128 v[72:75], v13 offset:1600
    s_waitcnt lgkmcnt(7)
    v_mfma_f32_32x32x16_bf16 v[32:47], v[76:79], a[172:175], v[32:47]
    ds_read_b128 v[76:79], v13 offset:1616
    s_waitcnt lgkmcnt(7)
    v_mfma_f32_32x32x16_bf16 v[32:47], v[80:83], a[176:179], v[32:47]
    ds_read_b128 v[80:83], v13 offset:1664
    s_waitcnt lgkmcnt(7)
    v_mfma_f32_32x32x16_bf16 v[32:47], v[84:87], a[180:183], v[32:47]
    ds_read_b128 v[84:87], v13 offset:1680
    s_waitcnt lgkmcnt(7)
    v_mfma_f32_32x32x16_bf16 v[32:47], v[88:91], a[184:187], v[32:47]
    ds_read_b128 v[88:91], v13 offset:1728
    s_waitcnt lgkmcnt(7)
    v_mfma_f32_32x32x16_bf16 v[32:47], v[92:95], a[188:191], v[32:47]
    ds_read_b128 v[92:95], v13 offset:1744
    s_waitcnt lgkmcnt(7)
    v_mfma_f32_32x32x16_bf16 v[32:47], v[64:67], a[192:195], v[32:47]
    ds_read_b128 v[64:67], v13 offset:1792
    s_waitcnt lgkmcnt(7)
    v_mfma_f32_32x32x16_bf16 v[32:47], v[68:71], a[196:199], v[32:47]
    ds_read_b128 v[68:71], v13 offset:1808
    s_waitcnt lgkmcnt(7)
    v_mfma_f32_32x32x16_bf16 v[32:47], v[72:75], a[200:203], v[32:47]
    ds_read_b128 v[72:75], v13 offset:1856
    s_waitcnt lgkmcnt(7)
    v_mfma_f32_32x32x16_bf16 v[32:47], v[76:79], a[204:207], v[32:47]
    ds_read_b128 v[76:79], v13 offset:1872
    s_waitcnt lgkmcnt(7)
    v_mfma_f32_32x32x16_bf16 v[32:47], v[80:83], a[208:211], v[32:47]
    ds_read_b128 v[80:83], v13 offset:1920
    s_waitcnt lgkmcnt(7)
    v_mfma_f32_32x32x16_bf16 v[32:47], v[84:87], a[212:215], v[32:47]
    ds_read_b128 v[84:87], v13 offset:1936
    s_waitcnt lgkmcnt(7)
    v_mfma_f32_32x32x16_bf16 v[32:47], v[88:91], a[216:219], v[32:47]
    ds_read_b128 v[88:91], v13 offset:1984
    s_waitcnt lgkmcnt(7)
    v_mfma_f32_32x32x16_bf16 v[32:47], v[92:95], a[220:223], v[32:47]
    ds_read_b128 v[92:95], v13 offset:2000
    s_waitcnt lgkmcnt(7)
    v_mfma_f32_32x32x16_bf16 v[32:47], v[64:67], a[224:227], v[32:47]
    s_waitcnt lgkmcnt(6)
    v_mfma_f32_32x32x16_bf16 v[32:47], v[68:71], a[228:231], v[32:47]
    s_waitcnt lgkmcnt(5)
    v_mfma_f32_32x32x16_bf16 v[32:47], v[72:75], a[232:235], v[32:47]
    s_waitcnt lgkmcnt(4)
    v_mfma_f32_32x32x16_bf16 v[32:47], v[76:79], a[236:239], v[32:47]
    s_waitcnt lgkmcnt(3)
    v_mfma_f32_32x32x16_bf16 v[32:47], v[80:83], a[240:243], v[32:47]
    s_waitcnt lgkmcnt(2)
    v_mfma_f32_32x32x16_bf16 v[32:47], v[84:87], a[244:247], v[32:47]
    s_waitcnt lgkmcnt(1)
    v_mfma_f32_32x32x16_bf16 v[32:47], v[88:91], a[248:251], v[32:47]
    s_waitcnt lgkmcnt(0)
    v_mfma_f32_32x32x16_bf16 v[32:47], v[92:95], a[252:255], v[32:47]
    s_waitcnt vmcnt(0)
    s_nop 7
    s_lshl_b32 s25, s28, 17
    v_lshlrev_b32 v96, 16, v96
    v_mul_f32 v96, v96, v12
    v_cvt_pk_bf16_f32 v96, v96, v96
    v_lshlrev_b32 v96, 16, v96
    v_fma_f32 v96, 2.0, v32, v96
    s_add_u32 s26, s25, 0
    buffer_store_dword v96, v8, s[20:23], s26 offen sc1
    v_lshlrev_b32 v97, 16, v97
    v_mul_f32 v97, v97, v12
    v_cvt_pk_bf16_f32 v97, v97, v97
    v_lshlrev_b32 v97, 16, v97
    v_fma_f32 v97, 2.0, v33, v97
    s_add_u32 s26, s25, 4096
    buffer_store_dword v97, v8, s[20:23], s26 offen sc1
    v_lshlrev_b32 v98, 16, v98
    v_mul_f32 v98, v98, v12
    v_cvt_pk_bf16_f32 v98, v98, v98
    v_lshlrev_b32 v98, 16, v98
    v_fma_f32 v98, 2.0, v34, v98
    s_add_u32 s26, s25, 8192
    buffer_store_dword v98, v8, s[20:23], s26 offen sc1
    v_lshlrev_b32 v99, 16, v99
    v_mul_f32 v99, v99, v12
    v_cvt_pk_bf16_f32 v99, v99, v99
    v_lshlrev_b32 v99, 16, v99
    v_fma_f32 v99, 2.0, v35, v99
    s_add_u32 s26, s25, 12288
    buffer_store_dword v99, v8, s[20:23], s26 offen sc1
    v_lshlrev_b32 v100, 16, v100
    v_mul_f32 v100, v100, v12
    v_cvt_pk_bf16_f32 v100, v100, v100
    v_lshlrev_b32 v100, 16, v100
    v_fma_f32 v100, 2.0, v36, v100
    s_add_u32 s26, s25, 32768
    buffer_store_dword v100, v8, s[20:23], s26 offen sc1
    v_lshlrev_b32 v101, 16, v101
    v_mul_f32 v101, v101, v12
    v_cvt_pk_bf16_f32 v101, v101, v101
    v_lshlrev_b32 v101, 16, v101
    v_fma_f32 v101, 2.0, v37, v101
    s_add_u32 s26, s25, 36864
    buffer_store_dword v101, v8, s[20:23], s26 offen sc1
    v_lshlrev_b32 v102, 16, v102
    v_mul_f32 v102, v102, v12
    v_cvt_pk_bf16_f32 v102, v102, v102
    v_lshlrev_b32 v102, 16, v102
    v_fma_f32 v102, 2.0, v38, v102
    s_add_u32 s26, s25, 40960
    buffer_store_dword v102, v8, s[20:23], s26 offen sc1
    v_lshlrev_b32 v103, 16, v103
    v_mul_f32 v103, v103, v12
    v_cvt_pk_bf16_f32 v103, v103, v103
    v_lshlrev_b32 v103, 16, v103
    v_fma_f32 v103, 2.0, v39, v103
    s_add_u32 s26, s25, 45056
    buffer_store_dword v103, v8, s[20:23], s26 offen sc1
    v_lshlrev_b32 v104, 16, v104
    v_mul_f32 v104, v104, v12
    v_cvt_pk_bf16_f32 v104, v104, v104
    v_lshlrev_b32 v104, 16, v104
    v_fma_f32 v104, 2.0, v40, v104
    s_add_u32 s26, s25, 65536
    buffer_store_dword v104, v8, s[20:23], s26 offen sc1
    v_lshlrev_b32 v105, 16, v105
    v_mul_f32 v105, v105, v12
    v_cvt_pk_bf16_f32 v105, v105, v105
    v_lshlrev_b32 v105, 16, v105
    v_fma_f32 v105, 2.0, v41, v105
    s_add_u32 s26, s25, 69632
    buffer_store_dword v105, v8, s[20:23], s26 offen sc1
    v_lshlrev_b32 v106, 16, v106
    v_mul_f32 v106, v106, v12
    v_cvt_pk_bf16_f32 v106, v106, v106
    v_lshlrev_b32 v106, 16, v106
    v_fma_f32 v106, 2.0, v42, v106
    s_add_u32 s26, s25, 73728
    buffer_store_dword v106, v8, s[20:23], s26 offen sc1
    v_lshlrev_b32 v107, 16, v107
    v_mul_f32 v107, v107, v12
    v_cvt_pk_bf16_f32 v107, v107, v107
    v_lshlrev_b32 v107, 16, v107
    v_fma_f32 v107, 2.0, v43, v107
    s_add_u32 s26, s25, 77824
    buffer_store_dword v107, v8, s[20:23], s26 offen sc1
    v_lshlrev_b32 v108, 16, v108
    v_mul_f32 v108, v108, v12
    v_cvt_pk_bf16_f32 v108, v108, v108
    v_lshlrev_b32 v108, 16, v108
    v_fma_f32 v108, 2.0, v44, v108
    s_add_u32 s26, s25, 98304
    buffer_store_dword v108, v8, s[20:23], s26 offen sc1
    v_lshlrev_b32 v109, 16, v109
    v_mul_f32 v109, v109, v12
    v_cvt_pk_bf16_f32 v109, v109, v109
    v_lshlrev_b32 v109, 16, v109
    v_fma_f32 v109, 2.0, v45, v109
    s_add_u32 s26, s25, 102400
    buffer_store_dword v109, v8, s[20:23], s26 offen sc1
    v_lshlrev_b32 v110, 16, v110
    v_mul_f32 v110, v110, v12
    v_cvt_pk_bf16_f32 v110, v110, v110
    v_lshlrev_b32 v110, 16, v110
    v_fma_f32 v110, 2.0, v46, v110
    s_add_u32 s26, s25, 106496
    buffer_store_dword v110, v8, s[20:23], s26 offen sc1
    v_lshlrev_b32 v111, 16, v111
    v_mul_f32 v111, v111, v12
    v_cvt_pk_bf16_f32 v111, v111, v111
    v_lshlrev_b32 v111, 16, v111
    v_fma_f32 v111, 2.0, v47, v111
    s_add_u32 s26, s25, 110592
    buffer_store_dword v111, v8, s[20:23], s26 offen sc1
    s_add_u32 s33, s33, 1
    s_cmp_ge_u32 s33, 8
    s_cbranch_scc1 L_yy_fin
    s_branch L_yy_loop
L_yy_fin:
    s_waitcnt vmcnt(0)
    s_waitcnt vmcnt(0)
L_exit:
    s_endpgm
.section .rodata,"a"
.p2align 6
.amdhsa_kernel concat_heads__memory_aug_recurrent_mem_tr__ssm_conv_s5__prompt_kernel
  .amdhsa_next_free_vgpr 512
  .amdhsa_next_free_sgpr 102
  .amdhsa_accum_offset 256
  .amdhsa_group_segment_fixed_size 0
  .amdhsa_kernarg_size 152
  .amdhsa_user_sgpr_count 2
  .amdhsa_user_sgpr_kernarg_segment_ptr 1
  .amdhsa_system_sgpr_workgroup_id_x 1
.end_amdhsa_kernel
```
